```python
import torch

def _softmax(x, axis=-1):
    return torch.softmax(x, dim=axis)
def _gelu(x):
    return torch.nn.functional.gelu(x, approximate="tanh")
def _silu(x):
    return torch.nn.functional.silu(x)
def _sigmoid(x):
    return torch.sigmoid(x)
def _layernorm(x, axis=-1, eps=1e-5):
    m = x.mean(dim=axis, keepdim=True)
    v = x.var(dim=axis, keepdim=True, unbiased=False)
    return (x - m) / torch.sqrt(v + eps)
def _scatter_add(tgt, idx, src, axis=0):
    return tgt.clone().index_add_(axis, idx, src)
def _segment_sum(src, seg, n):
    out = torch.zeros((n,) + src.shape[1:], dtype=src.dtype)
    return out.index_add_(0, seg, src)
def _pad(x, pw):
    flat = tuple(v for pair in reversed(pw) for v in pair)
    return torch.nn.functional.pad(x, flat)

kernel_name = 'sequential_preLN__linear_attn_block__swiglu_ffn__prompt'

def setup_inputs():

    _w = (lambda a: (lambda t: t.to(torch.bfloat16) if t.is_floating_point() else t)(torch.as_tensor(a)))
    def _A_setup():
        B, S, D = 1, 2048, 640
        return {
            "x": _w((lambda *s: torch.randn(*s, dtype=torch.bfloat16) * 0.05)(B, S, D)),
            "wqkv": _w((lambda *s: torch.randn(*s, dtype=torch.bfloat16) * 0.1)(D, 3 * D)),
            "wo": _w((lambda *s: torch.randn(*s, dtype=torch.bfloat16) * 0.05)(D, D)),
        }
    _A_in = _A_setup()

    def _B_setup():
        B, S, D, F = 1, 2048, 640, 1728
        return {
            "x": _w((lambda *s: torch.randn(*s, dtype=torch.bfloat16) * 0.05)(B, S, D)),
            "w_gate": _w((lambda *s: torch.randn(*s, dtype=torch.bfloat16) * 0.05)(D, F)),
            "w_up": _w((lambda *s: torch.randn(*s, dtype=torch.bfloat16) * 0.05)(D, F)),
            "w_down": _w((lambda *s: torch.randn(*s, dtype=torch.bfloat16) * 0.05)(F, D)),
        }
    _B_in = _B_setup()

    return {
        "A_x": _A_in["x"],
        "A_wqkv": _A_in["wqkv"],
        "A_wo": _A_in["wo"],
        "B_x": _B_in["x"],
        "B_w_gate": _B_in["w_gate"],
        "B_w_up": _B_in["w_up"],
        "B_w_down": _B_in["w_down"],
    }

def reference(A_x, A_wqkv, A_wo, B_x, B_w_gate, B_w_up, B_w_down):
    def _A_ref(x, wqkv, wo):
        B, S, D = x.shape
        H = 32; Dh = D // H
        qkv = (lambda x, *d: x.permute(*d))((x @ wqkv).reshape(B, S, 3, H, Dh), 2, 0, 3, 1, 4)
        q, k, v = qkv[0], qkv[1], qkv[2]
        phi = lambda t: torch.where(t > 0, t + 1, torch.exp(t)) + 1e-6
        pq, pk = phi(q), phi(k)
        kv = torch.einsum("bhsd,bhse->bhde", pk, v)
        z = torch.einsum("bhsd->bhd", pk)
        num = torch.einsum("bhqd,bhde->bhqe", pq, kv)
        den = torch.einsum("bhqd,bhd->bhq", pq, z)[..., None] + 1e-6
        o = num / den
        return (lambda x, *d: x.permute(*d))(o, 0, 2, 1, 3).reshape(B, S, D) @ wo

    def _B_ref(x, w_gate, w_up, w_down):
        g = _silu(x @ w_gate)
        u = x @ w_up
        return (g * u) @ w_down

    x = A_x
    h = x + _A_ref(_layernorm(x, axis=-1), A_wqkv, A_wo)
    h2 = h + _B_ref(_layernorm(h, axis=-1), B_w_gate, B_w_up, B_w_down)
    return h2
```

```asm
; @launch kernel=k1_kernel grid=(256,1,1) block=(512,1,1) lds=163840
; @launch kernel=k234_kernel grid=(256,1,1) block=(256,1,1) lds=159744
.amdgcn_target "amdgcn-amd-amdhsa--gfx950"
.text
.globl k1_kernel
.p2align 8
.type k1_kernel,@function
k1_kernel:
    s_cmp_ge_u32 s2, 0x100
    s_cbranch_scc1 L_end_k1_kernel
    s_load_dwordx16 s[32:47], s[0:1], 0x0
    s_load_dwordx4 s[48:51], s[0:1], 0x40
    s_getpc_b64 s[90:91]
L_pc_k1:
    v_and_b32 v1, 63, v0
    v_lshrrev_b32 v164, 6, v0
    s_nop 0
    v_readfirstlane_b32 s52, v164
    v_lshrrev_b32 v2, 4, v1
    v_and_b32 v3, 15, v1
    s_and_b32 s65, s2, 7
    s_lshr_b32 s64, s2, 3
    s_sub_u32 s20, s90, (L_pc_k1-k1_kernel)
    s_subb_u32 s21, s91, 0
    s_mov_b32 s22, (L_code_end-k1_kernel)
    s_mov_b32 s23, 0x20000
    s_cmp_lt_u32 s64, 24
    s_cbranch_scc1 L_k1_gemm
    s_sub_u32 s66, s64, 24
    s_lshl_b32 s71, s66, 3
    s_add_u32 s71, s71, s52
    s_lshl_b32 s66, s66, 3
    s_add_u32 s66, s66, s65
    s_lshl_b32 s67, s66, 3
    s_add_u32 s67, s67, s52
    v_lshlrev_b32_e64 v9, 4, v1
    v_mul_u32_u24 v128, 0x500, v1
    s_lshl_b32 s57, s52, 10
    s_add_u32 s57, s57, (L_k1_rt2-k1_kernel)
    buffer_load_dwordx4 v[24:27], v9, s[20:23], s57 offen
    s_waitcnt lgkmcnt(0)
    s_mov_b32 s4, s32
    s_mov_b32 s5, s33
    s_mov_b32 s6, 0x280000
    s_mov_b32 s7, 0x20000
    s_mov_b32 s8, s34
    s_mov_b32 s9, s35
    s_mov_b32 s10, 0x258000
    s_mov_b32 s11, 0x20000
    s_mov_b32 s12, s50
    s_mov_b32 s13, s51
    s_mov_b32 s14, 0x1800000
    s_mov_b32 s15, 0x20000
    s_mov_b32 s69, 0
    s_add_u32 s71, s71, 46
L_k1_pf:
    s_mul_i32 s72, s71, 0xb22
    s_lshr_b32 s72, s72, 16
    s_mul_i32 s57, s72, 23
    s_sub_u32 s73, s71, s57
    s_cmp_ge_u32 s73, 8
    s_cbranch_scc1 L_k1_pfw
    s_lshr_b32 s57, s65, 1
    s_lshl_b32 s57, s57, 3
    s_add_u32 s57, s57, s73
    s_mul_i32 s57, s57, 0x14000
    s_lshl_b32 s58, s72, 7
    s_add_u32 s57, s57, s58
    s_cmp_ge_u32 s72, 10
    s_cselect_b32 s57, 0x7f000000, s57
    buffer_load_dword v20, v128, s[4:7], s57 offen
    s_branch L_k1_pfn
L_k1_pfw:
    s_sub_u32 s57, s73, 8
    s_lshl_b32 s57, s57, 6
    v_add_u32_e64 v120, s57, v1
    v_mul_u32_u24 v121, 0x1112, v120
    v_lshrrev_b32 v121, 16, v121
    v_mul_u32_u24 v122, 15, v121
    v_sub_u32_e64 v122, v120, v122
    v_mul_u32_u24 v123, 0x3334, v122
    v_lshrrev_b32_e64 v123, 16, v123
    v_mul_u32_u24 v121, 0xf00, v121
    v_mul_u32_u24 v123, 0x280, v123
    v_lshl_add_u32 v121, v122, 7, v121
    v_add_u32_e64 v121, v121, v123
    s_mul_i32 s57, s72, 0x3c000
    s_and_b32 s58, s65, 1
    s_mul_i32 s58, s58, 0x280
    s_add_u32 s57, s57, s58
    buffer_load_dword v21, v121, s[8:11], s57 offen
L_k1_pfn:
    s_add_u32 s71, s71, 64
    s_add_u32 s69, s69, 1
    s_cmp_lt_u32 s69, 3
    s_cbranch_scc1 L_k1_pf
    s_branch L_k1_rt2
L_k1_gemm:
    s_cmp_ge_u32 s64, 16
    s_cselect_b32 s63, 1, 0
    s_lshr_b32 s53, s65, 1
    s_lshl_b32 s53, s53, 2
    s_and_b32 s75, s65, 1
    s_lshr_b32 s57, s64, 2
    s_and_b32 s58, s64, 3
    s_lshl_b32 s54, s75, 2
    s_add_u32 s54, s54, s58
    s_and_b32 s55, s64, 7
    s_lshr_b32 s55, s55, 1
    s_and_b32 s56, s64, 1
    s_lshl_b32 s58, s75, 1
    s_add_u32 s56, s56, s58
    s_cmp_eq_u32 s63, 1
    s_cselect_b32 s57, s55, s57
    s_cselect_b32 s54, s56, s54
    s_add_u32 s53, s53, s57
    v_mov_b32 v164, 0x7f000000
    v_cmp_eq_u32 vcc, 0, v1
    s_nop 1
    v_cndmask_b32 v25, v164, 0, vcc
    s_lshl_b32 s71, s54, 5
    s_add_u32 s70, s71, 4
    s_cmp_lt_u32 s52, 4
    s_cbranch_scc1 L_k1_comp
    s_sub_u32 s89, s52, 4
    v_lshrrev_b32_e64 v164, 3, v1
    v_mul_u32_u24 v164, 0x500, v164
    v_and_b32 v165, 7, v1
    v_xor_b32 v165, v165, v2
    v_xor_b32_e64 v166, 4, v165
    v_lshl_add_u32 v167, v165, 4, v164
    v_lshl_add_u32 v168, v166, 4, v164
    s_mul_i32 s57, s89, 0xa000
    v_add_u32_e64 v48, s57, v167
    s_add_u32 s57, s57, 0x2800
    v_add_u32_e64 v49, s57, v168
    s_add_u32 s57, s57, 0x2800
    v_add_u32_e64 v50, s57, v167
    s_add_u32 s57, s57, 0x2800
    v_add_u32_e64 v51, s57, v168
    s_mul_i32 s55, s53, 0x28000
    s_mul_i32 s56, s54, 0xa0
    s_lshl_b32 s56, s56, s63
    s_lshl_b32 s57, s54, s63
    s_add_u32 s57, s57, s53
    s_and_b32 s57, s57, 3
    s_lshl_b32 s57, s57, 3
    s_lshr_b32 s66, 0, s57
    s_and_b32 s66, s66, 15
    s_lshl_b32 s57, s66, 7
    s_add_u32 s55, s55, s57
    s_mul_i32 s57, s66, 0x3c000
    s_add_u32 s56, s56, s57
    s_lshl_b32 s61, s89, 12
    s_lshl_b32 s62, s89, 10
    s_add_u32 s62, s62, 0x4000
    s_add_u32 s24, s62, 0x5000
    s_cmp_ge_u32 s89, 1
    s_cselect_b32 s24, 0x30000, s24
    s_add_u32 s25, s62, 0xe400
    s_cmp_ge_u32 s89, 1
    s_cselect_b32 s25, 0x30000, s25
    s_add_u32 s26, s62, 0x17800
    s_cmp_ge_u32 s89, 1
    s_cselect_b32 s26, 0x30000, s26
    s_add_u32 s27, s62, 0x20c00
    s_cmp_ge_u32 s89, 1
    s_cselect_b32 s27, 0x30000, s27
    s_waitcnt lgkmcnt(0)
    s_mov_b32 s4, s32
    s_mov_b32 s5, s33
    s_mov_b32 s6, 0x280000
    s_mov_b32 s7, 0x20000
    s_mov_b32 s8, s34
    s_mov_b32 s9, s35
    s_mov_b32 s10, 0x258000
    s_mov_b32 s11, 0x20000
    s_add_u32 m0, s61, 0
    s_nop 0
    buffer_load_dwordx4 v48, s[4:7], s55 offen lds
    s_add_u32 m0, s61, 0x400
    s_nop 0
    buffer_load_dwordx4 v49, s[4:7], s55 offen lds
    s_add_u32 m0, s61, 0x800
    s_nop 0
    buffer_load_dwordx4 v50, s[4:7], s55 offen lds
    s_add_u32 m0, s61, 0xc00
    s_nop 0
    buffer_load_dwordx4 v51, s[4:7], s55 offen lds
    s_cmp_eq_u32 s63, 1
    s_cselect_b64 s[76:77], -1, 0
    s_lshl_b32 s57, s89, 6
    v_mov_b32 v53, 0
    v_mov_b32 v54, 0
    v_mov_b32 v55, 0
    v_mov_b32 v56, 0
    v_mov_b32 v57, 0
    v_mov_b32 v171, 0x7f000000
L_k1_wl:
    v_add_u32_e64 v164, s57, v1
    v_mul_u32_u24 v165, 0xc31, v164
    v_lshrrev_b32 v165, 16, v165
    v_mul_u32_u24 v166, 21, v165
    v_sub_u32 v166, v164, v166
    v_and_b32 v167, 32, v165
    v_bfe_u32 v168, v165, 3, 2
    v_lshl_add_u32 v167, v168, 3, v167
    v_and_b32_e64 v168, 1, v165
    v_lshl_add_u32 v167, v168, 2, v167
    v_bfe_u32 v168, v165, 1, 2
    v_add_u32_e64 v167, v167, v168
    v_mul_u32_u24 v167, 0xf00, v167
    v_mul_u32_u24 v168, 0x3334, v166
    v_lshrrev_b32 v168, 16, v168
    v_and_b32 v169, 1, v168
    v_mul_u32_u24 v169, 0x4b0, v169
    v_lshrrev_b32_e64 v170, 1, v168
    v_mul_u32_u24 v170, 0x50, v170
    v_sub_u32_e64 v169, v169, v170
    v_add_u32 v169, 0x500, v169
    v_cndmask_b32 v169, v169, 0, s[76:77]
    v_lshl_add_u32 v167, v166, 4, v167
    v_add_u32 v167, v167, v169
    v_cmp_eq_u32 vcc, 20, v166
    v_cmp_le_u32 s[78:79], 64, v165
    v_mov_b32 v52, v53
    v_mov_b32 v53, v54
    v_mov_b32 v54, v55
    v_mov_b32 v55, v56
    v_mov_b32 v56, v57
    s_or_b64 vcc, vcc, s[78:79]
    v_cndmask_b32_e64 v57, v167, v171, vcc
    s_add_u32 s57, s57, 0x100
    s_cmp_lt_u32 s57, 0x600
    s_cbranch_scc1 L_k1_wl
    s_add_u32 m0, s62, 0
    s_nop 0
    buffer_load_dwordx4 v52, s[8:11], s56 offen lds
    s_add_u32 m0, s62, 0x1000
    s_nop 0
    buffer_load_dwordx4 v53, s[8:11], s56 offen lds
    s_add_u32 m0, s62, 0x2000
    s_nop 0
    buffer_load_dwordx4 v54, s[8:11], s56 offen lds
    s_add_u32 m0, s62, 0x3000
    s_nop 0
    buffer_load_dwordx4 v55, s[8:11], s56 offen lds
    s_add_u32 m0, s62, 0x4000
    s_nop 0
    buffer_load_dwordx4 v56, s[8:11], s56 offen lds
    s_mov_b32 m0, s24
    s_nop 0
    s_nop 0
    buffer_load_dwordx4 v57, s[8:11], s56 offen lds
    s_add_u32 s55, s55, 0x80
    s_add_u32 s56, s56, 0x3c000
    s_add_u32 s66, s66, 1
    s_cmp_eq_u32 s66, 10
    s_cselect_b32 s75, 0x500, 0
    s_cselect_b32 s58, 0x258000, 0
    s_sub_u32 s55, s55, s75
    s_sub_u32 s56, s56, s58
    s_mov_b32 s16, s48
    s_mov_b32 s17, s49
    s_mov_b32 s18, 0x100
    s_mov_b32 s19, 0x20000
    s_mov_b32 s12, s50
    s_mov_b32 s13, s51
    s_mov_b32 s14, 0x1800000
    s_mov_b32 s15, 0x20000
    s_add_u32 m0, s61, 0x9400
    s_nop 0
    buffer_load_dwordx4 v48, s[4:7], s55 offen lds
    s_add_u32 m0, s61, 0x9800
    s_nop 0
    buffer_load_dwordx4 v49, s[4:7], s55 offen lds
    s_add_u32 m0, s61, 0x9c00
    s_nop 0
    buffer_load_dwordx4 v50, s[4:7], s55 offen lds
    s_add_u32 m0, s61, 0xa000
    s_nop 0
    buffer_load_dwordx4 v51, s[4:7], s55 offen lds
    s_add_u32 m0, s62, 0x9400
    s_nop 0
    buffer_load_dwordx4 v52, s[8:11], s56 offen lds
    s_add_u32 m0, s62, 0xa400
    s_nop 0
    buffer_load_dwordx4 v53, s[8:11], s56 offen lds
    s_add_u32 m0, s62, 0xb400
    s_nop 0
    buffer_load_dwordx4 v54, s[8:11], s56 offen lds
    s_add_u32 m0, s62, 0xc400
    s_nop 0
    buffer_load_dwordx4 v55, s[8:11], s56 offen lds
    s_add_u32 m0, s62, 0xd400
    s_nop 0
    buffer_load_dwordx4 v56, s[8:11], s56 offen lds
    s_mov_b32 m0, s25
    s_nop 0
    s_nop 0
    buffer_load_dwordx4 v57, s[8:11], s56 offen lds
    s_add_u32 s55, s55, 0x80
    s_add_u32 s56, s56, 0x3c000
    s_add_u32 s66, s66, 1
    s_cmp_eq_u32 s66, 10
    s_cselect_b32 s75, 0x500, 0
    s_cselect_b32 s58, 0x258000, 0
    s_sub_u32 s55, s55, s75
    s_sub_u32 s56, s56, s58
    v_mov_b32 v60, 0
    v_mov_b32 v61, 0
    v_mov_b32 v62, 0
    v_mov_b32 v63, 0
    v_lshlrev_b32 v164, 4, v1
    v_cmp_gt_u32 vcc, 36, v1
    s_nop 1
    v_cndmask_b32 v165, v171, v164, vcc
    s_mul_i32 s67, s54, 0x1a40
    s_add_u32 s67, s67, 0x1500000
    s_add_u32 s74, s67, 0x1000
    s_waitcnt vmcnt(10)
    s_barrier
    s_add_u32 m0, s61, 0x12800
    s_nop 0
    buffer_load_dwordx4 v48, s[4:7], s55 offen lds
    s_add_u32 m0, s61, 0x12c00
    s_nop 0
    buffer_load_dwordx4 v49, s[4:7], s55 offen lds
    s_add_u32 m0, s61, 0x13000
    s_nop 0
    buffer_load_dwordx4 v50, s[4:7], s55 offen lds
    s_add_u32 m0, s61, 0x13400
    s_nop 0
    buffer_load_dwordx4 v51, s[4:7], s55 offen lds
    s_add_u32 m0, s62, 0x12800
    s_nop 0
    buffer_load_dwordx4 v52, s[8:11], s56 offen lds
    s_add_u32 m0, s62, 0x13800
    s_nop 0
    buffer_load_dwordx4 v53, s[8:11], s56 offen lds
    s_add_u32 m0, s62, 0x14800
    s_nop 0
    buffer_load_dwordx4 v54, s[8:11], s56 offen lds
    s_add_u32 m0, s62, 0x15800
    s_nop 0
    buffer_load_dwordx4 v55, s[8:11], s56 offen lds
    s_add_u32 m0, s62, 0x16800
    s_nop 0
    buffer_load_dwordx4 v56, s[8:11], s56 offen lds
    s_mov_b32 m0, s26
    s_nop 0
    s_nop 0
    buffer_load_dwordx4 v57, s[8:11], s56 offen lds
    s_add_u32 s55, s55, 0x80
    s_add_u32 s56, s56, 0x3c000
    s_add_u32 s66, s66, 1
    s_cmp_eq_u32 s66, 10
    s_cselect_b32 s75, 0x500, 0
    s_cselect_b32 s58, 0x258000, 0
    s_sub_u32 s55, s55, s75
    s_sub_u32 s56, s56, s58
    s_add_u32 m0, s61, 0x1bc00
    s_nop 0
    buffer_load_dwordx4 v48, s[4:7], s55 offen lds
    s_add_u32 m0, s61, 0x1c000
    s_nop 0
    buffer_load_dwordx4 v49, s[4:7], s55 offen lds
    s_add_u32 m0, s61, 0x1c400
    s_nop 0
    buffer_load_dwordx4 v50, s[4:7], s55 offen lds
    s_add_u32 m0, s61, 0x1c800
    s_nop 0
    buffer_load_dwordx4 v51, s[4:7], s55 offen lds
    s_add_u32 m0, s62, 0x1bc00
    s_nop 0
    buffer_load_dwordx4 v52, s[8:11], s56 offen lds
    s_add_u32 m0, s62, 0x1cc00
    s_nop 0
    buffer_load_dwordx4 v53, s[8:11], s56 offen lds
    s_add_u32 m0, s62, 0x1dc00
    s_nop 0
    buffer_load_dwordx4 v54, s[8:11], s56 offen lds
    s_add_u32 m0, s62, 0x1ec00
    s_nop 0
    buffer_load_dwordx4 v55, s[8:11], s56 offen lds
    s_add_u32 m0, s62, 0x1fc00
    s_nop 0
    buffer_load_dwordx4 v56, s[8:11], s56 offen lds
    s_mov_b32 m0, s27
    s_nop 0
    s_nop 0
    buffer_load_dwordx4 v57, s[8:11], s56 offen lds
    s_add_u32 s55, s55, 0x80
    s_add_u32 s56, s56, 0x3c000
    s_add_u32 s66, s66, 1
    s_cmp_eq_u32 s66, 10
    s_cselect_b32 s75, 0x500, 0
    s_cselect_b32 s58, 0x258000, 0
    s_sub_u32 s55, s55, s75
    s_sub_u32 s56, s56, s58
    s_waitcnt vmcnt(20)
    s_barrier
    s_add_u32 m0, s61, 0
    s_nop 0
    buffer_load_dwordx4 v48, s[4:7], s55 offen lds
    s_add_u32 m0, s61, 0x400
    s_nop 0
    buffer_load_dwordx4 v49, s[4:7], s55 offen lds
    s_add_u32 m0, s61, 0x800
    s_nop 0
    buffer_load_dwordx4 v50, s[4:7], s55 offen lds
    s_add_u32 m0, s61, 0xc00
    s_nop 0
    buffer_load_dwordx4 v51, s[4:7], s55 offen lds
    s_add_u32 m0, s62, 0
    s_nop 0
    buffer_load_dwordx4 v52, s[8:11], s56 offen lds
    s_add_u32 m0, s62, 0x1000
    s_nop 0
    buffer_load_dwordx4 v53, s[8:11], s56 offen lds
    s_add_u32 m0, s62, 0x2000
    s_nop 0
    buffer_load_dwordx4 v54, s[8:11], s56 offen lds
    s_add_u32 m0, s62, 0x3000
    s_nop 0
    buffer_load_dwordx4 v55, s[8:11], s56 offen lds
    s_add_u32 m0, s62, 0x4000
    s_nop 0
    buffer_load_dwordx4 v56, s[8:11], s56 offen lds
    s_mov_b32 m0, s24
    s_nop 0
    s_nop 0
    buffer_load_dwordx4 v57, s[8:11], s56 offen lds
    s_add_u32 s55, s55, 0x80
    s_add_u32 s56, s56, 0x3c000
    s_add_u32 s66, s66, 1
    s_cmp_eq_u32 s66, 10
    s_cselect_b32 s75, 0x500, 0
    s_cselect_b32 s58, 0x258000, 0
    s_sub_u32 s55, s55, s75
    s_sub_u32 s56, s56, s58
    s_waitcnt vmcnt(20)
    s_barrier
    s_add_u32 m0, s61, 0x9400
    s_nop 0
    buffer_load_dwordx4 v48, s[4:7], s55 offen lds
    s_add_u32 m0, s61, 0x9800
    s_nop 0
    buffer_load_dwordx4 v49, s[4:7], s55 offen lds
    s_add_u32 m0, s61, 0x9c00
    s_nop 0
    buffer_load_dwordx4 v50, s[4:7], s55 offen lds
    s_add_u32 m0, s61, 0xa000
    s_nop 0
    buffer_load_dwordx4 v51, s[4:7], s55 offen lds
    s_add_u32 m0, s62, 0x9400
    s_nop 0
    buffer_load_dwordx4 v52, s[8:11], s56 offen lds
    s_add_u32 m0, s62, 0xa400
    s_nop 0
    buffer_load_dwordx4 v53, s[8:11], s56 offen lds
    s_add_u32 m0, s62, 0xb400
    s_nop 0
    buffer_load_dwordx4 v54, s[8:11], s56 offen lds
    s_add_u32 m0, s62, 0xc400
    s_nop 0
    buffer_load_dwordx4 v55, s[8:11], s56 offen lds
    s_add_u32 m0, s62, 0xd400
    s_nop 0
    buffer_load_dwordx4 v56, s[8:11], s56 offen lds
    s_mov_b32 m0, s25
    s_nop 0
    s_nop 0
    buffer_load_dwordx4 v57, s[8:11], s56 offen lds
    s_add_u32 s55, s55, 0x80
    s_add_u32 s56, s56, 0x3c000
    s_add_u32 s66, s66, 1
    s_cmp_eq_u32 s66, 10
    s_cselect_b32 s75, 0x500, 0
    s_cselect_b32 s58, 0x258000, 0
    s_sub_u32 s55, s55, s75
    s_sub_u32 s56, s56, s58
    s_waitcnt vmcnt(20)
    s_barrier
    s_add_u32 m0, s61, 0x12800
    s_nop 0
    buffer_load_dwordx4 v48, s[4:7], s55 offen lds
    s_add_u32 m0, s61, 0x12c00
    s_nop 0
    buffer_load_dwordx4 v49, s[4:7], s55 offen lds
    s_add_u32 m0, s61, 0x13000
    s_nop 0
    buffer_load_dwordx4 v50, s[4:7], s55 offen lds
    s_add_u32 m0, s61, 0x13400
    s_nop 0
    buffer_load_dwordx4 v51, s[4:7], s55 offen lds
    s_add_u32 m0, s62, 0x12800
    s_nop 0
    buffer_load_dwordx4 v52, s[8:11], s56 offen lds
    s_add_u32 m0, s62, 0x13800
    s_nop 0
    buffer_load_dwordx4 v53, s[8:11], s56 offen lds
    s_add_u32 m0, s62, 0x14800
    s_nop 0
    buffer_load_dwordx4 v54, s[8:11], s56 offen lds
    s_add_u32 m0, s62, 0x15800
    s_nop 0
    buffer_load_dwordx4 v55, s[8:11], s56 offen lds
    s_add_u32 m0, s62, 0x16800
    s_nop 0
    buffer_load_dwordx4 v56, s[8:11], s56 offen lds
    s_mov_b32 m0, s26
    s_nop 0
    s_nop 0
    buffer_load_dwordx4 v57, s[8:11], s56 offen lds
    s_add_u32 s55, s55, 0x80
    s_add_u32 s56, s56, 0x3c000
    s_add_u32 s66, s66, 1
    s_cmp_eq_u32 s66, 10
    s_cselect_b32 s75, 0x500, 0
    s_cselect_b32 s58, 0x258000, 0
    s_sub_u32 s55, s55, s75
    s_sub_u32 s56, s56, s58
    s_waitcnt vmcnt(20)
    s_barrier
    s_add_u32 m0, s61, 0x1bc00
    s_nop 0
    buffer_load_dwordx4 v48, s[4:7], s55 offen lds
    s_add_u32 m0, s61, 0x1c000
    s_nop 0
    buffer_load_dwordx4 v49, s[4:7], s55 offen lds
    s_add_u32 m0, s61, 0x1c400
    s_nop 0
    buffer_load_dwordx4 v50, s[4:7], s55 offen lds
    s_add_u32 m0, s61, 0x1c800
    s_nop 0
    buffer_load_dwordx4 v51, s[4:7], s55 offen lds
    s_add_u32 m0, s62, 0x1bc00
    s_nop 0
    buffer_load_dwordx4 v52, s[8:11], s56 offen lds
    s_add_u32 m0, s62, 0x1cc00
    s_nop 0
    buffer_load_dwordx4 v53, s[8:11], s56 offen lds
    s_add_u32 m0, s62, 0x1dc00
    s_nop 0
    buffer_load_dwordx4 v54, s[8:11], s56 offen lds
    s_add_u32 m0, s62, 0x1ec00
    s_nop 0
    buffer_load_dwordx4 v55, s[8:11], s56 offen lds
    s_add_u32 m0, s62, 0x1fc00
    s_nop 0
    buffer_load_dwordx4 v56, s[8:11], s56 offen lds
    s_mov_b32 m0, s27
    s_nop 0
    s_nop 0
    buffer_load_dwordx4 v57, s[8:11], s56 offen lds
    s_add_u32 s55, s55, 0x80
    s_add_u32 s56, s56, 0x3c000
    s_add_u32 s66, s66, 1
    s_cmp_eq_u32 s66, 10
    s_cselect_b32 s75, 0x500, 0
    s_cselect_b32 s58, 0x258000, 0
    s_sub_u32 s55, s55, s75
    s_sub_u32 s56, s56, s58
    s_waitcnt vmcnt(20)
    s_barrier
    s_add_u32 m0, s61, 0
    s_nop 0
    buffer_load_dwordx4 v48, s[4:7], s55 offen lds
    s_add_u32 m0, s61, 0x400
    s_nop 0
    buffer_load_dwordx4 v49, s[4:7], s55 offen lds
    s_add_u32 m0, s61, 0x800
    s_nop 0
    buffer_load_dwordx4 v50, s[4:7], s55 offen lds
    s_add_u32 m0, s61, 0xc00
    s_nop 0
    buffer_load_dwordx4 v51, s[4:7], s55 offen lds
    s_add_u32 m0, s62, 0
    s_nop 0
    buffer_load_dwordx4 v52, s[8:11], s56 offen lds
    s_add_u32 m0, s62, 0x1000
    s_nop 0
    buffer_load_dwordx4 v53, s[8:11], s56 offen lds
    s_add_u32 m0, s62, 0x2000
    s_nop 0
    buffer_load_dwordx4 v54, s[8:11], s56 offen lds
    s_add_u32 m0, s62, 0x3000
    s_nop 0
    buffer_load_dwordx4 v55, s[8:11], s56 offen lds
    s_add_u32 m0, s62, 0x4000
    s_nop 0
    buffer_load_dwordx4 v56, s[8:11], s56 offen lds
    s_mov_b32 m0, s24
    s_nop 0
    s_nop 0
    buffer_load_dwordx4 v57, s[8:11], s56 offen lds
    s_add_u32 s55, s55, 0x80
    s_add_u32 s56, s56, 0x3c000
    s_add_u32 s66, s66, 1
    s_cmp_eq_u32 s66, 10
    s_cselect_b32 s75, 0x500, 0
    s_cselect_b32 s58, 0x258000, 0
    s_sub_u32 s55, s55, s75
    s_sub_u32 s56, s56, s58
    s_waitcnt vmcnt(20)
    s_barrier
    s_add_u32 m0, s61, 0x9400
    s_nop 0
    buffer_load_dwordx4 v48, s[4:7], s55 offen lds
    s_add_u32 m0, s61, 0x9800
    s_nop 0
    buffer_load_dwordx4 v49, s[4:7], s55 offen lds
    s_add_u32 m0, s61, 0x9c00
    s_nop 0
    buffer_load_dwordx4 v50, s[4:7], s55 offen lds
    s_add_u32 m0, s61, 0xa000
    s_nop 0
    buffer_load_dwordx4 v51, s[4:7], s55 offen lds
    s_add_u32 m0, s62, 0x9400
    s_nop 0
    buffer_load_dwordx4 v52, s[8:11], s56 offen lds
    s_add_u32 m0, s62, 0xa400
    s_nop 0
    buffer_load_dwordx4 v53, s[8:11], s56 offen lds
    s_add_u32 m0, s62, 0xb400
    s_nop 0
    buffer_load_dwordx4 v54, s[8:11], s56 offen lds
    s_add_u32 m0, s62, 0xc400
    s_nop 0
    buffer_load_dwordx4 v55, s[8:11], s56 offen lds
    s_add_u32 m0, s62, 0xd400
    s_nop 0
    buffer_load_dwordx4 v56, s[8:11], s56 offen lds
    s_mov_b32 m0, s25
    s_nop 0
    s_nop 0
    buffer_load_dwordx4 v57, s[8:11], s56 offen lds
    s_add_u32 s55, s55, 0x80
    s_add_u32 s56, s56, 0x3c000
    s_add_u32 s66, s66, 1
    s_cmp_eq_u32 s66, 10
    s_cselect_b32 s75, 0x500, 0
    s_cselect_b32 s58, 0x258000, 0
    s_sub_u32 s55, s55, s75
    s_sub_u32 s56, s56, s58
    s_waitcnt vmcnt(20)
    s_barrier
    s_lshl_b32 s76, s2, 2
    s_add_u32 s76, s76, s89
    s_mul_i32 s77, s76, 0x38f
    s_lshr_b32 s77, s77, 16
    s_mul_i32 s57, s77, 0x48
    s_sub_u32 s78, s76, s57
    s_mul_i32 s78, s78, 3
    s_mov_b32 s4, s44
    s_mov_b32 s5, s45
    s_nop 0
    s_mov_b32 s6, 0x21c000
    s_mov_b32 s7, 0x20000
    s_mul_i32 s57, s78, 0x2800
    s_lshl_b32 s58, s77, 7
    s_add_u32 s57, s57, s58
    s_cmp_ge_u32 s76, 0x2d0
    s_cselect_b32 s57, 0x7f000000, s57
    v_lshrrev_b32_e64 v64, 3, v1
    v_mul_u32_u24 v64, 0x500, v64
    v_and_b32_e64 v65, 7, v1
    v_lshl_add_u32 v64, v65, 4, v64
    s_add_u32 m0, s61, 0x12800
    s_nop 0
    s_nop 0
    buffer_load_dwordx4 v64, s[4:7], s57 offen lds
    s_add_u32 s57, s57, 0x2800
    s_add_u32 m0, s61, 0x12c00
    s_nop 0
    s_nop 0
    buffer_load_dwordx4 v64, s[4:7], s57 offen lds
    s_add_u32 s57, s57, 0x2800
    s_add_u32 m0, s61, 0x13000
    s_nop 0
    s_nop 0
    buffer_load_dwordx4 v64, s[4:7], s57 offen lds
    s_add_u32 s57, s57, 0x2800
    v_bfe_u32 v65, v1, 2, 2
    v_lshlrev_b32_e64 v65, 7, v65
    v_lshl_add_u32 v65, v2, 5, v65
    v_and_b32_e64 v167, 3, v1
    v_lshl_add_u32 v65, v167, 3, v65
    s_add_u32 s57, s61, 0x12800
    v_add_u32 v65, s57, v65
    s_lshl_b32 s57, s77, 6
    v_add_u32_e64 v167, s57, v1
    v_min_u32 v167, 0x27f, v167
    v_mul_u32_u24 v66, 0x334, v167
    v_lshrrev_b32_e64 v66, 16, v66
    v_mul_u32_u24 v169, 0x50, v66
    v_sub_u32 v169, v167, v169
    v_mul_u32_u24 v66, 5, v66
    v_lshrrev_b32 v170, 5, v169
    v_lshlrev_b32 v170, 1, v170
    v_bfe_u32 v172, v169, 2, 1
    v_add_u32_e64 v170, v170, v172
    v_bfe_u32 v172, v169, 3, 2
    v_lshlrev_b32 v172, 2, v172
    v_and_b32 v168, 3, v169
    v_add_u32 v168, v168, v172
    v_cmp_le_u32 vcc, 64, v169
    s_nop 1
    v_cndmask_b32 v170, v170, 4, vcc
    v_and_b32 v172, 15, v169
    v_cndmask_b32 v168, v168, v172, vcc
    v_add_u32 v66, v66, v170
    v_lshlrev_b32_e64 v66, 10, v66
    v_lshl_add_u32 v66, v168, 4, v66
    s_waitcnt vmcnt(13)
    s_barrier
    s_waitcnt vmcnt(3)
    s_barrier
    s_waitcnt vmcnt(0)
    s_nop 0
    ds_read_b64_tr_b16 v[72:73], v65
    ds_read_b64_tr_b16 v[74:75], v65 offset:512
    ds_read_b64_tr_b16 v[76:77], v65 offset:1024
    ds_read_b64_tr_b16 v[78:79], v65 offset:1536
    ds_read_b64_tr_b16 v[80:81], v65 offset:2048
    ds_read_b64_tr_b16 v[82:83], v65 offset:2560
    s_add_u32 s57, s78, 0
    s_lshr_b32 s58, s57, 2
    s_mul_i32 s58, s58, 0xa000
    s_and_b32 s57, s57, 3
    s_lshl_b32 s57, s57, 8
    s_add_u32 s58, s58, s57
    s_nop 0
    s_add_u32 s58, s58, 0x1200000
    s_cmp_ge_u32 s76, 0x2d0
    s_cselect_b32 s58, 0x7f000000, s58
    s_waitcnt lgkmcnt(4)
    buffer_store_dwordx4 v[72:75], v66, s[12:15], s58 offen sc1
    s_add_u32 s57, s78, 1
    s_lshr_b32 s58, s57, 2
    s_mul_i32 s58, s58, 0xa000
    s_and_b32 s57, s57, 3
    s_lshl_b32 s57, s57, 8
    s_add_u32 s58, s58, s57
    s_add_u32 s58, s58, 0x1200000
    s_cmp_ge_u32 s76, 0x2d0
    s_cselect_b32 s58, 0x7f000000, s58
    s_waitcnt lgkmcnt(2)
    buffer_store_dwordx4 v[76:79], v66, s[12:15], s58 offen sc1
    s_add_u32 s57, s78, 2
    s_lshr_b32 s58, s57, 2
    s_mul_i32 s58, s58, 0xa000
    s_and_b32 s57, s57, 3
    s_lshl_b32 s57, s57, 8
    s_add_u32 s58, s58, s57
    s_add_u32 s58, s58, 0x1200000
    s_cmp_ge_u32 s76, 0x2d0
    s_cselect_b32 s58, 0x7f000000, s58
    s_waitcnt lgkmcnt(0)
    buffer_store_dwordx4 v[80:83], v66, s[12:15], s58 offen sc1
    s_branch L_k1_fin
L_k1_comp:
    s_lshl_b32 s57, s64, 2
    s_add_u32 s57, s57, s52
    s_and_b32 s57, s57, 31
    s_lshl_b32 s57, s57, 10
    v_lshlrev_b32_e64 v164, 4, v1
    buffer_load_dwordx4 v[48:51], v164, s[20:23], s57 offen
    s_lshr_b32 s59, s52, 1
    s_and_b32 s60, s52, 1
    v_lshrrev_b32 v164, 1, v3
    v_xor_b32 v164, v164, v2
    v_lshlrev_b32_e64 v164, 4, v164
    v_lshl_add_u32 v164, v3, 7, v164
    v_xor_b32 v165, 64, v164
    s_lshl_b32 s57, s59, 13
    s_lshl_b32 s58, s60, 12
    s_add_u32 s75, s57, s58
    s_xor_b32 s58, s58, 0x1000
    s_add_u32 s57, s57, s58
    v_add_u32 v4, s75, v164
    v_add_u32 v5, s57, v164
    v_add_u32 v6, s75, v165
    v_add_u32_e64 v7, s57, v165
    v_bfe_u32 v164, v1, 2, 2
    v_lshlrev_b32_e64 v164, 1, v164
    v_lshl_add_u32 v164, v2, 3, v164
    v_mul_u32_u24 v164, 0x150, v164
    v_and_b32_e64 v165, 3, v1
    v_lshl_add_u32 v164, v165, 3, v164
    s_mul_i32 s57, s60, 0xa0
    s_add_u32 s57, s57, 0x4000
    v_add_u32 v10, s57, v164
    s_lshl_b32 s58, s59, 6
    v_add_u32 v8, s58, v10
    s_xor_b32 s58, s58, 64
    v_add_u32_e64 v9, s58, v10
    v_mov_b32 v28, 0x3f803f80
    v_mov_b32 v29, 0x3f803f80
    v_mov_b32 v30, 0x3f803f80
    v_mov_b32 v31, 0x3f803f80
    s_mov_b32 s68, 0x3acccccd
    v_mov_b32 v32, 0x358637bd
    v_mov_b32 v33, 0xb5c1a2a0
    v_mov_b32 v34, 0x3fb8aa3b
    v_mov_b32 v35, 0
    s_lshl_b32 s57, s59, 9
    s_lshl_b32 s58, s60, 8
    s_add_u32 s75, s57, s58
    s_xor_b32 s58, s58, 0x100
    s_add_u32 s57, s57, s58
    s_add_u32 s75, s75, 0x25000
    s_add_u32 s57, s57, 0x25000
    v_lshlrev_b32 v164, 3, v3
    v_add_u32 v21, s75, v164
    v_add_u32 v22, s57, v164
    s_lshl_b32 s57, s60, 8
    s_add_u32 s57, s57, 0x25400
    s_lshl_b32 s58, s59, 7
    s_add_u32 s75, s57, s58
    s_xor_b32 s58, s58, 0x80
    s_add_u32 s57, s57, s58
    v_lshlrev_b32 v164, 4, v2
    v_add_u32 v23, s75, v164
    v_add_u32 v24, s57, v164
    v_and_b32 v164, 3, v3
    v_lshrrev_b32_e64 v165, 2, v3
    v_cmp_eq_u32 s[76:77], 1, v164
    v_cmp_eq_u32 s[78:79], 2, v164
    v_cmp_eq_u32 s[80:81], 3, v164
    v_cmp_eq_u32 s[82:83], v165, v2
    v_cmp_gt_u32 s[84:85], 2, v2
    s_waitcnt lgkmcnt(0)
    s_mov_b32 s16, s48
    s_mov_b32 s17, s49
    s_mov_b32 s18, 0x100
    s_mov_b32 s19, 0x20000
    s_mov_b32 s12, s50
    s_mov_b32 s13, s51
    s_mov_b32 s14, 0x1800000
    s_mov_b32 s15, 0x20000
    v_mov_b32 v26, 1
    s_or_b32 s57, s63, s52
    s_cmp_lg_u32 s57, 0
    s_cbranch_scc1 L_k1_noat
    buffer_atomic_add v26, v25, s[16:19], s71 offen sc0
L_k1_noat:
    s_cmp_eq_u32 s63, 1
    s_cbranch_scc1 L_k1_setq
    s_nop 0
    v_mul_u32_u24 v164, 0xa8, v3
    s_mul_i32 s57, s59, 0x2a00
    s_mul_i32 s58, s60, 0x6900
    s_add_u32 s75, s57, s58
    s_mul_i32 s58, s60, 0x3f00
    s_add_u32 s57, s57, s58
    s_add_u32 s57, s57, 0x1500
    v_add_u32 v14, s75, v164
    v_add_u32 v15, s57, v164
    v_lshl_add_u32 v12, v2, 3, v14
    v_lshl_add_u32 v13, v2, 3, v15
    s_and_b32 s75, s52, 3
    s_nop 0
    s_mov_b32 s86, 0x1414130e
    s_mov_b32 s87, 0x9040904
    s_mov_b32 s88, 0x9040904
    s_cmp_eq_u32 s75, 0
    s_cselect_b32 s86, 0xd0c0b0a, s86
    s_cselect_b32 s87, 0x3020100, s87
    s_cmp_eq_u32 s75, 1
    s_cselect_b32 s86, 0x1211100f, s86
    s_cselect_b32 s87, 0x8070605, s87
    s_cmp_eq_u32 s75, 2
    s_cselect_b32 s87, 0x3020100, s87
    s_cselect_b32 s88, 0x8070605, s88
    v_and_b32 v164, 1, v2
    v_bfe_u32 v165, v1, 2, 2
    v_lshl_add_u32 v164, v164, 2, v165
    v_lshrrev_b32_e64 v165, 1, v2
    v_lshl_add_u32 v164, v164, 2, v165
    v_mul_u32_u24 v164, 0xa8, v164
    v_and_b32 v165, 3, v1
    v_lshlrev_b32 v165, 3, v165
    v_bfe_u32 v16, s86, v165, 8
    v_lshl_add_u32 v16, v16, 3, v164
    v_bfe_u32 v17, s87, v165, 8
    v_lshl_add_u32 v17, v17, 3, v164
    v_bfe_u32 v18, s88, v165, 8
    v_lshl_add_u32 v18, v18, 3, v164
    s_mul_i32 s67, s54, 0x1a40
    s_add_u32 s67, s67, 0x1500000
    s_cmp_eq_u32 s75, 3
    s_cselect_b32 s74, 0x7f000000, s67
    v_lshlrev_b32 v171, 3, v2
    v_bfe_u32 v171, s86, v171, 8
    v_subrev_u32 v171, 10, v171
    v_lshrrev_b32 v172, 2, v3
    v_lshlrev_b32_e64 v172, 3, v172
    v_bfe_u32 v173, s87, v172, 8
    v_cmp_le_u32 vcc, 5, v173
    s_nop 1
    v_cndmask_b32 v174, 0, 1, vcc
    v_mul_u32_u24 v175, 5, v174
    v_sub_u32 v173, v173, v175
    v_sub_u32 v175, v171, v175
    v_cmp_eq_u32 vcc, 10, v171
    s_nop 1
    v_cndmask_b32 v175, v175, 5, vcc
    v_cmp_eq_u32 s[92:93], 5, v171
    v_cmp_eq_u32 vcc, 0, v174
    s_nop 1
    s_and_b64 s[92:93], s[92:93], vcc
    v_cndmask_b32 v175, v175, 63, s[92:93]
    v_mul_u32_u24_e64 v19, 21, v174
    v_lshl_add_u32 v19, v175, 2, v19
    v_mul_u32_u24_e64 v19, 20, v19
    v_lshl_add_u32 v19, v173, 2, v19
    v_and_b32_e64 v176, 3, v3
    v_add_lshl_u32 v19, v19, v176, 2
    v_mov_b32 v176, 0x7f000000
    v_cmp_lt_u32 vcc, 5, v175
    s_nop 1
    v_cndmask_b32_e64 v19, v19, v176, vcc
    s_cmp_eq_u32 s87, 0x9040904
    s_cselect_b32 s57, 8, 16
    v_cmp_le_u32 vcc, s57, v3
    s_nop 1
    v_cndmask_b32 v19, v19, v176, vcc
    s_cmp_eq_u32 s86, 0x1414130e
    s_cselect_b32 s57, 3, 4
    v_cmp_le_u32 vcc, s57, v2
    s_nop 1
    v_cndmask_b32 v19, v19, v176, vcc
    v_bfe_u32 v173, s88, v172, 8
    v_cmp_le_u32 vcc, 5, v173
    s_nop 1
    v_cndmask_b32 v174, 0, 1, vcc
    v_mul_u32_u24 v175, 5, v174
    v_sub_u32 v173, v173, v175
    v_sub_u32 v175, v171, v175
    v_cmp_eq_u32 vcc, 10, v171
    s_nop 1
    v_cndmask_b32 v175, v175, 5, vcc
    v_cmp_eq_u32 s[92:93], 5, v171
    v_cmp_eq_u32 vcc, 0, v174
    s_nop 1
    s_and_b64 s[92:93], s[92:93], vcc
    v_cndmask_b32 v175, v175, 63, s[92:93]
    v_mul_u32_u24_e64 v20, 21, v174
    v_lshl_add_u32 v20, v175, 2, v20
    v_mul_u32_u24_e64 v20, 20, v20
    v_lshl_add_u32 v20, v173, 2, v20
    v_and_b32_e64 v176, 3, v3
    v_add_lshl_u32 v20, v20, v176, 2
    v_mov_b32 v176, 0x7f000000
    v_cmp_lt_u32 vcc, 5, v175
    s_nop 1
    v_cndmask_b32_e64 v20, v20, v176, vcc
    s_cmp_eq_u32 s88, 0x9040904
    s_cselect_b32 s57, 8, 16
    v_cmp_le_u32 vcc, s57, v3
    s_nop 1
    v_cndmask_b32 v20, v20, v176, vcc
    s_cmp_eq_u32 s86, 0x1414130e
    s_cselect_b32 s57, 3, 4
    v_cmp_le_u32 vcc, s57, v2
    s_nop 1
    v_cndmask_b32 v20, v20, v176, vcc
    s_cmp_eq_u32 s75, 3
    s_cselect_b32 s57, 0x7f000000, 0
    v_add_u32 v20, s57, v20
    v_cmp_gt_u32 vcc, 0xfa0, v19
    v_add_u32 v19, 0x25800, v19
    v_lshlrev_b32_e64 v164, 2, v1
    v_add_u32 v164, 0x24800, v164
    v_cndmask_b32 v19, v164, v19, vcc
    v_cmp_eq_u32 vcc, 10, v171
    s_nop 1
    v_cndmask_b32 v238, v19, v164, vcc
    v_cmp_gt_u32 vcc, 0xfa0, v20
    v_add_u32 v20, 0x25800, v20
    v_lshlrev_b32_e64 v164, 2, v1
    v_add_u32 v164, 0x24800, v164
    v_cndmask_b32 v20, v164, v20, vcc
    v_cmp_eq_u32 vcc, 10, v171
    s_nop 1
    v_cndmask_b32 v239, v20, v164, vcc
    s_mul_i32 s57, s52, 0x700
    v_lshlrev_b32 v36, 2, v1
    v_add_u32 v36, s57, v36
    v_add_u32 v37, 0x25800, v36
    s_branch L_k1_main
L_k1_setq:
    v_mov_b32 v36, 0
    v_mov_b32_e64 v37, 0
    s_mul_i32 s57, s54, 0xa0
    s_mul_i32 s58, s60, 0x50
    s_add_u32 s57, s57, s58
    v_lshlrev_b32 v164, 2, v2
    v_add_u32 v164, s57, v164
    s_lshl_b32 s58, s59, 5
    s_xor_b32 s58, s58, 0
    v_add_u32 v164, s58, v164
    v_lshrrev_b32 v165, 5, v164
    v_lshlrev_b32 v165, 17, v165
    v_bfe_u32 v166, v164, 3, 2
    v_lshl_add_u32 v166, v166, 4, v3
    v_lshl_add_u32 v165, v166, 4, v165
    v_bfe_u32 v166, v164, 2, 1
    v_lshl_add_u32 v16, v166, 3, v165
    v_lshlrev_b32 v164, 2, v2
    v_add_u32 v164, s57, v164
    s_lshl_b32 s58, s59, 5
    s_xor_b32 s58, s58, 16
    v_add_u32 v164, s58, v164
    v_lshrrev_b32 v165, 5, v164
    v_lshlrev_b32_e64 v165, 17, v165
    v_bfe_u32 v166, v164, 3, 2
    v_lshl_add_u32 v166, v166, 4, v3
    v_lshl_add_u32 v165, v166, 4, v165
    v_bfe_u32 v166, v164, 2, 1
    v_lshl_add_u32 v17, v166, 3, v165
    v_lshlrev_b32 v164, 2, v2
    v_add_u32 v164, s57, v164
    s_lshl_b32 s58, s59, 5
    s_xor_b32 s58, s58, 32
    v_add_u32 v164, s58, v164
    v_lshrrev_b32 v165, 5, v164
    v_lshlrev_b32_e64 v165, 17, v165
    v_bfe_u32 v166, v164, 3, 2
    v_lshl_add_u32 v166, v166, 4, v3
    v_lshl_add_u32 v165, v166, 4, v165
    v_bfe_u32 v166, v164, 2, 1
    v_lshl_add_u32 v18, v166, 3, v165
    v_lshlrev_b32 v164, 2, v2
    v_add_u32 v164, s57, v164
    s_lshl_b32 s58, s59, 5
    s_xor_b32 s58, s58, 48
    v_add_u32 v164, s58, v164
    v_lshrrev_b32 v165, 5, v164
    v_lshlrev_b32_e64 v165, 17, v165
    v_bfe_u32 v166, v164, 3, 2
    v_lshl_add_u32 v166, v166, 4, v3
    v_lshl_add_u32 v165, v166, 4, v165
    v_bfe_u32 v166, v164, 2, 1
    v_lshl_add_u32 v19, v166, 3, v165
    v_lshlrev_b32 v164, 2, v2
    v_add_u32 v164, s57, v164
    v_add_u32 v164, 64, v164
    v_lshrrev_b32 v165, 5, v164
    v_lshlrev_b32_e64 v165, 17, v165
    v_bfe_u32 v166, v164, 3, 2
    v_lshl_add_u32 v166, v166, 4, v3
    v_lshl_add_u32 v165, v166, 4, v165
    v_bfe_u32 v166, v164, 2, 1
    v_lshl_add_u32 v20, v166, 3, v165
    s_lshl_b32 s57, s53, 3
    s_lshl_b32 s58, s59, 2
    s_add_u32 s57, s57, s58
    s_lshl_b32 s58, s60, 1
    s_add_u32 s72, s57, s58
    s_lshl_b32 s72, s72, 10
    s_xor_b32 s73, s72, 0x800
    v_mov_b32 v12, 0
    v_mov_b32 v13, 0
    v_mov_b32 v14, 0
    v_mov_b32 v15, 0
L_k1_main:
    s_waitcnt vmcnt(0)
    v_readfirstlane_b32 s69, v26
    s_nop 1
    s_cmp_lg_u32 s69, 0
    s_cbranch_scc1 L_k1_noz
    v_mov_b32 v196, 0
    v_mov_b32 v197, 0
    v_mov_b32 v198, 0
    v_mov_b32 v199, 0
    v_lshlrev_b32 v200, 4, v1
    v_mov_b32 v202, 0x7f000000
    v_cmp_gt_u32 vcc, 36, v1
    s_nop 1
    v_cndmask_b32_e64 v201, v202, v200, vcc
    s_add_u32 s57, s67, 0x1000
    buffer_store_dwordx4 v[196:199], v200, s[12:15], s67 offen offset:0 sc0 sc1
    buffer_store_dwordx4 v[196:199], v200, s[12:15], s67 offen offset:1024 sc0 sc1
    buffer_store_dwordx4 v[196:199], v200, s[12:15], s67 offen offset:2048 sc0 sc1
    buffer_store_dwordx4 v[196:199], v200, s[12:15], s67 offen offset:3072 sc0 sc1
    buffer_store_dwordx4 v[196:199], v200, s[12:15], s57 offen offset:0 sc0 sc1
    buffer_store_dwordx4 v[196:199], v200, s[12:15], s57 offen offset:1024 sc0 sc1
    buffer_store_dwordx4 v[196:199], v201, s[12:15], s57 offen offset:2048 sc0 sc1
    s_nop 3
L_k1_noz:
    s_barrier
    ds_read_b128 v[164:167], v4
    ds_read_b64_tr_b16 v[196:197], v8
    ds_read_b64_tr_b16 v[198:199], v8 offset:336
    ds_read_b128 v[168:171], v4 offset:2048
    ds_read_b128 v[172:175], v5
    ds_read_b128 v[176:179], v5 offset:2048
    ds_read_b64_tr_b16 v[200:201], v8 offset:32
    ds_read_b64_tr_b16 v[202:203], v8 offset:368
    ds_read_b64_tr_b16 v[204:205], v9
    ds_read_b64_tr_b16 v[206:207], v9 offset:336
    ds_read_b64_tr_b16 v[208:209], v9 offset:32
    ds_read_b64_tr_b16 v[210:211], v9 offset:368
    ds_read_b64_tr_b16 v[212:213], v10 offset:128
    ds_read_b64_tr_b16 v[214:215], v10 offset:464
    s_waitcnt lgkmcnt(0)
    s_nop 0
    v_mfma_f32_16x16x32_bf16 v[48:51], v[196:199], v[164:167], 0
    ds_read_b128 v[180:183], v6
    ds_read_b64_tr_b16 v[216:217], v8 offset:10752
    v_mfma_f32_16x16x32_bf16 v[68:71], v[196:199], v[168:171], 0
    ds_read_b64_tr_b16 v[218:219], v8 offset:11088
    v_mfma_f32_16x16x32_bf16 v[88:91], v[196:199], v[172:175], 0
    ds_read_b128 v[184:187], v6 offset:2048
    v_mfma_f32_16x16x32_bf16 v[108:111], v[196:199], v[176:179], 0
    ds_read_b128 v[188:191], v7
    v_mfma_f32_16x16x32_bf16 v[128:131], v[196:199], v[28:31], 0
    ds_read_b128 v[192:195], v7 offset:2048
    v_mfma_f32_16x16x32_bf16 v[52:55], v[200:203], v[164:167], 0
    ds_read_b64_tr_b16 v[220:221], v8 offset:10784
    v_mfma_f32_16x16x32_bf16 v[72:75], v[200:203], v[168:171], 0
    ds_read_b64_tr_b16 v[222:223], v8 offset:11120
    v_mfma_f32_16x16x32_bf16 v[92:95], v[200:203], v[172:175], 0
    ds_read_b64_tr_b16 v[224:225], v9 offset:10752
    v_mfma_f32_16x16x32_bf16 v[112:115], v[200:203], v[176:179], 0
    ds_read_b64_tr_b16 v[226:227], v9 offset:11088
    v_mfma_f32_16x16x32_bf16 v[132:135], v[200:203], v[28:31], 0
    ds_read_b64_tr_b16 v[228:229], v9 offset:10784
    v_mfma_f32_16x16x32_bf16 v[148:151], v[28:31], v[164:167], 0
    ds_read_b64_tr_b16 v[230:231], v9 offset:11120
    v_mfma_f32_16x16x32_bf16 v[56:59], v[204:207], v[164:167], 0
    ds_read_b64_tr_b16 v[232:233], v10 offset:10880
    v_mfma_f32_16x16x32_bf16 v[76:79], v[204:207], v[168:171], 0
    ds_read_b64_tr_b16 v[234:235], v10 offset:11216
    v_mfma_f32_16x16x32_bf16 v[96:99], v[204:207], v[172:175], 0
    v_mfma_f32_16x16x32_bf16 v[116:119], v[204:207], v[176:179], 0
    v_mfma_f32_16x16x32_bf16 v[152:155], v[28:31], v[168:171], 0
    v_mfma_f32_16x16x32_bf16 v[60:63], v[208:211], v[164:167], 0
    v_mfma_f32_16x16x32_bf16 v[80:83], v[208:211], v[168:171], 0
    v_mfma_f32_16x16x32_bf16 v[100:103], v[208:211], v[172:175], 0
    v_mfma_f32_16x16x32_bf16 v[120:123], v[208:211], v[176:179], 0
    v_mfma_f32_16x16x32_bf16 v[156:159], v[164:167], v[164:167], 0
    v_mfma_f32_16x16x32_bf16 v[64:67], v[212:215], v[164:167], 0
    v_mfma_f32_16x16x32_bf16 v[84:87], v[212:215], v[168:171], 0
    v_mfma_f32_16x16x32_bf16 v[104:107], v[212:215], v[172:175], 0
    v_mfma_f32_16x16x32_bf16 v[124:127], v[212:215], v[176:179], 0
    v_mfma_f32_16x16x32_bf16 v[144:147], v[212:215], v[28:31], 0
    v_mfma_f32_16x16x32_bf16 v[160:163], v[168:171], v[168:171], 0
    s_waitcnt lgkmcnt(0)
    s_barrier
    v_mfma_f32_16x16x32_bf16 v[48:51], v[216:219], v[180:183], v[48:51]
    v_add_u32 v4, 0x9400, v4
    v_add_u32 v8, 0x9400, v8
    v_mfma_f32_16x16x32_bf16 v[68:71], v[216:219], v[184:187], v[68:71]
    v_add_u32 v5, 0x9400, v5
    v_mfma_f32_16x16x32_bf16 v[88:91], v[216:219], v[188:191], v[88:91]
    v_add_u32 v9, 0x9400, v9
    v_mfma_f32_16x16x32_bf16 v[108:111], v[216:219], v[192:195], v[108:111]
    v_add_u32 v10, 0x9400, v10
    v_mfma_f32_16x16x32_bf16 v[128:131], v[216:219], v[28:31], v[128:131]
    ds_read_b128 v[164:167], v4
    v_mfma_f32_16x16x32_bf16 v[52:55], v[220:223], v[180:183], v[52:55]
    ds_read_b64_tr_b16 v[196:197], v8
    v_mfma_f32_16x16x32_bf16 v[72:75], v[220:223], v[184:187], v[72:75]
    ds_read_b64_tr_b16 v[198:199], v8 offset:336
    v_mfma_f32_16x16x32_bf16 v[92:95], v[220:223], v[188:191], v[92:95]
    ds_read_b128 v[168:171], v4 offset:2048
    v_mfma_f32_16x16x32_bf16 v[112:115], v[220:223], v[192:195], v[112:115]
    ds_read_b128 v[172:175], v5
    v_mfma_f32_16x16x32_bf16 v[132:135], v[220:223], v[28:31], v[132:135]
    ds_read_b128 v[176:179], v5 offset:2048
    v_mfma_f32_16x16x32_bf16 v[148:151], v[28:31], v[180:183], v[148:151]
    ds_read_b64_tr_b16 v[200:201], v8 offset:32
    v_mfma_f32_16x16x32_bf16 v[56:59], v[224:227], v[180:183], v[56:59]
    ds_read_b64_tr_b16 v[202:203], v8 offset:368
    v_mfma_f32_16x16x32_bf16 v[76:79], v[224:227], v[184:187], v[76:79]
    ds_read_b64_tr_b16 v[204:205], v9
    v_mfma_f32_16x16x32_bf16 v[96:99], v[224:227], v[188:191], v[96:99]
    ds_read_b64_tr_b16 v[206:207], v9 offset:336
    v_mfma_f32_16x16x32_bf16 v[116:119], v[224:227], v[192:195], v[116:119]
    ds_read_b64_tr_b16 v[208:209], v9 offset:32
    v_mfma_f32_16x16x32_bf16 v[152:155], v[28:31], v[184:187], v[152:155]
    ds_read_b64_tr_b16 v[210:211], v9 offset:368
    v_mfma_f32_16x16x32_bf16 v[60:63], v[228:231], v[180:183], v[60:63]
    ds_read_b64_tr_b16 v[212:213], v10 offset:128
    v_mfma_f32_16x16x32_bf16 v[80:83], v[228:231], v[184:187], v[80:83]
    ds_read_b64_tr_b16 v[214:215], v10 offset:464
    v_mfma_f32_16x16x32_bf16 v[100:103], v[228:231], v[188:191], v[100:103]
    v_mfma_f32_16x16x32_bf16 v[120:123], v[228:231], v[192:195], v[120:123]
    v_mfma_f32_16x16x32_bf16 v[156:159], v[180:183], v[180:183], v[156:159]
    v_mfma_f32_16x16x32_bf16 v[64:67], v[232:235], v[180:183], v[64:67]
    v_mfma_f32_16x16x32_bf16 v[84:87], v[232:235], v[184:187], v[84:87]
    v_mfma_f32_16x16x32_bf16 v[104:107], v[232:235], v[188:191], v[104:107]
    v_mfma_f32_16x16x32_bf16 v[124:127], v[232:235], v[192:195], v[124:127]
    v_mfma_f32_16x16x32_bf16 v[144:147], v[232:235], v[28:31], v[144:147]
    v_mfma_f32_16x16x32_bf16 v[160:163], v[184:187], v[184:187], v[160:163]
    s_waitcnt lgkmcnt(0)
    s_nop 0
    v_mfma_f32_16x16x32_bf16 v[48:51], v[196:199], v[164:167], v[48:51]
    v_add_u32 v6, 0x9400, v6
    v_add_u32 v7, 0x9400, v7
    v_mfma_f32_16x16x32_bf16 v[68:71], v[196:199], v[168:171], v[68:71]
    ds_read_b128 v[180:183], v6
    v_mfma_f32_16x16x32_bf16 v[88:91], v[196:199], v[172:175], v[88:91]
    ds_read_b64_tr_b16 v[216:217], v8 offset:10752
    v_mfma_f32_16x16x32_bf16 v[108:111], v[196:199], v[176:179], v[108:111]
    ds_read_b64_tr_b16 v[218:219], v8 offset:11088
    v_mfma_f32_16x16x32_bf16 v[128:131], v[196:199], v[28:31], v[128:131]
    ds_read_b128 v[184:187], v6 offset:2048
    v_mfma_f32_16x16x32_bf16 v[52:55], v[200:203], v[164:167], v[52:55]
    ds_read_b128 v[188:191], v7
    v_mfma_f32_16x16x32_bf16 v[72:75], v[200:203], v[168:171], v[72:75]
    ds_read_b128 v[192:195], v7 offset:2048
    v_mfma_f32_16x16x32_bf16 v[92:95], v[200:203], v[172:175], v[92:95]
    ds_read_b64_tr_b16 v[220:221], v8 offset:10784
    v_mfma_f32_16x16x32_bf16 v[112:115], v[200:203], v[176:179], v[112:115]
    ds_read_b64_tr_b16 v[222:223], v8 offset:11120
    v_mfma_f32_16x16x32_bf16 v[132:135], v[200:203], v[28:31], v[132:135]
    ds_read_b64_tr_b16 v[224:225], v9 offset:10752
    v_mfma_f32_16x16x32_bf16 v[148:151], v[28:31], v[164:167], v[148:151]
    ds_read_b64_tr_b16 v[226:227], v9 offset:11088
    v_mfma_f32_16x16x32_bf16 v[56:59], v[204:207], v[164:167], v[56:59]
    ds_read_b64_tr_b16 v[228:229], v9 offset:10784
    v_mfma_f32_16x16x32_bf16 v[76:79], v[204:207], v[168:171], v[76:79]
    ds_read_b64_tr_b16 v[230:231], v9 offset:11120
    v_mfma_f32_16x16x32_bf16 v[96:99], v[204:207], v[172:175], v[96:99]
    ds_read_b64_tr_b16 v[232:233], v10 offset:10880
    v_mfma_f32_16x16x32_bf16 v[116:119], v[204:207], v[176:179], v[116:119]
    ds_read_b64_tr_b16 v[234:235], v10 offset:11216
    v_mfma_f32_16x16x32_bf16 v[152:155], v[28:31], v[168:171], v[152:155]
    v_mfma_f32_16x16x32_bf16 v[60:63], v[208:211], v[164:167], v[60:63]
    v_mfma_f32_16x16x32_bf16 v[80:83], v[208:211], v[168:171], v[80:83]
    v_mfma_f32_16x16x32_bf16 v[100:103], v[208:211], v[172:175], v[100:103]
    v_mfma_f32_16x16x32_bf16 v[120:123], v[208:211], v[176:179], v[120:123]
    v_mfma_f32_16x16x32_bf16 v[156:159], v[164:167], v[164:167], v[156:159]
    v_mfma_f32_16x16x32_bf16 v[64:67], v[212:215], v[164:167], v[64:67]
    v_mfma_f32_16x16x32_bf16 v[84:87], v[212:215], v[168:171], v[84:87]
    v_mfma_f32_16x16x32_bf16 v[104:107], v[212:215], v[172:175], v[104:107]
    v_mfma_f32_16x16x32_bf16 v[124:127], v[212:215], v[176:179], v[124:127]
    v_mfma_f32_16x16x32_bf16 v[144:147], v[212:215], v[28:31], v[144:147]
    v_mfma_f32_16x16x32_bf16 v[160:163], v[168:171], v[168:171], v[160:163]
    s_waitcnt lgkmcnt(0)
    s_barrier
    v_mfma_f32_16x16x32_bf16 v[48:51], v[216:219], v[180:183], v[48:51]
    v_add_u32 v4, 0x9400, v4
    v_add_u32 v8, 0x9400, v8
    v_mfma_f32_16x16x32_bf16 v[68:71], v[216:219], v[184:187], v[68:71]
    v_add_u32 v5, 0x9400, v5
    v_mfma_f32_16x16x32_bf16 v[88:91], v[216:219], v[188:191], v[88:91]
    v_add_u32 v9, 0x9400, v9
    v_mfma_f32_16x16x32_bf16 v[108:111], v[216:219], v[192:195], v[108:111]
    v_add_u32 v10, 0x9400, v10
    v_mfma_f32_16x16x32_bf16 v[128:131], v[216:219], v[28:31], v[128:131]
    ds_read_b128 v[164:167], v4
    v_mfma_f32_16x16x32_bf16 v[52:55], v[220:223], v[180:183], v[52:55]
    ds_read_b64_tr_b16 v[196:197], v8
    v_mfma_f32_16x16x32_bf16 v[72:75], v[220:223], v[184:187], v[72:75]
    ds_read_b64_tr_b16 v[198:199], v8 offset:336
    v_mfma_f32_16x16x32_bf16 v[92:95], v[220:223], v[188:191], v[92:95]
    ds_read_b128 v[168:171], v4 offset:2048
    v_mfma_f32_16x16x32_bf16 v[112:115], v[220:223], v[192:195], v[112:115]
    ds_read_b128 v[172:175], v5
    v_mfma_f32_16x16x32_bf16 v[132:135], v[220:223], v[28:31], v[132:135]
    ds_read_b128 v[176:179], v5 offset:2048
    v_mfma_f32_16x16x32_bf16 v[148:151], v[28:31], v[180:183], v[148:151]
    ds_read_b64_tr_b16 v[200:201], v8 offset:32
    v_mfma_f32_16x16x32_bf16 v[56:59], v[224:227], v[180:183], v[56:59]
    ds_read_b64_tr_b16 v[202:203], v8 offset:368
    v_mfma_f32_16x16x32_bf16 v[76:79], v[224:227], v[184:187], v[76:79]
    ds_read_b64_tr_b16 v[204:205], v9
    v_mfma_f32_16x16x32_bf16 v[96:99], v[224:227], v[188:191], v[96:99]
    ds_read_b64_tr_b16 v[206:207], v9 offset:336
    v_mfma_f32_16x16x32_bf16 v[116:119], v[224:227], v[192:195], v[116:119]
    ds_read_b64_tr_b16 v[208:209], v9 offset:32
    v_mfma_f32_16x16x32_bf16 v[152:155], v[28:31], v[184:187], v[152:155]
    ds_read_b64_tr_b16 v[210:211], v9 offset:368
    v_mfma_f32_16x16x32_bf16 v[60:63], v[228:231], v[180:183], v[60:63]
    ds_read_b64_tr_b16 v[212:213], v10 offset:128
    v_mfma_f32_16x16x32_bf16 v[80:83], v[228:231], v[184:187], v[80:83]
    ds_read_b64_tr_b16 v[214:215], v10 offset:464
    v_mfma_f32_16x16x32_bf16 v[100:103], v[228:231], v[188:191], v[100:103]
    v_mfma_f32_16x16x32_bf16 v[120:123], v[228:231], v[192:195], v[120:123]
    v_mfma_f32_16x16x32_bf16 v[156:159], v[180:183], v[180:183], v[156:159]
    v_mfma_f32_16x16x32_bf16 v[64:67], v[232:235], v[180:183], v[64:67]
    v_mfma_f32_16x16x32_bf16 v[84:87], v[232:235], v[184:187], v[84:87]
    v_mfma_f32_16x16x32_bf16 v[104:107], v[232:235], v[188:191], v[104:107]
    v_mfma_f32_16x16x32_bf16 v[124:127], v[232:235], v[192:195], v[124:127]
    v_mfma_f32_16x16x32_bf16 v[144:147], v[232:235], v[28:31], v[144:147]
    v_mfma_f32_16x16x32_bf16 v[160:163], v[184:187], v[184:187], v[160:163]
    s_waitcnt lgkmcnt(0)
    s_nop 0
    v_mfma_f32_16x16x32_bf16 v[48:51], v[196:199], v[164:167], v[48:51]
    v_add_u32 v6, 0x9400, v6
    v_add_u32 v7, 0x9400, v7
    v_mfma_f32_16x16x32_bf16 v[68:71], v[196:199], v[168:171], v[68:71]
    ds_read_b128 v[180:183], v6
    v_mfma_f32_16x16x32_bf16 v[88:91], v[196:199], v[172:175], v[88:91]
    ds_read_b64_tr_b16 v[216:217], v8 offset:10752
    v_mfma_f32_16x16x32_bf16 v[108:111], v[196:199], v[176:179], v[108:111]
    ds_read_b64_tr_b16 v[218:219], v8 offset:11088
    v_mfma_f32_16x16x32_bf16 v[128:131], v[196:199], v[28:31], v[128:131]
    ds_read_b128 v[184:187], v6 offset:2048
    v_mfma_f32_16x16x32_bf16 v[52:55], v[200:203], v[164:167], v[52:55]
    ds_read_b128 v[188:191], v7
    v_mfma_f32_16x16x32_bf16 v[72:75], v[200:203], v[168:171], v[72:75]
    ds_read_b128 v[192:195], v7 offset:2048
    v_mfma_f32_16x16x32_bf16 v[92:95], v[200:203], v[172:175], v[92:95]
    ds_read_b64_tr_b16 v[220:221], v8 offset:10784
    v_mfma_f32_16x16x32_bf16 v[112:115], v[200:203], v[176:179], v[112:115]
    ds_read_b64_tr_b16 v[222:223], v8 offset:11120
    v_mfma_f32_16x16x32_bf16 v[132:135], v[200:203], v[28:31], v[132:135]
    ds_read_b64_tr_b16 v[224:225], v9 offset:10752
    v_mfma_f32_16x16x32_bf16 v[148:151], v[28:31], v[164:167], v[148:151]
    ds_read_b64_tr_b16 v[226:227], v9 offset:11088
    v_mfma_f32_16x16x32_bf16 v[56:59], v[204:207], v[164:167], v[56:59]
    ds_read_b64_tr_b16 v[228:229], v9 offset:10784
    v_mfma_f32_16x16x32_bf16 v[76:79], v[204:207], v[168:171], v[76:79]
    ds_read_b64_tr_b16 v[230:231], v9 offset:11120
    v_mfma_f32_16x16x32_bf16 v[96:99], v[204:207], v[172:175], v[96:99]
    ds_read_b64_tr_b16 v[232:233], v10 offset:10880
    v_mfma_f32_16x16x32_bf16 v[116:119], v[204:207], v[176:179], v[116:119]
    ds_read_b64_tr_b16 v[234:235], v10 offset:11216
    v_mfma_f32_16x16x32_bf16 v[152:155], v[28:31], v[168:171], v[152:155]
    v_mfma_f32_16x16x32_bf16 v[60:63], v[208:211], v[164:167], v[60:63]
    v_mfma_f32_16x16x32_bf16 v[80:83], v[208:211], v[168:171], v[80:83]
    v_mfma_f32_16x16x32_bf16 v[100:103], v[208:211], v[172:175], v[100:103]
    v_mfma_f32_16x16x32_bf16 v[120:123], v[208:211], v[176:179], v[120:123]
    v_mfma_f32_16x16x32_bf16 v[156:159], v[164:167], v[164:167], v[156:159]
    v_mfma_f32_16x16x32_bf16 v[64:67], v[212:215], v[164:167], v[64:67]
    v_mfma_f32_16x16x32_bf16 v[84:87], v[212:215], v[168:171], v[84:87]
    v_mfma_f32_16x16x32_bf16 v[104:107], v[212:215], v[172:175], v[104:107]
    v_mfma_f32_16x16x32_bf16 v[124:127], v[212:215], v[176:179], v[124:127]
    v_mfma_f32_16x16x32_bf16 v[144:147], v[212:215], v[28:31], v[144:147]
    v_mfma_f32_16x16x32_bf16 v[160:163], v[168:171], v[168:171], v[160:163]
    s_waitcnt lgkmcnt(0)
    s_barrier
    v_mfma_f32_16x16x32_bf16 v[48:51], v[216:219], v[180:183], v[48:51]
    v_add_u32 v4, 0x9400, v4
    v_add_u32 v8, 0x9400, v8
    v_mfma_f32_16x16x32_bf16 v[68:71], v[216:219], v[184:187], v[68:71]
    v_add_u32 v5, 0x9400, v5
    v_mfma_f32_16x16x32_bf16 v[88:91], v[216:219], v[188:191], v[88:91]
    v_add_u32 v9, 0x9400, v9
    v_mfma_f32_16x16x32_bf16 v[108:111], v[216:219], v[192:195], v[108:111]
    v_add_u32 v10, 0x9400, v10
    v_mfma_f32_16x16x32_bf16 v[128:131], v[216:219], v[28:31], v[128:131]
    ds_read_b128 v[164:167], v4
    v_mfma_f32_16x16x32_bf16 v[52:55], v[220:223], v[180:183], v[52:55]
    ds_read_b64_tr_b16 v[196:197], v8
    v_mfma_f32_16x16x32_bf16 v[72:75], v[220:223], v[184:187], v[72:75]
    ds_read_b64_tr_b16 v[198:199], v8 offset:336
    v_mfma_f32_16x16x32_bf16 v[92:95], v[220:223], v[188:191], v[92:95]
    ds_read_b128 v[168:171], v4 offset:2048
    v_mfma_f32_16x16x32_bf16 v[112:115], v[220:223], v[192:195], v[112:115]
    ds_read_b128 v[172:175], v5
    v_mfma_f32_16x16x32_bf16 v[132:135], v[220:223], v[28:31], v[132:135]
    ds_read_b128 v[176:179], v5 offset:2048
    v_mfma_f32_16x16x32_bf16 v[148:151], v[28:31], v[180:183], v[148:151]
    ds_read_b64_tr_b16 v[200:201], v8 offset:32
    v_mfma_f32_16x16x32_bf16 v[56:59], v[224:227], v[180:183], v[56:59]
    ds_read_b64_tr_b16 v[202:203], v8 offset:368
    v_mfma_f32_16x16x32_bf16 v[76:79], v[224:227], v[184:187], v[76:79]
    ds_read_b64_tr_b16 v[204:205], v9
    v_mfma_f32_16x16x32_bf16 v[96:99], v[224:227], v[188:191], v[96:99]
    ds_read_b64_tr_b16 v[206:207], v9 offset:336
    v_mfma_f32_16x16x32_bf16 v[116:119], v[224:227], v[192:195], v[116:119]
    ds_read_b64_tr_b16 v[208:209], v9 offset:32
    v_mfma_f32_16x16x32_bf16 v[152:155], v[28:31], v[184:187], v[152:155]
    ds_read_b64_tr_b16 v[210:211], v9 offset:368
    v_mfma_f32_16x16x32_bf16 v[60:63], v[228:231], v[180:183], v[60:63]
    ds_read_b64_tr_b16 v[212:213], v10 offset:128
    v_mfma_f32_16x16x32_bf16 v[80:83], v[228:231], v[184:187], v[80:83]
    ds_read_b64_tr_b16 v[214:215], v10 offset:464
    v_mfma_f32_16x16x32_bf16 v[100:103], v[228:231], v[188:191], v[100:103]
    v_mfma_f32_16x16x32_bf16 v[120:123], v[228:231], v[192:195], v[120:123]
    v_mfma_f32_16x16x32_bf16 v[156:159], v[180:183], v[180:183], v[156:159]
    v_mfma_f32_16x16x32_bf16 v[64:67], v[232:235], v[180:183], v[64:67]
    v_mfma_f32_16x16x32_bf16 v[84:87], v[232:235], v[184:187], v[84:87]
    v_mfma_f32_16x16x32_bf16 v[104:107], v[232:235], v[188:191], v[104:107]
    v_mfma_f32_16x16x32_bf16 v[124:127], v[232:235], v[192:195], v[124:127]
    v_mfma_f32_16x16x32_bf16 v[144:147], v[232:235], v[28:31], v[144:147]
    v_mfma_f32_16x16x32_bf16 v[160:163], v[184:187], v[184:187], v[160:163]
    s_waitcnt lgkmcnt(0)
    s_nop 0
    v_mfma_f32_16x16x32_bf16 v[48:51], v[196:199], v[164:167], v[48:51]
    v_add_u32 v6, 0x9400, v6
    v_add_u32 v7, 0x9400, v7
    v_mfma_f32_16x16x32_bf16 v[68:71], v[196:199], v[168:171], v[68:71]
    ds_read_b128 v[180:183], v6
    v_mfma_f32_16x16x32_bf16 v[88:91], v[196:199], v[172:175], v[88:91]
    ds_read_b64_tr_b16 v[216:217], v8 offset:10752
    v_mfma_f32_16x16x32_bf16 v[108:111], v[196:199], v[176:179], v[108:111]
    ds_read_b64_tr_b16 v[218:219], v8 offset:11088
    v_mfma_f32_16x16x32_bf16 v[128:131], v[196:199], v[28:31], v[128:131]
    ds_read_b128 v[184:187], v6 offset:2048
    v_mfma_f32_16x16x32_bf16 v[52:55], v[200:203], v[164:167], v[52:55]
    ds_read_b128 v[188:191], v7
    v_mfma_f32_16x16x32_bf16 v[72:75], v[200:203], v[168:171], v[72:75]
    ds_read_b128 v[192:195], v7 offset:2048
    v_mfma_f32_16x16x32_bf16 v[92:95], v[200:203], v[172:175], v[92:95]
    ds_read_b64_tr_b16 v[220:221], v8 offset:10784
    v_mfma_f32_16x16x32_bf16 v[112:115], v[200:203], v[176:179], v[112:115]
    ds_read_b64_tr_b16 v[222:223], v8 offset:11120
    v_mfma_f32_16x16x32_bf16 v[132:135], v[200:203], v[28:31], v[132:135]
    ds_read_b64_tr_b16 v[224:225], v9 offset:10752
    v_mfma_f32_16x16x32_bf16 v[148:151], v[28:31], v[164:167], v[148:151]
    ds_read_b64_tr_b16 v[226:227], v9 offset:11088
    v_mfma_f32_16x16x32_bf16 v[56:59], v[204:207], v[164:167], v[56:59]
    ds_read_b64_tr_b16 v[228:229], v9 offset:10784
    v_mfma_f32_16x16x32_bf16 v[76:79], v[204:207], v[168:171], v[76:79]
    ds_read_b64_tr_b16 v[230:231], v9 offset:11120
    v_mfma_f32_16x16x32_bf16 v[96:99], v[204:207], v[172:175], v[96:99]
    ds_read_b64_tr_b16 v[232:233], v10 offset:10880
    v_mfma_f32_16x16x32_bf16 v[116:119], v[204:207], v[176:179], v[116:119]
    ds_read_b64_tr_b16 v[234:235], v10 offset:11216
    v_mfma_f32_16x16x32_bf16 v[152:155], v[28:31], v[168:171], v[152:155]
    v_mfma_f32_16x16x32_bf16 v[60:63], v[208:211], v[164:167], v[60:63]
    v_mfma_f32_16x16x32_bf16 v[80:83], v[208:211], v[168:171], v[80:83]
    v_mfma_f32_16x16x32_bf16 v[100:103], v[208:211], v[172:175], v[100:103]
    v_mfma_f32_16x16x32_bf16 v[120:123], v[208:211], v[176:179], v[120:123]
    v_mfma_f32_16x16x32_bf16 v[156:159], v[164:167], v[164:167], v[156:159]
    v_mfma_f32_16x16x32_bf16 v[64:67], v[212:215], v[164:167], v[64:67]
    v_mfma_f32_16x16x32_bf16 v[84:87], v[212:215], v[168:171], v[84:87]
    v_mfma_f32_16x16x32_bf16 v[104:107], v[212:215], v[172:175], v[104:107]
    v_mfma_f32_16x16x32_bf16 v[124:127], v[212:215], v[176:179], v[124:127]
    v_mfma_f32_16x16x32_bf16 v[144:147], v[212:215], v[28:31], v[144:147]
    v_mfma_f32_16x16x32_bf16 v[160:163], v[168:171], v[168:171], v[160:163]
    s_waitcnt lgkmcnt(0)
    s_barrier
    v_mfma_f32_16x16x32_bf16 v[48:51], v[216:219], v[180:183], v[48:51]
    v_add_u32 v4, 0xfffe4400, v4
    v_add_u32 v8, 0xfffe4400, v8
    v_mfma_f32_16x16x32_bf16 v[68:71], v[216:219], v[184:187], v[68:71]
    v_add_u32 v5, 0xfffe4400, v5
    v_mfma_f32_16x16x32_bf16 v[88:91], v[216:219], v[188:191], v[88:91]
    v_add_u32 v9, 0xfffe4400, v9
    v_mfma_f32_16x16x32_bf16 v[108:111], v[216:219], v[192:195], v[108:111]
    v_add_u32 v10, 0xfffe4400, v10
    v_mfma_f32_16x16x32_bf16 v[128:131], v[216:219], v[28:31], v[128:131]
    ds_read_b128 v[164:167], v4
    v_mfma_f32_16x16x32_bf16 v[52:55], v[220:223], v[180:183], v[52:55]
    ds_read_b64_tr_b16 v[196:197], v8
    v_mfma_f32_16x16x32_bf16 v[72:75], v[220:223], v[184:187], v[72:75]
    ds_read_b64_tr_b16 v[198:199], v8 offset:336
    v_mfma_f32_16x16x32_bf16 v[92:95], v[220:223], v[188:191], v[92:95]
    ds_read_b128 v[168:171], v4 offset:2048
    v_mfma_f32_16x16x32_bf16 v[112:115], v[220:223], v[192:195], v[112:115]
    ds_read_b128 v[172:175], v5
    v_mfma_f32_16x16x32_bf16 v[132:135], v[220:223], v[28:31], v[132:135]
    ds_read_b128 v[176:179], v5 offset:2048
    v_mfma_f32_16x16x32_bf16 v[148:151], v[28:31], v[180:183], v[148:151]
    ds_read_b64_tr_b16 v[200:201], v8 offset:32
    v_mfma_f32_16x16x32_bf16 v[56:59], v[224:227], v[180:183], v[56:59]
    ds_read_b64_tr_b16 v[202:203], v8 offset:368
    v_mfma_f32_16x16x32_bf16 v[76:79], v[224:227], v[184:187], v[76:79]
    ds_read_b64_tr_b16 v[204:205], v9
    v_mfma_f32_16x16x32_bf16 v[96:99], v[224:227], v[188:191], v[96:99]
    ds_read_b64_tr_b16 v[206:207], v9 offset:336
    v_mfma_f32_16x16x32_bf16 v[116:119], v[224:227], v[192:195], v[116:119]
    ds_read_b64_tr_b16 v[208:209], v9 offset:32
    v_mfma_f32_16x16x32_bf16 v[152:155], v[28:31], v[184:187], v[152:155]
    ds_read_b64_tr_b16 v[210:211], v9 offset:368
    v_mfma_f32_16x16x32_bf16 v[60:63], v[228:231], v[180:183], v[60:63]
    ds_read_b64_tr_b16 v[212:213], v10 offset:128
    v_mfma_f32_16x16x32_bf16 v[80:83], v[228:231], v[184:187], v[80:83]
    ds_read_b64_tr_b16 v[214:215], v10 offset:464
    v_mfma_f32_16x16x32_bf16 v[100:103], v[228:231], v[188:191], v[100:103]
    v_mfma_f32_16x16x32_bf16 v[120:123], v[228:231], v[192:195], v[120:123]
    v_mfma_f32_16x16x32_bf16 v[156:159], v[180:183], v[180:183], v[156:159]
    v_mfma_f32_16x16x32_bf16 v[64:67], v[232:235], v[180:183], v[64:67]
    v_mfma_f32_16x16x32_bf16 v[84:87], v[232:235], v[184:187], v[84:87]
    v_mfma_f32_16x16x32_bf16 v[104:107], v[232:235], v[188:191], v[104:107]
    v_mfma_f32_16x16x32_bf16 v[124:127], v[232:235], v[192:195], v[124:127]
    v_mfma_f32_16x16x32_bf16 v[144:147], v[232:235], v[28:31], v[144:147]
    v_mfma_f32_16x16x32_bf16 v[160:163], v[184:187], v[184:187], v[160:163]
    s_waitcnt lgkmcnt(0)
    s_cmp_lg_u32 s69, 0
    s_cbranch_scc1 L_k1_nof
    s_waitcnt vmcnt(0)
    v_mov_b32_e64 v26, 1
    buffer_store_dword v26, v25, s[16:19], s70 offen sc0 sc1
L_k1_nof:
    v_mfma_f32_16x16x32_bf16 v[48:51], v[196:199], v[164:167], v[48:51]
    v_add_u32 v6, 0xfffe4400, v6
    v_add_u32 v7, 0xfffe4400, v7
    v_mfma_f32_16x16x32_bf16 v[68:71], v[196:199], v[168:171], v[68:71]
    ds_read_b128 v[180:183], v6
    v_mfma_f32_16x16x32_bf16 v[88:91], v[196:199], v[172:175], v[88:91]
    ds_read_b64_tr_b16 v[216:217], v8 offset:10752
    v_mfma_f32_16x16x32_bf16 v[108:111], v[196:199], v[176:179], v[108:111]
    ds_read_b64_tr_b16 v[218:219], v8 offset:11088
    v_mfma_f32_16x16x32_bf16 v[128:131], v[196:199], v[28:31], v[128:131]
    ds_read_b128 v[184:187], v6 offset:2048
    v_mfma_f32_16x16x32_bf16 v[52:55], v[200:203], v[164:167], v[52:55]
    ds_read_b128 v[188:191], v7
    v_mfma_f32_16x16x32_bf16 v[72:75], v[200:203], v[168:171], v[72:75]
    ds_read_b128 v[192:195], v7 offset:2048
    v_mfma_f32_16x16x32_bf16 v[92:95], v[200:203], v[172:175], v[92:95]
    ds_read_b64_tr_b16 v[220:221], v8 offset:10784
    v_mfma_f32_16x16x32_bf16 v[112:115], v[200:203], v[176:179], v[112:115]
    ds_read_b64_tr_b16 v[222:223], v8 offset:11120
    v_mfma_f32_16x16x32_bf16 v[132:135], v[200:203], v[28:31], v[132:135]
    ds_read_b64_tr_b16 v[224:225], v9 offset:10752
    v_mfma_f32_16x16x32_bf16 v[148:151], v[28:31], v[164:167], v[148:151]
    ds_read_b64_tr_b16 v[226:227], v9 offset:11088
    v_mfma_f32_16x16x32_bf16 v[56:59], v[204:207], v[164:167], v[56:59]
    ds_read_b64_tr_b16 v[228:229], v9 offset:10784
    v_mfma_f32_16x16x32_bf16 v[76:79], v[204:207], v[168:171], v[76:79]
    ds_read_b64_tr_b16 v[230:231], v9 offset:11120
    v_mfma_f32_16x16x32_bf16 v[96:99], v[204:207], v[172:175], v[96:99]
    ds_read_b64_tr_b16 v[232:233], v10 offset:10880
    v_mfma_f32_16x16x32_bf16 v[116:119], v[204:207], v[176:179], v[116:119]
    ds_read_b64_tr_b16 v[234:235], v10 offset:11216
    v_mfma_f32_16x16x32_bf16 v[152:155], v[28:31], v[168:171], v[152:155]
    v_mfma_f32_16x16x32_bf16 v[60:63], v[208:211], v[164:167], v[60:63]
    v_mfma_f32_16x16x32_bf16 v[80:83], v[208:211], v[168:171], v[80:83]
    v_mfma_f32_16x16x32_bf16 v[100:103], v[208:211], v[172:175], v[100:103]
    v_mfma_f32_16x16x32_bf16 v[120:123], v[208:211], v[176:179], v[120:123]
    v_mfma_f32_16x16x32_bf16 v[156:159], v[164:167], v[164:167], v[156:159]
    v_mfma_f32_16x16x32_bf16 v[64:67], v[212:215], v[164:167], v[64:67]
    v_mfma_f32_16x16x32_bf16 v[84:87], v[212:215], v[168:171], v[84:87]
    v_mfma_f32_16x16x32_bf16 v[104:107], v[212:215], v[172:175], v[104:107]
    v_mfma_f32_16x16x32_bf16 v[124:127], v[212:215], v[176:179], v[124:127]
    v_mfma_f32_16x16x32_bf16 v[144:147], v[212:215], v[28:31], v[144:147]
    v_mfma_f32_16x16x32_bf16 v[160:163], v[168:171], v[168:171], v[160:163]
    s_waitcnt lgkmcnt(0)
    s_barrier
    v_mfma_f32_16x16x32_bf16 v[48:51], v[216:219], v[180:183], v[48:51]
    v_add_u32 v4, 0x9400, v4
    v_add_u32 v8, 0x9400, v8
    v_mfma_f32_16x16x32_bf16 v[68:71], v[216:219], v[184:187], v[68:71]
    v_add_u32 v5, 0x9400, v5
    v_mfma_f32_16x16x32_bf16 v[88:91], v[216:219], v[188:191], v[88:91]
    v_add_u32 v9, 0x9400, v9
    v_mfma_f32_16x16x32_bf16 v[108:111], v[216:219], v[192:195], v[108:111]
    v_add_u32 v10, 0x9400, v10
    v_mfma_f32_16x16x32_bf16 v[128:131], v[216:219], v[28:31], v[128:131]
    ds_read_b128 v[164:167], v4
    v_mfma_f32_16x16x32_bf16 v[52:55], v[220:223], v[180:183], v[52:55]
    ds_read_b64_tr_b16 v[196:197], v8
    v_mfma_f32_16x16x32_bf16 v[72:75], v[220:223], v[184:187], v[72:75]
    ds_read_b64_tr_b16 v[198:199], v8 offset:336
    v_mfma_f32_16x16x32_bf16 v[92:95], v[220:223], v[188:191], v[92:95]
    ds_read_b128 v[168:171], v4 offset:2048
    v_mfma_f32_16x16x32_bf16 v[112:115], v[220:223], v[192:195], v[112:115]
    ds_read_b128 v[172:175], v5
    v_mfma_f32_16x16x32_bf16 v[132:135], v[220:223], v[28:31], v[132:135]
    ds_read_b128 v[176:179], v5 offset:2048
    v_mfma_f32_16x16x32_bf16 v[148:151], v[28:31], v[180:183], v[148:151]
    ds_read_b64_tr_b16 v[200:201], v8 offset:32
    v_mfma_f32_16x16x32_bf16 v[56:59], v[224:227], v[180:183], v[56:59]
    ds_read_b64_tr_b16 v[202:203], v8 offset:368
    v_mfma_f32_16x16x32_bf16 v[76:79], v[224:227], v[184:187], v[76:79]
    ds_read_b64_tr_b16 v[204:205], v9
    v_mfma_f32_16x16x32_bf16 v[96:99], v[224:227], v[188:191], v[96:99]
    ds_read_b64_tr_b16 v[206:207], v9 offset:336
    v_mfma_f32_16x16x32_bf16 v[116:119], v[224:227], v[192:195], v[116:119]
    ds_read_b64_tr_b16 v[208:209], v9 offset:32
    v_mfma_f32_16x16x32_bf16 v[152:155], v[28:31], v[184:187], v[152:155]
    ds_read_b64_tr_b16 v[210:211], v9 offset:368
    v_mfma_f32_16x16x32_bf16 v[60:63], v[228:231], v[180:183], v[60:63]
    ds_read_b64_tr_b16 v[212:213], v10 offset:128
    v_mfma_f32_16x16x32_bf16 v[80:83], v[228:231], v[184:187], v[80:83]
    ds_read_b64_tr_b16 v[214:215], v10 offset:464
    v_mfma_f32_16x16x32_bf16 v[100:103], v[228:231], v[188:191], v[100:103]
    v_mfma_f32_16x16x32_bf16 v[120:123], v[228:231], v[192:195], v[120:123]
    v_mfma_f32_16x16x32_bf16 v[156:159], v[180:183], v[180:183], v[156:159]
    v_mfma_f32_16x16x32_bf16 v[64:67], v[232:235], v[180:183], v[64:67]
    v_mfma_f32_16x16x32_bf16 v[84:87], v[232:235], v[184:187], v[84:87]
    v_mfma_f32_16x16x32_bf16 v[104:107], v[232:235], v[188:191], v[104:107]
    v_mfma_f32_16x16x32_bf16 v[124:127], v[232:235], v[192:195], v[124:127]
    v_mfma_f32_16x16x32_bf16 v[144:147], v[232:235], v[28:31], v[144:147]
    v_mfma_f32_16x16x32_bf16 v[160:163], v[184:187], v[184:187], v[160:163]
    s_waitcnt lgkmcnt(0)
    s_nop 0
    v_mfma_f32_16x16x32_bf16 v[48:51], v[196:199], v[164:167], v[48:51]
    v_add_u32 v6, 0x9400, v6
    v_add_u32 v7, 0x9400, v7
    v_mfma_f32_16x16x32_bf16 v[68:71], v[196:199], v[168:171], v[68:71]
    ds_read_b128 v[180:183], v6
    v_mfma_f32_16x16x32_bf16 v[88:91], v[196:199], v[172:175], v[88:91]
    ds_read_b64_tr_b16 v[216:217], v8 offset:10752
    v_mfma_f32_16x16x32_bf16 v[108:111], v[196:199], v[176:179], v[108:111]
    ds_read_b64_tr_b16 v[218:219], v8 offset:11088
    v_mfma_f32_16x16x32_bf16 v[128:131], v[196:199], v[28:31], v[128:131]
    ds_read_b128 v[184:187], v6 offset:2048
    v_mfma_f32_16x16x32_bf16 v[52:55], v[200:203], v[164:167], v[52:55]
    ds_read_b128 v[188:191], v7
    v_mfma_f32_16x16x32_bf16 v[72:75], v[200:203], v[168:171], v[72:75]
    ds_read_b128 v[192:195], v7 offset:2048
    v_mfma_f32_16x16x32_bf16 v[92:95], v[200:203], v[172:175], v[92:95]
    ds_read_b64_tr_b16 v[220:221], v8 offset:10784
    v_mfma_f32_16x16x32_bf16 v[112:115], v[200:203], v[176:179], v[112:115]
    ds_read_b64_tr_b16 v[222:223], v8 offset:11120
    v_mfma_f32_16x16x32_bf16 v[132:135], v[200:203], v[28:31], v[132:135]
    ds_read_b64_tr_b16 v[224:225], v9 offset:10752
    v_mfma_f32_16x16x32_bf16 v[148:151], v[28:31], v[164:167], v[148:151]
    ds_read_b64_tr_b16 v[226:227], v9 offset:11088
    v_mfma_f32_16x16x32_bf16 v[56:59], v[204:207], v[164:167], v[56:59]
    ds_read_b64_tr_b16 v[228:229], v9 offset:10784
    v_mfma_f32_16x16x32_bf16 v[76:79], v[204:207], v[168:171], v[76:79]
    ds_read_b64_tr_b16 v[230:231], v9 offset:11120
    v_mfma_f32_16x16x32_bf16 v[96:99], v[204:207], v[172:175], v[96:99]
    ds_read_b64_tr_b16 v[232:233], v10 offset:10880
    v_mfma_f32_16x16x32_bf16 v[116:119], v[204:207], v[176:179], v[116:119]
    ds_read_b64_tr_b16 v[234:235], v10 offset:11216
    v_mfma_f32_16x16x32_bf16 v[152:155], v[28:31], v[168:171], v[152:155]
    v_mfma_f32_16x16x32_bf16 v[60:63], v[208:211], v[164:167], v[60:63]
    v_mfma_f32_16x16x32_bf16 v[80:83], v[208:211], v[168:171], v[80:83]
    v_mfma_f32_16x16x32_bf16 v[100:103], v[208:211], v[172:175], v[100:103]
    v_mfma_f32_16x16x32_bf16 v[120:123], v[208:211], v[176:179], v[120:123]
    v_mfma_f32_16x16x32_bf16 v[156:159], v[164:167], v[164:167], v[156:159]
    v_mfma_f32_16x16x32_bf16 v[64:67], v[212:215], v[164:167], v[64:67]
    v_mfma_f32_16x16x32_bf16 v[84:87], v[212:215], v[168:171], v[84:87]
    v_mfma_f32_16x16x32_bf16 v[104:107], v[212:215], v[172:175], v[104:107]
    v_mfma_f32_16x16x32_bf16 v[124:127], v[212:215], v[176:179], v[124:127]
    v_mfma_f32_16x16x32_bf16 v[144:147], v[212:215], v[28:31], v[144:147]
    v_mfma_f32_16x16x32_bf16 v[160:163], v[168:171], v[168:171], v[160:163]
    s_waitcnt lgkmcnt(0)
    s_barrier
    v_mfma_f32_16x16x32_bf16 v[48:51], v[216:219], v[180:183], v[48:51]
    v_add_u32 v4, 0x9400, v4
    v_add_u32 v8, 0x9400, v8
    v_mfma_f32_16x16x32_bf16 v[68:71], v[216:219], v[184:187], v[68:71]
    v_add_u32 v5, 0x9400, v5
    v_mfma_f32_16x16x32_bf16 v[88:91], v[216:219], v[188:191], v[88:91]
    v_add_u32 v9, 0x9400, v9
    v_mfma_f32_16x16x32_bf16 v[108:111], v[216:219], v[192:195], v[108:111]
    v_add_u32 v10, 0x9400, v10
    v_mfma_f32_16x16x32_bf16 v[128:131], v[216:219], v[28:31], v[128:131]
    ds_read_b128 v[164:167], v4
    v_mfma_f32_16x16x32_bf16 v[52:55], v[220:223], v[180:183], v[52:55]
    ds_read_b64_tr_b16 v[196:197], v8
    v_mfma_f32_16x16x32_bf16 v[72:75], v[220:223], v[184:187], v[72:75]
    ds_read_b64_tr_b16 v[198:199], v8 offset:336
    v_mfma_f32_16x16x32_bf16 v[92:95], v[220:223], v[188:191], v[92:95]
    ds_read_b128 v[168:171], v4 offset:2048
    v_mfma_f32_16x16x32_bf16 v[112:115], v[220:223], v[192:195], v[112:115]
    ds_read_b128 v[172:175], v5
    v_mfma_f32_16x16x32_bf16 v[132:135], v[220:223], v[28:31], v[132:135]
    ds_read_b128 v[176:179], v5 offset:2048
    v_mfma_f32_16x16x32_bf16 v[148:151], v[28:31], v[180:183], v[148:151]
    ds_read_b64_tr_b16 v[200:201], v8 offset:32
    v_mfma_f32_16x16x32_bf16 v[56:59], v[224:227], v[180:183], v[56:59]
    ds_read_b64_tr_b16 v[202:203], v8 offset:368
    v_mfma_f32_16x16x32_bf16 v[76:79], v[224:227], v[184:187], v[76:79]
    ds_read_b64_tr_b16 v[204:205], v9
    v_mfma_f32_16x16x32_bf16 v[96:99], v[224:227], v[188:191], v[96:99]
    ds_read_b64_tr_b16 v[206:207], v9 offset:336
    v_mfma_f32_16x16x32_bf16 v[116:119], v[224:227], v[192:195], v[116:119]
    ds_read_b64_tr_b16 v[208:209], v9 offset:32
    v_mfma_f32_16x16x32_bf16 v[152:155], v[28:31], v[184:187], v[152:155]
    ds_read_b64_tr_b16 v[210:211], v9 offset:368
    v_mfma_f32_16x16x32_bf16 v[60:63], v[228:231], v[180:183], v[60:63]
    ds_read_b64_tr_b16 v[212:213], v10 offset:128
    v_mfma_f32_16x16x32_bf16 v[80:83], v[228:231], v[184:187], v[80:83]
    ds_read_b64_tr_b16 v[214:215], v10 offset:464
    v_mfma_f32_16x16x32_bf16 v[100:103], v[228:231], v[188:191], v[100:103]
    v_mfma_f32_16x16x32_bf16 v[120:123], v[228:231], v[192:195], v[120:123]
    v_mfma_f32_16x16x32_bf16 v[156:159], v[180:183], v[180:183], v[156:159]
    v_mfma_f32_16x16x32_bf16 v[64:67], v[232:235], v[180:183], v[64:67]
    v_mfma_f32_16x16x32_bf16 v[84:87], v[232:235], v[184:187], v[84:87]
    v_mfma_f32_16x16x32_bf16 v[104:107], v[232:235], v[188:191], v[104:107]
    v_mfma_f32_16x16x32_bf16 v[124:127], v[232:235], v[192:195], v[124:127]
    v_mfma_f32_16x16x32_bf16 v[144:147], v[232:235], v[28:31], v[144:147]
    v_mfma_f32_16x16x32_bf16 v[160:163], v[184:187], v[184:187], v[160:163]
    s_waitcnt lgkmcnt(0)
    s_nop 0
    v_mfma_f32_16x16x32_bf16 v[48:51], v[196:199], v[164:167], v[48:51]
    v_add_u32 v6, 0x9400, v6
    v_add_u32 v7, 0x9400, v7
    v_mfma_f32_16x16x32_bf16 v[68:71], v[196:199], v[168:171], v[68:71]
    ds_read_b128 v[180:183], v6
    v_mfma_f32_16x16x32_bf16 v[88:91], v[196:199], v[172:175], v[88:91]
    ds_read_b64_tr_b16 v[216:217], v8 offset:10752
    v_mfma_f32_16x16x32_bf16 v[108:111], v[196:199], v[176:179], v[108:111]
    ds_read_b64_tr_b16 v[218:219], v8 offset:11088
    v_mfma_f32_16x16x32_bf16 v[128:131], v[196:199], v[28:31], v[128:131]
    ds_read_b128 v[184:187], v6 offset:2048
    v_mfma_f32_16x16x32_bf16 v[52:55], v[200:203], v[164:167], v[52:55]
    ds_read_b128 v[188:191], v7
    v_mfma_f32_16x16x32_bf16 v[72:75], v[200:203], v[168:171], v[72:75]
    ds_read_b128 v[192:195], v7 offset:2048
    v_mfma_f32_16x16x32_bf16 v[92:95], v[200:203], v[172:175], v[92:95]
    ds_read_b64_tr_b16 v[220:221], v8 offset:10784
    v_mfma_f32_16x16x32_bf16 v[112:115], v[200:203], v[176:179], v[112:115]
    ds_read_b64_tr_b16 v[222:223], v8 offset:11120
    v_mfma_f32_16x16x32_bf16 v[132:135], v[200:203], v[28:31], v[132:135]
    ds_read_b64_tr_b16 v[224:225], v9 offset:10752
    v_mfma_f32_16x16x32_bf16 v[148:151], v[28:31], v[164:167], v[148:151]
    ds_read_b64_tr_b16 v[226:227], v9 offset:11088
    v_mfma_f32_16x16x32_bf16 v[56:59], v[204:207], v[164:167], v[56:59]
    ds_read_b64_tr_b16 v[228:229], v9 offset:10784
    v_mfma_f32_16x16x32_bf16 v[76:79], v[204:207], v[168:171], v[76:79]
    ds_read_b64_tr_b16 v[230:231], v9 offset:11120
    v_mfma_f32_16x16x32_bf16 v[96:99], v[204:207], v[172:175], v[96:99]
    ds_read_b64_tr_b16 v[232:233], v10 offset:10880
    v_mfma_f32_16x16x32_bf16 v[116:119], v[204:207], v[176:179], v[116:119]
    ds_read_b64_tr_b16 v[234:235], v10 offset:11216
    v_mfma_f32_16x16x32_bf16 v[152:155], v[28:31], v[168:171], v[152:155]
    v_mfma_f32_16x16x32_bf16 v[60:63], v[208:211], v[164:167], v[60:63]
    v_mfma_f32_16x16x32_bf16 v[80:83], v[208:211], v[168:171], v[80:83]
    v_mfma_f32_16x16x32_bf16 v[100:103], v[208:211], v[172:175], v[100:103]
    v_mfma_f32_16x16x32_bf16 v[120:123], v[208:211], v[176:179], v[120:123]
    v_mfma_f32_16x16x32_bf16 v[156:159], v[164:167], v[164:167], v[156:159]
    v_mfma_f32_16x16x32_bf16 v[64:67], v[212:215], v[164:167], v[64:67]
    v_mfma_f32_16x16x32_bf16 v[84:87], v[212:215], v[168:171], v[84:87]
    v_mfma_f32_16x16x32_bf16 v[104:107], v[212:215], v[172:175], v[104:107]
    v_mfma_f32_16x16x32_bf16 v[124:127], v[212:215], v[176:179], v[124:127]
    v_mfma_f32_16x16x32_bf16 v[144:147], v[212:215], v[28:31], v[144:147]
    v_mfma_f32_16x16x32_bf16 v[160:163], v[168:171], v[168:171], v[160:163]
    s_waitcnt lgkmcnt(0)
    s_barrier
    v_mfma_f32_16x16x32_bf16 v[48:51], v[216:219], v[180:183], v[48:51]
    v_add_u32 v4, 0x9400, v4
    v_add_u32 v8, 0x9400, v8
    v_mfma_f32_16x16x32_bf16 v[68:71], v[216:219], v[184:187], v[68:71]
    v_add_u32 v5, 0x9400, v5
    v_mfma_f32_16x16x32_bf16 v[88:91], v[216:219], v[188:191], v[88:91]
    v_add_u32 v9, 0x9400, v9
    v_mfma_f32_16x16x32_bf16 v[108:111], v[216:219], v[192:195], v[108:111]
    v_add_u32 v10, 0x9400, v10
    v_mfma_f32_16x16x32_bf16 v[128:131], v[216:219], v[28:31], v[128:131]
    ds_read_b128 v[164:167], v4
    v_mfma_f32_16x16x32_bf16 v[52:55], v[220:223], v[180:183], v[52:55]
    ds_read_b64_tr_b16 v[196:197], v8
    v_mfma_f32_16x16x32_bf16 v[72:75], v[220:223], v[184:187], v[72:75]
    ds_read_b64_tr_b16 v[198:199], v8 offset:336
    v_mfma_f32_16x16x32_bf16 v[92:95], v[220:223], v[188:191], v[92:95]
    ds_read_b128 v[168:171], v4 offset:2048
    v_mfma_f32_16x16x32_bf16 v[112:115], v[220:223], v[192:195], v[112:115]
    ds_read_b128 v[172:175], v5
    v_mfma_f32_16x16x32_bf16 v[132:135], v[220:223], v[28:31], v[132:135]
    ds_read_b128 v[176:179], v5 offset:2048
    v_mfma_f32_16x16x32_bf16 v[148:151], v[28:31], v[180:183], v[148:151]
    ds_read_b64_tr_b16 v[200:201], v8 offset:32
    v_mfma_f32_16x16x32_bf16 v[56:59], v[224:227], v[180:183], v[56:59]
    ds_read_b64_tr_b16 v[202:203], v8 offset:368
    v_mfma_f32_16x16x32_bf16 v[76:79], v[224:227], v[184:187], v[76:79]
    ds_read_b64_tr_b16 v[204:205], v9
    v_mfma_f32_16x16x32_bf16 v[96:99], v[224:227], v[188:191], v[96:99]
    ds_read_b64_tr_b16 v[206:207], v9 offset:336
    v_mfma_f32_16x16x32_bf16 v[116:119], v[224:227], v[192:195], v[116:119]
    ds_read_b64_tr_b16 v[208:209], v9 offset:32
    v_mfma_f32_16x16x32_bf16 v[152:155], v[28:31], v[184:187], v[152:155]
    ds_read_b64_tr_b16 v[210:211], v9 offset:368
    v_mfma_f32_16x16x32_bf16 v[60:63], v[228:231], v[180:183], v[60:63]
    ds_read_b64_tr_b16 v[212:213], v10 offset:128
    v_mfma_f32_16x16x32_bf16 v[80:83], v[228:231], v[184:187], v[80:83]
    ds_read_b64_tr_b16 v[214:215], v10 offset:464
    v_mfma_f32_16x16x32_bf16 v[100:103], v[228:231], v[188:191], v[100:103]
    v_mfma_f32_16x16x32_bf16 v[120:123], v[228:231], v[192:195], v[120:123]
    v_mfma_f32_16x16x32_bf16 v[156:159], v[180:183], v[180:183], v[156:159]
    v_mfma_f32_16x16x32_bf16 v[64:67], v[232:235], v[180:183], v[64:67]
    v_mfma_f32_16x16x32_bf16 v[84:87], v[232:235], v[184:187], v[84:87]
    v_mfma_f32_16x16x32_bf16 v[104:107], v[232:235], v[188:191], v[104:107]
    v_mfma_f32_16x16x32_bf16 v[124:127], v[232:235], v[192:195], v[124:127]
    v_mfma_f32_16x16x32_bf16 v[144:147], v[232:235], v[28:31], v[144:147]
    v_mfma_f32_16x16x32_bf16 v[160:163], v[184:187], v[184:187], v[160:163]
    s_waitcnt lgkmcnt(0)
    s_nop 0
    v_mfma_f32_16x16x32_bf16 v[48:51], v[196:199], v[164:167], v[48:51]
    v_add_u32 v6, 0x9400, v6
    v_add_u32 v7, 0x9400, v7
    v_mfma_f32_16x16x32_bf16 v[68:71], v[196:199], v[168:171], v[68:71]
    ds_read_b128 v[180:183], v6
    v_mfma_f32_16x16x32_bf16 v[88:91], v[196:199], v[172:175], v[88:91]
    ds_read_b64_tr_b16 v[216:217], v8 offset:10752
    v_mfma_f32_16x16x32_bf16 v[108:111], v[196:199], v[176:179], v[108:111]
    ds_read_b64_tr_b16 v[218:219], v8 offset:11088
    v_mfma_f32_16x16x32_bf16 v[128:131], v[196:199], v[28:31], v[128:131]
    ds_read_b128 v[184:187], v6 offset:2048
    v_mfma_f32_16x16x32_bf16 v[52:55], v[200:203], v[164:167], v[52:55]
    ds_read_b128 v[188:191], v7
    v_mfma_f32_16x16x32_bf16 v[72:75], v[200:203], v[168:171], v[72:75]
    ds_read_b128 v[192:195], v7 offset:2048
    v_mfma_f32_16x16x32_bf16 v[92:95], v[200:203], v[172:175], v[92:95]
    ds_read_b64_tr_b16 v[220:221], v8 offset:10784
    v_mfma_f32_16x16x32_bf16 v[112:115], v[200:203], v[176:179], v[112:115]
    ds_read_b64_tr_b16 v[222:223], v8 offset:11120
    v_mfma_f32_16x16x32_bf16 v[132:135], v[200:203], v[28:31], v[132:135]
    ds_read_b64_tr_b16 v[224:225], v9 offset:10752
    v_mfma_f32_16x16x32_bf16 v[148:151], v[28:31], v[164:167], v[148:151]
    ds_read_b64_tr_b16 v[226:227], v9 offset:11088
    v_mfma_f32_16x16x32_bf16 v[56:59], v[204:207], v[164:167], v[56:59]
    ds_read_b64_tr_b16 v[228:229], v9 offset:10784
    v_mfma_f32_16x16x32_bf16 v[76:79], v[204:207], v[168:171], v[76:79]
    ds_read_b64_tr_b16 v[230:231], v9 offset:11120
    v_mfma_f32_16x16x32_bf16 v[96:99], v[204:207], v[172:175], v[96:99]
    ds_read_b64_tr_b16 v[232:233], v10 offset:10880
    v_mfma_f32_16x16x32_bf16 v[116:119], v[204:207], v[176:179], v[116:119]
    ds_read_b64_tr_b16 v[234:235], v10 offset:11216
    v_mfma_f32_16x16x32_bf16 v[152:155], v[28:31], v[168:171], v[152:155]
    v_mfma_f32_16x16x32_bf16 v[60:63], v[208:211], v[164:167], v[60:63]
    v_mfma_f32_16x16x32_bf16 v[80:83], v[208:211], v[168:171], v[80:83]
    v_mfma_f32_16x16x32_bf16 v[100:103], v[208:211], v[172:175], v[100:103]
    v_mfma_f32_16x16x32_bf16 v[120:123], v[208:211], v[176:179], v[120:123]
    v_mfma_f32_16x16x32_bf16 v[156:159], v[164:167], v[164:167], v[156:159]
    v_mfma_f32_16x16x32_bf16 v[64:67], v[212:215], v[164:167], v[64:67]
    v_mfma_f32_16x16x32_bf16 v[84:87], v[212:215], v[168:171], v[84:87]
    v_mfma_f32_16x16x32_bf16 v[104:107], v[212:215], v[172:175], v[104:107]
    v_mfma_f32_16x16x32_bf16 v[124:127], v[212:215], v[176:179], v[124:127]
    v_mfma_f32_16x16x32_bf16 v[144:147], v[212:215], v[28:31], v[144:147]
    v_mfma_f32_16x16x32_bf16 v[160:163], v[168:171], v[168:171], v[160:163]
    s_waitcnt lgkmcnt(0)
    s_barrier
    v_mfma_f32_16x16x32_bf16 v[48:51], v[216:219], v[180:183], v[48:51]
    v_add_u32 v4, 0xfffe4400, v4
    v_add_u32 v8, 0xfffe4400, v8
    v_mfma_f32_16x16x32_bf16 v[68:71], v[216:219], v[184:187], v[68:71]
    v_add_u32 v5, 0xfffe4400, v5
    v_mfma_f32_16x16x32_bf16 v[88:91], v[216:219], v[188:191], v[88:91]
    v_add_u32 v9, 0xfffe4400, v9
    v_mfma_f32_16x16x32_bf16 v[108:111], v[216:219], v[192:195], v[108:111]
    v_add_u32 v10, 0xfffe4400, v10
    v_mfma_f32_16x16x32_bf16 v[128:131], v[216:219], v[28:31], v[128:131]
    ds_read_b128 v[164:167], v4
    v_mfma_f32_16x16x32_bf16 v[52:55], v[220:223], v[180:183], v[52:55]
    ds_read_b64_tr_b16 v[196:197], v8
    v_mfma_f32_16x16x32_bf16 v[72:75], v[220:223], v[184:187], v[72:75]
    ds_read_b64_tr_b16 v[198:199], v8 offset:336
    v_mfma_f32_16x16x32_bf16 v[92:95], v[220:223], v[188:191], v[92:95]
    ds_read_b128 v[168:171], v4 offset:2048
    v_mfma_f32_16x16x32_bf16 v[112:115], v[220:223], v[192:195], v[112:115]
    ds_read_b128 v[172:175], v5
    v_mfma_f32_16x16x32_bf16 v[132:135], v[220:223], v[28:31], v[132:135]
    ds_read_b128 v[176:179], v5 offset:2048
    v_mfma_f32_16x16x32_bf16 v[148:151], v[28:31], v[180:183], v[148:151]
    ds_read_b64_tr_b16 v[200:201], v8 offset:32
    v_mfma_f32_16x16x32_bf16 v[56:59], v[224:227], v[180:183], v[56:59]
    ds_read_b64_tr_b16 v[202:203], v8 offset:368
    v_mfma_f32_16x16x32_bf16 v[76:79], v[224:227], v[184:187], v[76:79]
    ds_read_b64_tr_b16 v[204:205], v9
    v_mfma_f32_16x16x32_bf16 v[96:99], v[224:227], v[188:191], v[96:99]
    ds_read_b64_tr_b16 v[206:207], v9 offset:336
    v_mfma_f32_16x16x32_bf16 v[116:119], v[224:227], v[192:195], v[116:119]
    ds_read_b64_tr_b16 v[208:209], v9 offset:32
    v_mfma_f32_16x16x32_bf16 v[152:155], v[28:31], v[184:187], v[152:155]
    ds_read_b64_tr_b16 v[210:211], v9 offset:368
    v_mfma_f32_16x16x32_bf16 v[60:63], v[228:231], v[180:183], v[60:63]
    ds_read_b64_tr_b16 v[212:213], v10 offset:128
    v_mfma_f32_16x16x32_bf16 v[80:83], v[228:231], v[184:187], v[80:83]
    ds_read_b64_tr_b16 v[214:215], v10 offset:464
    v_mfma_f32_16x16x32_bf16 v[100:103], v[228:231], v[188:191], v[100:103]
    v_mfma_f32_16x16x32_bf16 v[120:123], v[228:231], v[192:195], v[120:123]
    v_mfma_f32_16x16x32_bf16 v[156:159], v[180:183], v[180:183], v[156:159]
    v_mfma_f32_16x16x32_bf16 v[64:67], v[232:235], v[180:183], v[64:67]
    v_mfma_f32_16x16x32_bf16 v[84:87], v[232:235], v[184:187], v[84:87]
    v_mfma_f32_16x16x32_bf16 v[104:107], v[232:235], v[188:191], v[104:107]
    v_mfma_f32_16x16x32_bf16 v[124:127], v[232:235], v[192:195], v[124:127]
    v_mfma_f32_16x16x32_bf16 v[144:147], v[232:235], v[28:31], v[144:147]
    v_mfma_f32_16x16x32_bf16 v[160:163], v[184:187], v[184:187], v[160:163]
    s_waitcnt lgkmcnt(0)
    s_nop 0
    v_mfma_f32_16x16x32_bf16 v[48:51], v[196:199], v[164:167], v[48:51]
    v_add_u32 v6, 0xfffe4400, v6
    v_add_u32 v7, 0xfffe4400, v7
    v_mfma_f32_16x16x32_bf16 v[68:71], v[196:199], v[168:171], v[68:71]
    ds_read_b128 v[180:183], v6
    v_mfma_f32_16x16x32_bf16 v[88:91], v[196:199], v[172:175], v[88:91]
    ds_read_b64_tr_b16 v[216:217], v8 offset:10752
    v_mfma_f32_16x16x32_bf16 v[108:111], v[196:199], v[176:179], v[108:111]
    ds_read_b64_tr_b16 v[218:219], v8 offset:11088
    v_mfma_f32_16x16x32_bf16 v[128:131], v[196:199], v[28:31], v[128:131]
    ds_read_b128 v[184:187], v6 offset:2048
    v_mfma_f32_16x16x32_bf16 v[52:55], v[200:203], v[164:167], v[52:55]
    ds_read_b128 v[188:191], v7
    v_mfma_f32_16x16x32_bf16 v[72:75], v[200:203], v[168:171], v[72:75]
    ds_read_b128 v[192:195], v7 offset:2048
    v_mfma_f32_16x16x32_bf16 v[92:95], v[200:203], v[172:175], v[92:95]
    ds_read_b64_tr_b16 v[220:221], v8 offset:10784
    v_mfma_f32_16x16x32_bf16 v[112:115], v[200:203], v[176:179], v[112:115]
    ds_read_b64_tr_b16 v[222:223], v8 offset:11120
    v_mfma_f32_16x16x32_bf16 v[132:135], v[200:203], v[28:31], v[132:135]
    ds_read_b64_tr_b16 v[224:225], v9 offset:10752
    v_mfma_f32_16x16x32_bf16 v[148:151], v[28:31], v[164:167], v[148:151]
    ds_read_b64_tr_b16 v[226:227], v9 offset:11088
    v_mfma_f32_16x16x32_bf16 v[56:59], v[204:207], v[164:167], v[56:59]
    ds_read_b64_tr_b16 v[228:229], v9 offset:10784
    v_mfma_f32_16x16x32_bf16 v[76:79], v[204:207], v[168:171], v[76:79]
    ds_read_b64_tr_b16 v[230:231], v9 offset:11120
    v_mfma_f32_16x16x32_bf16 v[96:99], v[204:207], v[172:175], v[96:99]
    ds_read_b64_tr_b16 v[232:233], v10 offset:10880
    v_mfma_f32_16x16x32_bf16 v[116:119], v[204:207], v[176:179], v[116:119]
    ds_read_b64_tr_b16 v[234:235], v10 offset:11216
    v_mfma_f32_16x16x32_bf16 v[152:155], v[28:31], v[168:171], v[152:155]
    v_mfma_f32_16x16x32_bf16 v[60:63], v[208:211], v[164:167], v[60:63]
    v_mfma_f32_16x16x32_bf16 v[80:83], v[208:211], v[168:171], v[80:83]
    v_mfma_f32_16x16x32_bf16 v[100:103], v[208:211], v[172:175], v[100:103]
    v_mfma_f32_16x16x32_bf16 v[120:123], v[208:211], v[176:179], v[120:123]
    v_mfma_f32_16x16x32_bf16 v[156:159], v[164:167], v[164:167], v[156:159]
    v_mfma_f32_16x16x32_bf16 v[64:67], v[212:215], v[164:167], v[64:67]
    v_mfma_f32_16x16x32_bf16 v[84:87], v[212:215], v[168:171], v[84:87]
    v_mfma_f32_16x16x32_bf16 v[104:107], v[212:215], v[172:175], v[104:107]
    v_mfma_f32_16x16x32_bf16 v[124:127], v[212:215], v[176:179], v[124:127]
    v_mfma_f32_16x16x32_bf16 v[144:147], v[212:215], v[28:31], v[144:147]
    v_mfma_f32_16x16x32_bf16 v[160:163], v[168:171], v[168:171], v[160:163]
    s_waitcnt lgkmcnt(0)
    s_barrier
    v_mfma_f32_16x16x32_bf16 v[48:51], v[216:219], v[180:183], v[48:51]
    v_add_u32 v4, 0x9400, v4
    v_add_u32 v8, 0x9400, v8
    v_mfma_f32_16x16x32_bf16 v[68:71], v[216:219], v[184:187], v[68:71]
    v_add_u32 v5, 0x9400, v5
    v_mfma_f32_16x16x32_bf16 v[88:91], v[216:219], v[188:191], v[88:91]
    v_add_u32 v9, 0x9400, v9
    v_mfma_f32_16x16x32_bf16 v[108:111], v[216:219], v[192:195], v[108:111]
    v_add_u32 v10, 0x9400, v10
    v_mfma_f32_16x16x32_bf16 v[128:131], v[216:219], v[28:31], v[128:131]
    ds_read_b128 v[164:167], v4
    v_mfma_f32_16x16x32_bf16 v[52:55], v[220:223], v[180:183], v[52:55]
    ds_read_b64_tr_b16 v[196:197], v8
    v_mfma_f32_16x16x32_bf16 v[72:75], v[220:223], v[184:187], v[72:75]
    ds_read_b64_tr_b16 v[198:199], v8 offset:336
    v_mfma_f32_16x16x32_bf16 v[92:95], v[220:223], v[188:191], v[92:95]
    ds_read_b128 v[168:171], v4 offset:2048
    v_mfma_f32_16x16x32_bf16 v[112:115], v[220:223], v[192:195], v[112:115]
    ds_read_b128 v[172:175], v5
    v_mfma_f32_16x16x32_bf16 v[132:135], v[220:223], v[28:31], v[132:135]
    ds_read_b128 v[176:179], v5 offset:2048
    v_mfma_f32_16x16x32_bf16 v[148:151], v[28:31], v[180:183], v[148:151]
    ds_read_b64_tr_b16 v[200:201], v8 offset:32
    v_mfma_f32_16x16x32_bf16 v[56:59], v[224:227], v[180:183], v[56:59]
    ds_read_b64_tr_b16 v[202:203], v8 offset:368
    v_mfma_f32_16x16x32_bf16 v[76:79], v[224:227], v[184:187], v[76:79]
    ds_read_b64_tr_b16 v[204:205], v9
    v_mfma_f32_16x16x32_bf16 v[96:99], v[224:227], v[188:191], v[96:99]
    ds_read_b64_tr_b16 v[206:207], v9 offset:336
    v_mfma_f32_16x16x32_bf16 v[116:119], v[224:227], v[192:195], v[116:119]
    ds_read_b64_tr_b16 v[208:209], v9 offset:32
    v_mfma_f32_16x16x32_bf16 v[152:155], v[28:31], v[184:187], v[152:155]
    ds_read_b64_tr_b16 v[210:211], v9 offset:368
    v_mfma_f32_16x16x32_bf16 v[60:63], v[228:231], v[180:183], v[60:63]
    ds_read_b64_tr_b16 v[212:213], v10 offset:128
    v_mfma_f32_16x16x32_bf16 v[80:83], v[228:231], v[184:187], v[80:83]
    ds_read_b64_tr_b16 v[214:215], v10 offset:464
    v_mfma_f32_16x16x32_bf16 v[100:103], v[228:231], v[188:191], v[100:103]
    v_mfma_f32_16x16x32_bf16 v[120:123], v[228:231], v[192:195], v[120:123]
    v_mfma_f32_16x16x32_bf16 v[156:159], v[180:183], v[180:183], v[156:159]
    v_mfma_f32_16x16x32_bf16 v[64:67], v[232:235], v[180:183], v[64:67]
    v_mfma_f32_16x16x32_bf16 v[84:87], v[232:235], v[184:187], v[84:87]
    v_mfma_f32_16x16x32_bf16 v[104:107], v[232:235], v[188:191], v[104:107]
    v_mfma_f32_16x16x32_bf16 v[124:127], v[232:235], v[192:195], v[124:127]
    v_mfma_f32_16x16x32_bf16 v[144:147], v[232:235], v[28:31], v[144:147]
    v_mfma_f32_16x16x32_bf16 v[160:163], v[184:187], v[184:187], v[160:163]
    s_waitcnt lgkmcnt(0)
    s_nop 0
    buffer_load_dword v26, v25, s[16:19], s70 offen sc0 sc1
    v_mfma_f32_16x16x32_bf16 v[48:51], v[196:199], v[164:167], v[48:51]
    v_add_u32 v6, 0x9400, v6
    v_add_u32 v7, 0x9400, v7
    v_mfma_f32_16x16x32_bf16 v[68:71], v[196:199], v[168:171], v[68:71]
    ds_read_b128 v[180:183], v6
    v_mfma_f32_16x16x32_bf16 v[88:91], v[196:199], v[172:175], v[88:91]
    ds_read_b64_tr_b16 v[216:217], v8 offset:10752
    v_mfma_f32_16x16x32_bf16 v[108:111], v[196:199], v[176:179], v[108:111]
    ds_read_b64_tr_b16 v[218:219], v8 offset:11088
    v_mfma_f32_16x16x32_bf16 v[128:131], v[196:199], v[28:31], v[128:131]
    ds_read_b128 v[184:187], v6 offset:2048
    v_mfma_f32_16x16x32_bf16 v[52:55], v[200:203], v[164:167], v[52:55]
    ds_read_b128 v[188:191], v7
    v_mfma_f32_16x16x32_bf16 v[72:75], v[200:203], v[168:171], v[72:75]
    ds_read_b128 v[192:195], v7 offset:2048
    v_mfma_f32_16x16x32_bf16 v[92:95], v[200:203], v[172:175], v[92:95]
    ds_read_b64_tr_b16 v[220:221], v8 offset:10784
    v_mfma_f32_16x16x32_bf16 v[112:115], v[200:203], v[176:179], v[112:115]
    ds_read_b64_tr_b16 v[222:223], v8 offset:11120
    v_mfma_f32_16x16x32_bf16 v[132:135], v[200:203], v[28:31], v[132:135]
    ds_read_b64_tr_b16 v[224:225], v9 offset:10752
    v_mfma_f32_16x16x32_bf16 v[148:151], v[28:31], v[164:167], v[148:151]
    ds_read_b64_tr_b16 v[226:227], v9 offset:11088
    v_mfma_f32_16x16x32_bf16 v[56:59], v[204:207], v[164:167], v[56:59]
    ds_read_b64_tr_b16 v[228:229], v9 offset:10784
    v_mfma_f32_16x16x32_bf16 v[76:79], v[204:207], v[168:171], v[76:79]
    ds_read_b64_tr_b16 v[230:231], v9 offset:11120
    v_mfma_f32_16x16x32_bf16 v[96:99], v[204:207], v[172:175], v[96:99]
    ds_read_b64_tr_b16 v[232:233], v10 offset:10880
    v_mfma_f32_16x16x32_bf16 v[116:119], v[204:207], v[176:179], v[116:119]
    ds_read_b64_tr_b16 v[234:235], v10 offset:11216
    v_mfma_f32_16x16x32_bf16 v[152:155], v[28:31], v[168:171], v[152:155]
    v_mfma_f32_16x16x32_bf16 v[60:63], v[208:211], v[164:167], v[60:63]
    v_mfma_f32_16x16x32_bf16 v[80:83], v[208:211], v[168:171], v[80:83]
    v_mfma_f32_16x16x32_bf16 v[100:103], v[208:211], v[172:175], v[100:103]
    v_mfma_f32_16x16x32_bf16 v[120:123], v[208:211], v[176:179], v[120:123]
    v_mfma_f32_16x16x32_bf16 v[156:159], v[164:167], v[164:167], v[156:159]
    v_mfma_f32_16x16x32_bf16 v[64:67], v[212:215], v[164:167], v[64:67]
    v_mfma_f32_16x16x32_bf16 v[84:87], v[212:215], v[168:171], v[84:87]
    v_mfma_f32_16x16x32_bf16 v[104:107], v[212:215], v[172:175], v[104:107]
    v_mfma_f32_16x16x32_bf16 v[124:127], v[212:215], v[176:179], v[124:127]
    v_mfma_f32_16x16x32_bf16 v[144:147], v[212:215], v[28:31], v[144:147]
    v_mfma_f32_16x16x32_bf16 v[160:163], v[168:171], v[168:171], v[160:163]
    s_waitcnt lgkmcnt(0)
    s_nop 0
    v_mfma_f32_16x16x32_bf16 v[48:51], v[216:219], v[180:183], v[48:51]
    v_mfma_f32_16x16x32_bf16 v[68:71], v[216:219], v[184:187], v[68:71]
    v_mfma_f32_16x16x32_bf16 v[88:91], v[216:219], v[188:191], v[88:91]
    v_mfma_f32_16x16x32_bf16 v[108:111], v[216:219], v[192:195], v[108:111]
    v_mfma_f32_16x16x32_bf16 v[128:131], v[216:219], v[28:31], v[128:131]
    v_mfma_f32_16x16x32_bf16 v[52:55], v[220:223], v[180:183], v[52:55]
    v_mfma_f32_16x16x32_bf16 v[72:75], v[220:223], v[184:187], v[72:75]
    v_mfma_f32_16x16x32_bf16 v[92:95], v[220:223], v[188:191], v[92:95]
    v_mfma_f32_16x16x32_bf16 v[112:115], v[220:223], v[192:195], v[112:115]
    v_mfma_f32_16x16x32_bf16 v[132:135], v[220:223], v[28:31], v[132:135]
    v_mfma_f32_16x16x32_bf16 v[148:151], v[28:31], v[180:183], v[148:151]
    v_mfma_f32_16x16x32_bf16 v[56:59], v[224:227], v[180:183], v[56:59]
    v_mfma_f32_16x16x32_bf16 v[76:79], v[224:227], v[184:187], v[76:79]
    v_mfma_f32_16x16x32_bf16 v[96:99], v[224:227], v[188:191], v[96:99]
    v_mfma_f32_16x16x32_bf16 v[116:119], v[224:227], v[192:195], v[116:119]
    v_mfma_f32_16x16x32_bf16 v[152:155], v[28:31], v[184:187], v[152:155]
    v_mfma_f32_16x16x32_bf16 v[60:63], v[228:231], v[180:183], v[60:63]
    v_mfma_f32_16x16x32_bf16 v[80:83], v[228:231], v[184:187], v[80:83]
    v_mfma_f32_16x16x32_bf16 v[100:103], v[228:231], v[188:191], v[100:103]
    v_mfma_f32_16x16x32_bf16 v[120:123], v[228:231], v[192:195], v[120:123]
    v_mfma_f32_16x16x32_bf16 v[156:159], v[180:183], v[180:183], v[156:159]
    v_mfma_f32_16x16x32_bf16 v[64:67], v[232:235], v[180:183], v[64:67]
    v_mfma_f32_16x16x32_bf16 v[84:87], v[232:235], v[184:187], v[84:87]
    v_mfma_f32_16x16x32_bf16 v[104:107], v[232:235], v[188:191], v[104:107]
    v_mfma_f32_16x16x32_bf16 v[124:127], v[232:235], v[192:195], v[124:127]
    v_mfma_f32_16x16x32_bf16 v[144:147], v[232:235], v[28:31], v[144:147]
    v_mfma_f32_16x16x32_bf16 v[160:163], v[184:187], v[184:187], v[160:163]
    ds_write_b128 v23, v[128:131]
    ds_write_b128 v23, v[132:135] offset:64
    v_cndmask_b32 v164, v156, v157, s[76:77]
    v_cndmask_b32 v164, v164, v158, s[78:79]
    v_cndmask_b32 v164, v164, v159, s[80:81]
    v_cndmask_b32 v164, 0, v164, s[82:83]
    s_nop 1
    s_nop 0
    v_cndmask_b32 v165, v160, v161, s[76:77]
    v_cndmask_b32 v165, v165, v162, s[78:79]
    v_cndmask_b32 v165, v165, v163, s[80:81]
    v_cndmask_b32 v165, 0, v165, s[82:83]
    v_mov_b32 v166, v164
    v_mov_b32 v167, v165
    s_nop 0
    v_permlane32_swap_b32 v164, v166
    v_permlane32_swap_b32 v165, v167
    v_add_f32 v164, v164, v166
    v_add_f32 v165, v165, v167
    v_mov_b32 v166, v164
    v_mov_b32 v167, v165
    s_nop 0
    v_permlane16_swap_b32 v164, v166
    v_permlane16_swap_b32 v165, v167
    v_add_f32 v164, v164, v166
    v_add_f32 v165, v165, v167
    v_mul_f32 v148, s68, v148
    v_mul_f32 v152, s68, v152
    v_mul_f32 v164, s68, v164
    v_mul_f32 v165, s68, v165
    v_fma_f32 v164, -v148, v148, v164
    v_fma_f32 v165, -v152, v152, v165
    v_max_f32 v164, 0, v164
    v_max_f32 v165, 0, v165
    v_cvt_pk_bf16_f32 v40, v148, v148
    v_cvt_pk_bf16_f32 v42, v152, v152
    v_lshlrev_b32 v40, 16, v40
    v_lshlrev_b32 v42, 16, v42
    v_cvt_pk_bf16_f32 v166, v164, v164
    v_cvt_pk_bf16_f32 v167, v165, v165
    v_lshlrev_b32 v166, 16, v166
    v_lshlrev_b32 v167, 16, v167
    v_add_f32 v166, 0x3727c5ac, v166
    v_add_f32 v167, 0x3727c5ac, v167
    v_cvt_pk_bf16_f32 v166, v166, v166
    v_cvt_pk_bf16_f32 v167, v167, v167
    v_lshlrev_b32 v166, 16, v166
    v_lshlrev_b32 v167, 16, v167
    v_sqrt_f32 v166, v166
    v_sqrt_f32 v167, v167
    v_cvt_pk_bf16_f32 v166, v166, v166
    v_cvt_pk_bf16_f32 v167, v167, v167
    v_lshlrev_b32 v166, 16, v166
    v_lshlrev_b32 v167, 16, v167
    v_rcp_f32 v41, v166
    v_rcp_f32 v43, v167
    v_mul_f32 v40, v40, v41
    v_mul_f32 v42, v42, v43
    v_sub_f32_e64 v40, 0, v40
    ds_write_b64 v21, v[40:41]
    v_sub_f32_e64 v42, 0, v42
    ds_write_b64 v21, v[42:43] offset:128
    s_waitcnt lgkmcnt(0)
    s_barrier
    ds_read_b64 v[44:45], v22
    ds_read_b128 v[136:139], v24
    ds_read_b64 v[46:47], v22 offset:128
    ds_read_b128 v[140:143], v24 offset:64
    s_cmp_eq_u32 s63, 1
    s_cbranch_scc1 L_k1_epiq
    v_mov_b32 v148, 0x3f80
    v_mov_b32_e64 v149, 0
    ds_write_b64 v14, v[148:149] offset:160
    ds_write_b64 v14, v[148:149] offset:2848
    ds_write_b64 v15, v[148:149] offset:160
    ds_write_b64 v15, v[148:149] offset:2848
    s_cmp_eq_u32 s59, 1
    s_cbranch_scc1 L_k1_epi_wm1
    v_pk_fma_f32 v[164:165], v[40:41], v[128:129], v[32:33] op_sel:[0,0,0] op_sel_hi:[0,1,0]
    v_pk_fma_f32 v[180:181], v[40:41], v[132:133], v[32:33] op_sel:[0,0,0] op_sel_hi:[0,1,0]
    v_pk_mul_f32 v[196:197], v[40:41], v[144:145] op_sel:[0,0] op_sel_hi:[0,1]
    v_pk_fma_f32 v[212:213], v[42:43], v[128:129], v[32:33] op_sel:[0,0,0] op_sel_hi:[0,1,0]
    v_pk_fma_f32 v[166:167], v[40:41], v[130:131], v[32:33] op_sel:[0,0,0] op_sel_hi:[0,1,0]
    v_pk_fma_f32 v[182:183], v[40:41], v[134:135], v[32:33] op_sel:[0,0,0] op_sel_hi:[0,1,0]
    v_pk_mul_f32 v[198:199], v[40:41], v[146:147] op_sel:[0,0] op_sel_hi:[0,1]
    v_pk_fma_f32 v[214:215], v[42:43], v[130:131], v[32:33] op_sel:[0,0,0] op_sel_hi:[0,1,0]
    v_pk_fma_f32 v[168:169], v[48:49], v[40:41], v[164:165] op_sel:[0,1,0] op_sel_hi:[1,1,1]
    v_pk_fma_f32 v[184:185], v[52:53], v[40:41], v[180:181] op_sel:[0,1,0] op_sel_hi:[1,1,1]
    v_pk_fma_f32 v[200:201], v[64:65], v[40:41], v[196:197] op_sel:[0,1,0] op_sel_hi:[1,1,1]
    v_pk_fma_f32 v[216:217], v[68:69], v[42:43], v[212:213] op_sel:[0,1,0] op_sel_hi:[1,1,1]
    v_pk_fma_f32 v[170:171], v[50:51], v[40:41], v[166:167] op_sel:[0,1,0] op_sel_hi:[1,1,1]
    v_pk_fma_f32 v[186:187], v[54:55], v[40:41], v[182:183] op_sel:[0,1,0] op_sel_hi:[1,1,1]
    v_pk_fma_f32 v[202:203], v[66:67], v[40:41], v[198:199] op_sel:[0,1,0] op_sel_hi:[1,1,1]
    v_pk_fma_f32 v[218:219], v[70:71], v[42:43], v[214:215] op_sel:[0,1,0] op_sel_hi:[1,1,1]
    v_pk_fma_f32 v[172:173], v[168:169], v[34:35], v[32:33] op_sel:[0,0,1] op_sel_hi:[1,0,1]
    v_pk_fma_f32 v[188:189], v[184:185], v[34:35], v[32:33] op_sel:[0,0,1] op_sel_hi:[1,0,1]
    v_cvt_pk_bf16_f32 v208, v200, v201
    v_pk_fma_f32 v[220:221], v[216:217], v[34:35], v[32:33] op_sel:[0,0,1] op_sel_hi:[1,0,1]
    v_pk_fma_f32 v[174:175], v[170:171], v[34:35], v[32:33] op_sel:[0,0,1] op_sel_hi:[1,0,1]
    v_pk_fma_f32 v[190:191], v[186:187], v[34:35], v[32:33] op_sel:[0,0,1] op_sel_hi:[1,0,1]
    v_cvt_pk_bf16_f32 v209, v202, v203
    v_pk_fma_f32 v[222:223], v[218:219], v[34:35], v[32:33] op_sel:[0,0,1] op_sel_hi:[1,0,1]
    v_exp_f32 v172, v172 clamp
    v_exp_f32 v188, v188 clamp
    ds_write_b64 v12, v[208:209] offset:128
    v_exp_f32 v220, v220 clamp
    v_max_f32 v164, v32, v168
    v_max_f32 v180, v32, v184
    v_max_f32_e64 v212, v32, v216
    v_exp_f32 v173, v173 clamp
    v_exp_f32 v189, v189 clamp
    v_exp_f32 v221, v221 clamp
    v_max_f32 v165, v32, v169
    v_max_f32 v181, v32, v185
    v_max_f32_e64 v213, v32, v217
    v_exp_f32 v174, v174 clamp
    v_exp_f32 v190, v190 clamp
    v_exp_f32 v222, v222 clamp
    v_max_f32 v166, v32, v170
    v_max_f32 v182, v32, v186
    v_max_f32_e64 v214, v32, v218
    v_exp_f32 v175, v175 clamp
    v_exp_f32 v191, v191 clamp
    v_exp_f32 v223, v223 clamp
    v_max_f32 v167, v32, v171
    v_max_f32 v183, v32, v187
    v_max_f32_e64 v215, v32, v219
    v_pk_add_f32 v[164:165], v[164:165], v[172:173]
    v_pk_add_f32 v[180:181], v[180:181], v[188:189]
    v_pk_add_f32 v[212:213], v[212:213], v[220:221]
    v_pk_add_f32 v[166:167], v[166:167], v[174:175]
    v_pk_add_f32 v[182:183], v[182:183], v[190:191]
    v_pk_add_f32 v[214:215], v[214:215], v[222:223]
    v_cvt_pk_bf16_f32 v176, v164, v165
    v_cvt_pk_bf16_f32 v192, v180, v181
    v_cvt_pk_bf16_f32 v224, v212, v213
    v_cvt_pk_bf16_f32 v177, v166, v167
    v_cvt_pk_bf16_f32 v193, v182, v183
    v_cvt_pk_bf16_f32 v225, v214, v215
    ds_write_b64 v12, v[176:177]
    ds_write_b64 v12, v[192:193] offset:32
    ds_write_b64 v12, v[224:225] offset:2688
    v_pk_fma_f32 v[164:165], v[42:43], v[132:133], v[32:33] op_sel:[0,0,0] op_sel_hi:[0,1,0]
    v_pk_mul_f32 v[180:181], v[42:43], v[144:145] op_sel:[0,0] op_sel_hi:[0,1]
    v_pk_fma_f32 v[166:167], v[42:43], v[134:135], v[32:33] op_sel:[0,0,0] op_sel_hi:[0,1,0]
    v_pk_mul_f32 v[182:183], v[42:43], v[146:147] op_sel:[0,0] op_sel_hi:[0,1]
    v_pk_fma_f32 v[168:169], v[72:73], v[42:43], v[164:165] op_sel:[0,1,0] op_sel_hi:[1,1,1]
    v_pk_fma_f32 v[184:185], v[84:85], v[42:43], v[180:181] op_sel:[0,1,0] op_sel_hi:[1,1,1]
    v_pk_fma_f32 v[170:171], v[74:75], v[42:43], v[166:167] op_sel:[0,1,0] op_sel_hi:[1,1,1]
    v_pk_fma_f32 v[186:187], v[86:87], v[42:43], v[182:183] op_sel:[0,1,0] op_sel_hi:[1,1,1]
    v_pk_fma_f32 v[172:173], v[168:169], v[34:35], v[32:33] op_sel:[0,0,1] op_sel_hi:[1,0,1]
    v_cvt_pk_bf16_f32 v192, v184, v185
    v_pk_fma_f32 v[174:175], v[170:171], v[34:35], v[32:33] op_sel:[0,0,1] op_sel_hi:[1,0,1]
    v_cvt_pk_bf16_f32 v193, v186, v187
    v_exp_f32 v172, v172 clamp
    ds_write_b64 v12, v[192:193] offset:2816
    v_max_f32_e64 v164, v32, v168
    v_exp_f32 v173, v173 clamp
    v_max_f32_e64 v165, v32, v169
    v_exp_f32 v174, v174 clamp
    v_max_f32_e64 v166, v32, v170
    v_exp_f32 v175, v175 clamp
    v_max_f32_e64 v167, v32, v171
    v_pk_add_f32 v[164:165], v[164:165], v[172:173]
    v_pk_add_f32 v[166:167], v[166:167], v[174:175]
    v_cvt_pk_bf16_f32 v176, v164, v165
    v_cvt_pk_bf16_f32 v177, v166, v167
    ds_write_b64 v12, v[176:177] offset:2720
    s_waitcnt lgkmcnt(10)
    s_nop 0
    v_pk_fma_f32 v[196:197], v[40:41], v[136:137], v[32:33] op_sel:[0,0,0] op_sel_hi:[0,1,0]
    v_pk_mul_f32 v[212:213], v[40:41], v[140:141] op_sel:[0,0] op_sel_hi:[0,1]
    v_pk_fma_f32 v[164:165], v[42:43], v[136:137], v[32:33] op_sel:[0,0,0] op_sel_hi:[0,1,0]
    v_pk_mul_f32 v[180:181], v[42:43], v[140:141] op_sel:[0,0] op_sel_hi:[0,1]
    v_pk_fma_f32 v[198:199], v[40:41], v[138:139], v[32:33] op_sel:[0,0,0] op_sel_hi:[0,1,0]
    v_pk_mul_f32 v[214:215], v[40:41], v[142:143] op_sel:[0,0] op_sel_hi:[0,1]
    v_pk_fma_f32 v[166:167], v[42:43], v[138:139], v[32:33] op_sel:[0,0,0] op_sel_hi:[0,1,0]
    v_pk_mul_f32 v[182:183], v[42:43], v[142:143] op_sel:[0,0] op_sel_hi:[0,1]
    v_pk_fma_f32 v[200:201], v[56:57], v[40:41], v[196:197] op_sel:[0,1,0] op_sel_hi:[1,1,1]
    v_pk_fma_f32 v[216:217], v[60:61], v[40:41], v[212:213] op_sel:[0,1,0] op_sel_hi:[1,1,1]
    v_pk_fma_f32 v[168:169], v[76:77], v[42:43], v[164:165] op_sel:[0,1,0] op_sel_hi:[1,1,1]
    v_pk_fma_f32 v[184:185], v[80:81], v[42:43], v[180:181] op_sel:[0,1,0] op_sel_hi:[1,1,1]
    v_pk_fma_f32 v[202:203], v[58:59], v[40:41], v[198:199] op_sel:[0,1,0] op_sel_hi:[1,1,1]
    v_pk_fma_f32 v[218:219], v[62:63], v[40:41], v[214:215] op_sel:[0,1,0] op_sel_hi:[1,1,1]
    v_pk_fma_f32 v[170:171], v[78:79], v[42:43], v[166:167] op_sel:[0,1,0] op_sel_hi:[1,1,1]
    v_pk_fma_f32 v[186:187], v[82:83], v[42:43], v[182:183] op_sel:[0,1,0] op_sel_hi:[1,1,1]
    v_pk_fma_f32 v[204:205], v[200:201], v[34:35], v[32:33] op_sel:[0,0,1] op_sel_hi:[1,0,1]
    v_cvt_pk_bf16_f32 v224, v216, v217
    v_pk_fma_f32 v[172:173], v[168:169], v[34:35], v[32:33] op_sel:[0,0,1] op_sel_hi:[1,0,1]
    v_cvt_pk_bf16_f32 v192, v184, v185
    v_pk_fma_f32 v[206:207], v[202:203], v[34:35], v[32:33] op_sel:[0,0,1] op_sel_hi:[1,0,1]
    v_cvt_pk_bf16_f32 v225, v218, v219
    v_pk_fma_f32 v[174:175], v[170:171], v[34:35], v[32:33] op_sel:[0,0,1] op_sel_hi:[1,0,1]
    v_cvt_pk_bf16_f32 v193, v186, v187
    v_exp_f32 v204, v204 clamp
    ds_write_b64 v12, v[224:225] offset:96
    v_exp_f32 v172, v172 clamp
    ds_write_b64 v12, v[192:193] offset:2784
    v_max_f32 v196, v32, v200
    v_max_f32 v164, v32, v168
    v_exp_f32 v205, v205 clamp
    v_exp_f32 v173, v173 clamp
    v_max_f32 v197, v32, v201
    v_max_f32 v165, v32, v169
    v_exp_f32 v206, v206 clamp
    v_exp_f32 v174, v174 clamp
    v_max_f32 v198, v32, v202
    v_max_f32 v166, v32, v170
    v_exp_f32 v207, v207 clamp
    v_exp_f32 v175, v175 clamp
    v_max_f32 v199, v32, v203
    v_max_f32 v167, v32, v171
    v_pk_add_f32 v[196:197], v[196:197], v[204:205]
    v_pk_add_f32 v[164:165], v[164:165], v[172:173]
    v_pk_add_f32 v[198:199], v[198:199], v[206:207]
    v_pk_add_f32 v[166:167], v[166:167], v[174:175]
    v_sub_f32 v200, v200, v32
    v_sub_f32 v168, v168, v32
    v_cndmask_b32 v196, v200, v196, s[84:85]
    v_cndmask_b32 v164, v168, v164, s[84:85]
    v_sub_f32 v201, v201, v32
    v_sub_f32 v169, v169, v32
    v_cndmask_b32 v197, v201, v197, s[84:85]
    v_cndmask_b32 v165, v169, v165, s[84:85]
    v_sub_f32 v202, v202, v32
    v_sub_f32 v170, v170, v32
    v_cndmask_b32 v198, v202, v198, s[84:85]
    v_cndmask_b32 v166, v170, v166, s[84:85]
    v_sub_f32 v203, v203, v32
    v_sub_f32 v171, v171, v32
    v_cndmask_b32 v199, v203, v199, s[84:85]
    v_cndmask_b32 v167, v171, v167, s[84:85]
    v_cvt_pk_bf16_f32 v208, v196, v197
    v_cvt_pk_bf16_f32 v176, v164, v165
    v_cvt_pk_bf16_f32 v209, v198, v199
    v_cvt_pk_bf16_f32 v177, v166, v167
    ds_write_b64 v12, v[208:209] offset:64
    ds_write_b64 v12, v[176:177] offset:2752
    v_pk_fma_f32 v[196:197], v[44:45], v[128:129], v[32:33] op_sel:[0,0,0] op_sel_hi:[0,1,0]
    v_pk_fma_f32 v[212:213], v[44:45], v[132:133], v[32:33] op_sel:[0,0,0] op_sel_hi:[0,1,0]
    v_pk_fma_f32 v[164:165], v[44:45], v[136:137], v[32:33] op_sel:[0,0,0] op_sel_hi:[0,1,0]
    v_pk_mul_f32 v[180:181], v[44:45], v[140:141] op_sel:[0,0] op_sel_hi:[0,1]
    v_pk_fma_f32 v[198:199], v[44:45], v[130:131], v[32:33] op_sel:[0,0,0] op_sel_hi:[0,1,0]
    v_pk_fma_f32 v[214:215], v[44:45], v[134:135], v[32:33] op_sel:[0,0,0] op_sel_hi:[0,1,0]
    v_pk_fma_f32 v[166:167], v[44:45], v[138:139], v[32:33] op_sel:[0,0,0] op_sel_hi:[0,1,0]
    v_pk_mul_f32 v[182:183], v[44:45], v[142:143] op_sel:[0,0] op_sel_hi:[0,1]
    v_pk_fma_f32 v[200:201], v[88:89], v[44:45], v[196:197] op_sel:[0,1,0] op_sel_hi:[1,1,1]
    v_pk_fma_f32 v[216:217], v[92:93], v[44:45], v[212:213] op_sel:[0,1,0] op_sel_hi:[1,1,1]
    v_pk_fma_f32 v[168:169], v[96:97], v[44:45], v[164:165] op_sel:[0,1,0] op_sel_hi:[1,1,1]
    v_pk_fma_f32 v[184:185], v[100:101], v[44:45], v[180:181] op_sel:[0,1,0] op_sel_hi:[1,1,1]
    v_pk_fma_f32 v[202:203], v[90:91], v[44:45], v[198:199] op_sel:[0,1,0] op_sel_hi:[1,1,1]
    v_pk_fma_f32 v[218:219], v[94:95], v[44:45], v[214:215] op_sel:[0,1,0] op_sel_hi:[1,1,1]
    v_pk_fma_f32 v[170:171], v[98:99], v[44:45], v[166:167] op_sel:[0,1,0] op_sel_hi:[1,1,1]
    v_pk_fma_f32 v[186:187], v[102:103], v[44:45], v[182:183] op_sel:[0,1,0] op_sel_hi:[1,1,1]
    v_pk_fma_f32 v[204:205], v[200:201], v[34:35], v[32:33] op_sel:[0,0,1] op_sel_hi:[1,0,1]
    v_pk_fma_f32 v[220:221], v[216:217], v[34:35], v[32:33] op_sel:[0,0,1] op_sel_hi:[1,0,1]
    v_pk_fma_f32 v[172:173], v[168:169], v[34:35], v[32:33] op_sel:[0,0,1] op_sel_hi:[1,0,1]
    v_cvt_pk_bf16_f32 v192, v184, v185
    v_pk_fma_f32 v[206:207], v[202:203], v[34:35], v[32:33] op_sel:[0,0,1] op_sel_hi:[1,0,1]
    v_pk_fma_f32 v[222:223], v[218:219], v[34:35], v[32:33] op_sel:[0,0,1] op_sel_hi:[1,0,1]
    v_pk_fma_f32 v[174:175], v[170:171], v[34:35], v[32:33] op_sel:[0,0,1] op_sel_hi:[1,0,1]
    v_cvt_pk_bf16_f32 v193, v186, v187
    v_exp_f32 v204, v204 clamp
    v_exp_f32 v220, v220 clamp
    v_exp_f32 v172, v172 clamp
    ds_write_b64 v13, v[192:193] offset:96
    v_max_f32 v196, v32, v200
    v_max_f32 v212, v32, v216
    v_max_f32_e64 v164, v32, v168
    v_exp_f32 v205, v205 clamp
    v_exp_f32 v221, v221 clamp
    v_exp_f32 v173, v173 clamp
    v_max_f32 v197, v32, v201
    v_max_f32 v213, v32, v217
    v_max_f32_e64 v165, v32, v169
    v_exp_f32 v206, v206 clamp
    v_exp_f32 v222, v222 clamp
    v_exp_f32 v174, v174 clamp
    v_max_f32 v198, v32, v202
    v_max_f32 v214, v32, v218
    v_max_f32_e64 v166, v32, v170
    v_exp_f32 v207, v207 clamp
    v_exp_f32 v223, v223 clamp
    v_exp_f32 v175, v175 clamp
    v_max_f32 v199, v32, v203
    v_max_f32 v215, v32, v219
    v_max_f32_e64 v167, v32, v171
    v_pk_add_f32 v[196:197], v[196:197], v[204:205]
    v_pk_add_f32 v[212:213], v[212:213], v[220:221]
    v_pk_add_f32 v[164:165], v[164:165], v[172:173]
    v_pk_add_f32 v[198:199], v[198:199], v[206:207]
    v_pk_add_f32 v[214:215], v[214:215], v[222:223]
    v_pk_add_f32 v[166:167], v[166:167], v[174:175]
    v_cvt_pk_bf16_f32 v208, v196, v197
    v_cvt_pk_bf16_f32 v224, v212, v213
    v_sub_f32_e64 v168, v168, v32
    v_cvt_pk_bf16_f32 v209, v198, v199
    v_cvt_pk_bf16_f32 v225, v214, v215
    v_cndmask_b32 v164, v168, v164, s[84:85]
    ds_write_b64 v13, v[208:209]
    ds_write_b64 v13, v[224:225] offset:32
    v_sub_f32_e64 v169, v169, v32
    v_cndmask_b32 v165, v169, v165, s[84:85]
    v_sub_f32_e64 v170, v170, v32
    v_cndmask_b32 v166, v170, v166, s[84:85]
    v_sub_f32_e64 v171, v171, v32
    v_cndmask_b32 v167, v171, v167, s[84:85]
    v_cvt_pk_bf16_f32 v176, v164, v165
    v_cvt_pk_bf16_f32 v177, v166, v167
    ds_write_b64 v13, v[176:177] offset:64
    v_pk_mul_f32 v[196:197], v[44:45], v[144:145] op_sel:[0,0] op_sel_hi:[0,1]
    v_pk_fma_f32 v[212:213], v[46:47], v[128:129], v[32:33] op_sel:[0,0,0] op_sel_hi:[0,1,0]
    v_pk_fma_f32 v[164:165], v[46:47], v[132:133], v[32:33] op_sel:[0,0,0] op_sel_hi:[0,1,0]
    v_pk_fma_f32 v[180:181], v[46:47], v[136:137], v[32:33] op_sel:[0,0,0] op_sel_hi:[0,1,0]
    v_pk_mul_f32 v[198:199], v[44:45], v[146:147] op_sel:[0,0] op_sel_hi:[0,1]
    v_pk_fma_f32 v[214:215], v[46:47], v[130:131], v[32:33] op_sel:[0,0,0] op_sel_hi:[0,1,0]
    v_pk_fma_f32 v[166:167], v[46:47], v[134:135], v[32:33] op_sel:[0,0,0] op_sel_hi:[0,1,0]
    v_pk_fma_f32 v[182:183], v[46:47], v[138:139], v[32:33] op_sel:[0,0,0] op_sel_hi:[0,1,0]
    v_pk_fma_f32 v[200:201], v[104:105], v[44:45], v[196:197] op_sel:[0,1,0] op_sel_hi:[1,1,1]
    v_pk_fma_f32 v[216:217], v[108:109], v[46:47], v[212:213] op_sel:[0,1,0] op_sel_hi:[1,1,1]
    v_pk_fma_f32 v[168:169], v[112:113], v[46:47], v[164:165] op_sel:[0,1,0] op_sel_hi:[1,1,1]
    v_pk_fma_f32 v[184:185], v[116:117], v[46:47], v[180:181] op_sel:[0,1,0] op_sel_hi:[1,1,1]
    v_pk_fma_f32 v[202:203], v[106:107], v[44:45], v[198:199] op_sel:[0,1,0] op_sel_hi:[1,1,1]
    v_pk_fma_f32 v[218:219], v[110:111], v[46:47], v[214:215] op_sel:[0,1,0] op_sel_hi:[1,1,1]
    v_pk_fma_f32 v[170:171], v[114:115], v[46:47], v[166:167] op_sel:[0,1,0] op_sel_hi:[1,1,1]
    v_pk_fma_f32 v[186:187], v[118:119], v[46:47], v[182:183] op_sel:[0,1,0] op_sel_hi:[1,1,1]
    v_cvt_pk_bf16_f32 v208, v200, v201
    v_pk_fma_f32 v[220:221], v[216:217], v[34:35], v[32:33] op_sel:[0,0,1] op_sel_hi:[1,0,1]
    v_pk_fma_f32 v[172:173], v[168:169], v[34:35], v[32:33] op_sel:[0,0,1] op_sel_hi:[1,0,1]
    v_pk_fma_f32 v[188:189], v[184:185], v[34:35], v[32:33] op_sel:[0,0,1] op_sel_hi:[1,0,1]
    v_cvt_pk_bf16_f32 v209, v202, v203
    v_pk_fma_f32 v[222:223], v[218:219], v[34:35], v[32:33] op_sel:[0,0,1] op_sel_hi:[1,0,1]
    v_pk_fma_f32 v[174:175], v[170:171], v[34:35], v[32:33] op_sel:[0,0,1] op_sel_hi:[1,0,1]
    v_pk_fma_f32 v[190:191], v[186:187], v[34:35], v[32:33] op_sel:[0,0,1] op_sel_hi:[1,0,1]
    ds_write_b64 v13, v[208:209] offset:128
    v_exp_f32 v220, v220 clamp
    v_exp_f32 v172, v172 clamp
    v_exp_f32 v188, v188 clamp
    v_max_f32 v212, v32, v216
    v_max_f32 v164, v32, v168
    v_max_f32_e64 v180, v32, v184
    v_exp_f32 v221, v221 clamp
    v_exp_f32 v173, v173 clamp
    v_exp_f32 v189, v189 clamp
    v_max_f32 v213, v32, v217
    v_max_f32 v165, v32, v169
    v_max_f32_e64 v181, v32, v185
    v_exp_f32 v222, v222 clamp
    v_exp_f32 v174, v174 clamp
    v_exp_f32 v190, v190 clamp
    v_max_f32 v214, v32, v218
    v_max_f32 v166, v32, v170
    v_max_f32_e64 v182, v32, v186
    v_exp_f32 v223, v223 clamp
    v_exp_f32 v175, v175 clamp
    v_exp_f32 v191, v191 clamp
    v_max_f32 v215, v32, v219
    v_max_f32 v167, v32, v171
    v_max_f32_e64 v183, v32, v187
    v_pk_add_f32 v[212:213], v[212:213], v[220:221]
    v_pk_add_f32 v[164:165], v[164:165], v[172:173]
    v_pk_add_f32 v[180:181], v[180:181], v[188:189]
    v_pk_add_f32 v[214:215], v[214:215], v[222:223]
    v_pk_add_f32 v[166:167], v[166:167], v[174:175]
    v_pk_add_f32 v[182:183], v[182:183], v[190:191]
    v_cvt_pk_bf16_f32 v224, v212, v213
    v_cvt_pk_bf16_f32 v176, v164, v165
    v_sub_f32_e64 v184, v184, v32
    v_cvt_pk_bf16_f32 v225, v214, v215
    v_cvt_pk_bf16_f32 v177, v166, v167
    v_cndmask_b32 v180, v184, v180, s[84:85]
    ds_write_b64 v13, v[224:225] offset:2688
    ds_write_b64 v13, v[176:177] offset:2720
    v_sub_f32_e64 v185, v185, v32
    v_cndmask_b32 v181, v185, v181, s[84:85]
    v_sub_f32_e64 v186, v186, v32
    v_cndmask_b32 v182, v186, v182, s[84:85]
    v_sub_f32_e64 v187, v187, v32
    v_cndmask_b32 v183, v187, v183, s[84:85]
    v_cvt_pk_bf16_f32 v192, v180, v181
    v_cvt_pk_bf16_f32 v193, v182, v183
    ds_write_b64 v13, v[192:193] offset:2752
    v_pk_mul_f32 v[196:197], v[46:47], v[140:141] op_sel:[0,0] op_sel_hi:[0,1]
    v_pk_mul_f32 v[212:213], v[46:47], v[144:145] op_sel:[0,0] op_sel_hi:[0,1]
    v_pk_mul_f32 v[198:199], v[46:47], v[142:143] op_sel:[0,0] op_sel_hi:[0,1]
    v_pk_mul_f32 v[214:215], v[46:47], v[146:147] op_sel:[0,0] op_sel_hi:[0,1]
    v_pk_fma_f32 v[200:201], v[120:121], v[46:47], v[196:197] op_sel:[0,1,0] op_sel_hi:[1,1,1]
    v_pk_fma_f32 v[216:217], v[124:125], v[46:47], v[212:213] op_sel:[0,1,0] op_sel_hi:[1,1,1]
    v_pk_fma_f32 v[202:203], v[122:123], v[46:47], v[198:199] op_sel:[0,1,0] op_sel_hi:[1,1,1]
    v_pk_fma_f32 v[218:219], v[126:127], v[46:47], v[214:215] op_sel:[0,1,0] op_sel_hi:[1,1,1]
    v_cvt_pk_bf16_f32 v208, v200, v201
    v_cvt_pk_bf16_f32 v224, v216, v217
    v_cvt_pk_bf16_f32 v209, v202, v203
    v_cvt_pk_bf16_f32 v225, v218, v219
    ds_write_b64 v13, v[208:209] offset:2784
    ds_write_b64 v13, v[224:225] offset:2816
    s_branch L_k1_epi_j
L_k1_epi_wm1:
    s_nop 0
    v_pk_fma_f32 v[164:165], v[40:41], v[128:129], v[32:33] op_sel:[0,0,0] op_sel_hi:[0,1,0]
    v_pk_mul_f32 v[180:181], v[40:41], v[132:133] op_sel:[0,0] op_sel_hi:[0,1]
    v_pk_mul_f32 v[196:197], v[40:41], v[144:145] op_sel:[0,0] op_sel_hi:[0,1]
    v_pk_fma_f32 v[212:213], v[42:43], v[128:129], v[32:33] op_sel:[0,0,0] op_sel_hi:[0,1,0]
    v_pk_fma_f32 v[166:167], v[40:41], v[130:131], v[32:33] op_sel:[0,0,0] op_sel_hi:[0,1,0]
    v_pk_mul_f32 v[182:183], v[40:41], v[134:135] op_sel:[0,0] op_sel_hi:[0,1]
    v_pk_mul_f32 v[198:199], v[40:41], v[146:147] op_sel:[0,0] op_sel_hi:[0,1]
    v_pk_fma_f32 v[214:215], v[42:43], v[130:131], v[32:33] op_sel:[0,0,0] op_sel_hi:[0,1,0]
    v_pk_fma_f32 v[168:169], v[48:49], v[40:41], v[164:165] op_sel:[0,1,0] op_sel_hi:[1,1,1]
    v_pk_fma_f32 v[184:185], v[52:53], v[40:41], v[180:181] op_sel:[0,1,0] op_sel_hi:[1,1,1]
    v_pk_fma_f32 v[200:201], v[64:65], v[40:41], v[196:197] op_sel:[0,1,0] op_sel_hi:[1,1,1]
    v_pk_fma_f32 v[216:217], v[68:69], v[42:43], v[212:213] op_sel:[0,1,0] op_sel_hi:[1,1,1]
    v_pk_fma_f32 v[170:171], v[50:51], v[40:41], v[166:167] op_sel:[0,1,0] op_sel_hi:[1,1,1]
    v_pk_fma_f32 v[186:187], v[54:55], v[40:41], v[182:183] op_sel:[0,1,0] op_sel_hi:[1,1,1]
    v_pk_fma_f32 v[202:203], v[66:67], v[40:41], v[198:199] op_sel:[0,1,0] op_sel_hi:[1,1,1]
    v_pk_fma_f32 v[218:219], v[70:71], v[42:43], v[214:215] op_sel:[0,1,0] op_sel_hi:[1,1,1]
    v_pk_fma_f32 v[172:173], v[168:169], v[34:35], v[32:33] op_sel:[0,0,1] op_sel_hi:[1,0,1]
    v_cvt_pk_bf16_f32 v192, v184, v185
    v_cvt_pk_bf16_f32 v208, v200, v201
    v_pk_fma_f32 v[220:221], v[216:217], v[34:35], v[32:33] op_sel:[0,0,1] op_sel_hi:[1,0,1]
    v_pk_fma_f32 v[174:175], v[170:171], v[34:35], v[32:33] op_sel:[0,0,1] op_sel_hi:[1,0,1]
    v_cvt_pk_bf16_f32 v193, v186, v187
    v_cvt_pk_bf16_f32 v209, v202, v203
    v_pk_fma_f32 v[222:223], v[218:219], v[34:35], v[32:33] op_sel:[0,0,1] op_sel_hi:[1,0,1]
    v_exp_f32 v172, v172 clamp
    ds_write_b64 v12, v[192:193] offset:96
    ds_write_b64 v12, v[208:209] offset:128
    v_exp_f32 v220, v220 clamp
    v_max_f32 v164, v32, v168
    v_max_f32 v212, v32, v216
    v_exp_f32 v173, v173 clamp
    v_exp_f32 v221, v221 clamp
    v_max_f32 v165, v32, v169
    v_max_f32 v213, v32, v217
    v_exp_f32 v174, v174 clamp
    v_exp_f32 v222, v222 clamp
    v_max_f32 v166, v32, v170
    v_max_f32 v214, v32, v218
    v_exp_f32 v175, v175 clamp
    v_exp_f32 v223, v223 clamp
    v_max_f32 v167, v32, v171
    v_max_f32 v215, v32, v219
    v_pk_add_f32 v[164:165], v[164:165], v[172:173]
    v_pk_add_f32 v[212:213], v[212:213], v[220:221]
    v_pk_add_f32 v[166:167], v[166:167], v[174:175]
    v_pk_add_f32 v[214:215], v[214:215], v[222:223]
    v_sub_f32 v168, v168, v32
    v_sub_f32 v216, v216, v32
    v_cndmask_b32 v164, v168, v164, s[84:85]
    v_cndmask_b32 v212, v216, v212, s[84:85]
    v_sub_f32 v169, v169, v32
    v_sub_f32 v217, v217, v32
    v_cndmask_b32 v165, v169, v165, s[84:85]
    v_cndmask_b32 v213, v217, v213, s[84:85]
    v_sub_f32 v170, v170, v32
    v_sub_f32 v218, v218, v32
    v_cndmask_b32 v166, v170, v166, s[84:85]
    v_cndmask_b32 v214, v218, v214, s[84:85]
    v_sub_f32 v171, v171, v32
    v_sub_f32 v219, v219, v32
    v_cndmask_b32 v167, v171, v167, s[84:85]
    v_cndmask_b32 v215, v219, v215, s[84:85]
    v_cvt_pk_bf16_f32 v176, v164, v165
    v_cvt_pk_bf16_f32 v224, v212, v213
    v_cvt_pk_bf16_f32 v177, v166, v167
    v_cvt_pk_bf16_f32 v225, v214, v215
    ds_write_b64 v12, v[176:177] offset:64
    ds_write_b64 v12, v[224:225] offset:2752
    v_pk_mul_f32 v[164:165], v[42:43], v[132:133] op_sel:[0,0] op_sel_hi:[0,1]
    v_pk_mul_f32 v[180:181], v[42:43], v[144:145] op_sel:[0,0] op_sel_hi:[0,1]
    v_pk_mul_f32 v[166:167], v[42:43], v[134:135] op_sel:[0,0] op_sel_hi:[0,1]
    v_pk_mul_f32 v[182:183], v[42:43], v[146:147] op_sel:[0,0] op_sel_hi:[0,1]
    v_pk_fma_f32 v[168:169], v[72:73], v[42:43], v[164:165] op_sel:[0,1,0] op_sel_hi:[1,1,1]
    v_pk_fma_f32 v[184:185], v[84:85], v[42:43], v[180:181] op_sel:[0,1,0] op_sel_hi:[1,1,1]
    v_pk_fma_f32 v[170:171], v[74:75], v[42:43], v[166:167] op_sel:[0,1,0] op_sel_hi:[1,1,1]
    v_pk_fma_f32 v[186:187], v[86:87], v[42:43], v[182:183] op_sel:[0,1,0] op_sel_hi:[1,1,1]
    v_cvt_pk_bf16_f32 v176, v168, v169
    v_cvt_pk_bf16_f32 v192, v184, v185
    v_cvt_pk_bf16_f32 v177, v170, v171
    v_cvt_pk_bf16_f32 v193, v186, v187
    ds_write_b64 v12, v[176:177] offset:2784
    ds_write_b64 v12, v[192:193] offset:2816
    s_waitcnt lgkmcnt(10)
    s_nop 0
    v_pk_fma_f32 v[196:197], v[40:41], v[136:137], v[32:33] op_sel:[0,0,0] op_sel_hi:[0,1,0]
    v_pk_fma_f32 v[212:213], v[40:41], v[140:141], v[32:33] op_sel:[0,0,0] op_sel_hi:[0,1,0]
    v_pk_fma_f32 v[164:165], v[42:43], v[136:137], v[32:33] op_sel:[0,0,0] op_sel_hi:[0,1,0]
    v_pk_fma_f32 v[180:181], v[42:43], v[140:141], v[32:33] op_sel:[0,0,0] op_sel_hi:[0,1,0]
    v_pk_fma_f32 v[198:199], v[40:41], v[138:139], v[32:33] op_sel:[0,0,0] op_sel_hi:[0,1,0]
    v_pk_fma_f32 v[214:215], v[40:41], v[142:143], v[32:33] op_sel:[0,0,0] op_sel_hi:[0,1,0]
    v_pk_fma_f32 v[166:167], v[42:43], v[138:139], v[32:33] op_sel:[0,0,0] op_sel_hi:[0,1,0]
    v_pk_fma_f32 v[182:183], v[42:43], v[142:143], v[32:33] op_sel:[0,0,0] op_sel_hi:[0,1,0]
    v_pk_fma_f32 v[200:201], v[56:57], v[40:41], v[196:197] op_sel:[0,1,0] op_sel_hi:[1,1,1]
    v_pk_fma_f32 v[216:217], v[60:61], v[40:41], v[212:213] op_sel:[0,1,0] op_sel_hi:[1,1,1]
    v_pk_fma_f32 v[168:169], v[76:77], v[42:43], v[164:165] op_sel:[0,1,0] op_sel_hi:[1,1,1]
    v_pk_fma_f32 v[184:185], v[80:81], v[42:43], v[180:181] op_sel:[0,1,0] op_sel_hi:[1,1,1]
    v_pk_fma_f32 v[202:203], v[58:59], v[40:41], v[198:199] op_sel:[0,1,0] op_sel_hi:[1,1,1]
    v_pk_fma_f32 v[218:219], v[62:63], v[40:41], v[214:215] op_sel:[0,1,0] op_sel_hi:[1,1,1]
    v_pk_fma_f32 v[170:171], v[78:79], v[42:43], v[166:167] op_sel:[0,1,0] op_sel_hi:[1,1,1]
    v_pk_fma_f32 v[186:187], v[82:83], v[42:43], v[182:183] op_sel:[0,1,0] op_sel_hi:[1,1,1]
    v_pk_fma_f32 v[204:205], v[200:201], v[34:35], v[32:33] op_sel:[0,0,1] op_sel_hi:[1,0,1]
    v_pk_fma_f32 v[220:221], v[216:217], v[34:35], v[32:33] op_sel:[0,0,1] op_sel_hi:[1,0,1]
    v_pk_fma_f32 v[172:173], v[168:169], v[34:35], v[32:33] op_sel:[0,0,1] op_sel_hi:[1,0,1]
    v_pk_fma_f32 v[188:189], v[184:185], v[34:35], v[32:33] op_sel:[0,0,1] op_sel_hi:[1,0,1]
    v_pk_fma_f32 v[206:207], v[202:203], v[34:35], v[32:33] op_sel:[0,0,1] op_sel_hi:[1,0,1]
    v_pk_fma_f32 v[222:223], v[218:219], v[34:35], v[32:33] op_sel:[0,0,1] op_sel_hi:[1,0,1]
    v_pk_fma_f32 v[174:175], v[170:171], v[34:35], v[32:33] op_sel:[0,0,1] op_sel_hi:[1,0,1]
    v_pk_fma_f32 v[190:191], v[186:187], v[34:35], v[32:33] op_sel:[0,0,1] op_sel_hi:[1,0,1]
    v_exp_f32 v204, v204 clamp
    v_exp_f32 v220, v220 clamp
    v_exp_f32 v172, v172 clamp
    v_exp_f32 v188, v188 clamp
    v_max_f32 v196, v32, v200
    v_max_f32 v212, v32, v216
    v_max_f32 v164, v32, v168
    v_max_f32 v180, v32, v184
    v_exp_f32 v205, v205 clamp
    v_exp_f32 v221, v221 clamp
    v_exp_f32 v173, v173 clamp
    v_exp_f32 v189, v189 clamp
    v_max_f32 v197, v32, v201
    v_max_f32 v213, v32, v217
    v_max_f32 v165, v32, v169
    v_max_f32 v181, v32, v185
    v_exp_f32 v206, v206 clamp
    v_exp_f32 v222, v222 clamp
    v_exp_f32 v174, v174 clamp
    v_exp_f32 v190, v190 clamp
    v_max_f32 v198, v32, v202
    v_max_f32 v214, v32, v218
    v_max_f32 v166, v32, v170
    v_max_f32 v182, v32, v186
    v_exp_f32 v207, v207 clamp
    v_exp_f32 v223, v223 clamp
    v_exp_f32 v175, v175 clamp
    v_exp_f32 v191, v191 clamp
    v_max_f32 v199, v32, v203
    v_max_f32 v215, v32, v219
    v_max_f32 v167, v32, v171
    v_max_f32 v183, v32, v187
    v_pk_add_f32 v[196:197], v[196:197], v[204:205]
    v_pk_add_f32 v[212:213], v[212:213], v[220:221]
    v_pk_add_f32 v[164:165], v[164:165], v[172:173]
    v_pk_add_f32 v[180:181], v[180:181], v[188:189]
    v_pk_add_f32 v[198:199], v[198:199], v[206:207]
    v_pk_add_f32 v[214:215], v[214:215], v[222:223]
    v_pk_add_f32 v[166:167], v[166:167], v[174:175]
    v_pk_add_f32 v[182:183], v[182:183], v[190:191]
    v_cvt_pk_bf16_f32 v208, v196, v197
    v_cvt_pk_bf16_f32 v224, v212, v213
    v_cvt_pk_bf16_f32 v176, v164, v165
    v_cvt_pk_bf16_f32 v192, v180, v181
    v_cvt_pk_bf16_f32 v209, v198, v199
    v_cvt_pk_bf16_f32 v225, v214, v215
    v_cvt_pk_bf16_f32 v177, v166, v167
    v_cvt_pk_bf16_f32 v193, v182, v183
    ds_write_b64 v12, v[208:209]
    ds_write_b64 v12, v[224:225] offset:32
    ds_write_b64 v12, v[176:177] offset:2688
    ds_write_b64 v12, v[192:193] offset:2720
    v_pk_fma_f32 v[196:197], v[44:45], v[128:129], v[32:33] op_sel:[0,0,0] op_sel_hi:[0,1,0]
    v_pk_mul_f32 v[212:213], v[44:45], v[132:133] op_sel:[0,0] op_sel_hi:[0,1]
    v_pk_fma_f32 v[164:165], v[44:45], v[136:137], v[32:33] op_sel:[0,0,0] op_sel_hi:[0,1,0]
    v_pk_fma_f32 v[180:181], v[44:45], v[140:141], v[32:33] op_sel:[0,0,0] op_sel_hi:[0,1,0]
    v_pk_fma_f32 v[198:199], v[44:45], v[130:131], v[32:33] op_sel:[0,0,0] op_sel_hi:[0,1,0]
    v_pk_mul_f32 v[214:215], v[44:45], v[134:135] op_sel:[0,0] op_sel_hi:[0,1]
    v_pk_fma_f32 v[166:167], v[44:45], v[138:139], v[32:33] op_sel:[0,0,0] op_sel_hi:[0,1,0]
    v_pk_fma_f32 v[182:183], v[44:45], v[142:143], v[32:33] op_sel:[0,0,0] op_sel_hi:[0,1,0]
    v_pk_fma_f32 v[200:201], v[88:89], v[44:45], v[196:197] op_sel:[0,1,0] op_sel_hi:[1,1,1]
    v_pk_fma_f32 v[216:217], v[92:93], v[44:45], v[212:213] op_sel:[0,1,0] op_sel_hi:[1,1,1]
    v_pk_fma_f32 v[168:169], v[96:97], v[44:45], v[164:165] op_sel:[0,1,0] op_sel_hi:[1,1,1]
    v_pk_fma_f32 v[184:185], v[100:101], v[44:45], v[180:181] op_sel:[0,1,0] op_sel_hi:[1,1,1]
    v_pk_fma_f32 v[202:203], v[90:91], v[44:45], v[198:199] op_sel:[0,1,0] op_sel_hi:[1,1,1]
    v_pk_fma_f32 v[218:219], v[94:95], v[44:45], v[214:215] op_sel:[0,1,0] op_sel_hi:[1,1,1]
    v_pk_fma_f32 v[170:171], v[98:99], v[44:45], v[166:167] op_sel:[0,1,0] op_sel_hi:[1,1,1]
    v_pk_fma_f32 v[186:187], v[102:103], v[44:45], v[182:183] op_sel:[0,1,0] op_sel_hi:[1,1,1]
    v_pk_fma_f32 v[204:205], v[200:201], v[34:35], v[32:33] op_sel:[0,0,1] op_sel_hi:[1,0,1]
    v_cvt_pk_bf16_f32 v224, v216, v217
    v_pk_fma_f32 v[172:173], v[168:169], v[34:35], v[32:33] op_sel:[0,0,1] op_sel_hi:[1,0,1]
    v_pk_fma_f32 v[188:189], v[184:185], v[34:35], v[32:33] op_sel:[0,0,1] op_sel_hi:[1,0,1]
    v_pk_fma_f32 v[206:207], v[202:203], v[34:35], v[32:33] op_sel:[0,0,1] op_sel_hi:[1,0,1]
    v_cvt_pk_bf16_f32 v225, v218, v219
    v_pk_fma_f32 v[174:175], v[170:171], v[34:35], v[32:33] op_sel:[0,0,1] op_sel_hi:[1,0,1]
    v_pk_fma_f32 v[190:191], v[186:187], v[34:35], v[32:33] op_sel:[0,0,1] op_sel_hi:[1,0,1]
    v_exp_f32 v204, v204 clamp
    ds_write_b64 v13, v[224:225] offset:96
    v_exp_f32 v172, v172 clamp
    v_exp_f32 v188, v188 clamp
    v_max_f32 v196, v32, v200
    v_max_f32 v164, v32, v168
    v_max_f32_e64 v180, v32, v184
    v_exp_f32 v205, v205 clamp
    v_exp_f32 v173, v173 clamp
    v_exp_f32 v189, v189 clamp
    v_max_f32 v197, v32, v201
    v_max_f32 v165, v32, v169
    v_max_f32_e64 v181, v32, v185
    v_exp_f32 v206, v206 clamp
    v_exp_f32 v174, v174 clamp
    v_exp_f32 v190, v190 clamp
    v_max_f32 v198, v32, v202
    v_max_f32 v166, v32, v170
    v_max_f32_e64 v182, v32, v186
    v_exp_f32 v207, v207 clamp
    v_exp_f32 v175, v175 clamp
    v_exp_f32 v191, v191 clamp
    v_max_f32 v199, v32, v203
    v_max_f32 v167, v32, v171
    v_max_f32_e64 v183, v32, v187
    v_pk_add_f32 v[196:197], v[196:197], v[204:205]
    v_pk_add_f32 v[164:165], v[164:165], v[172:173]
    v_pk_add_f32 v[180:181], v[180:181], v[188:189]
    v_pk_add_f32 v[198:199], v[198:199], v[206:207]
    v_pk_add_f32 v[166:167], v[166:167], v[174:175]
    v_pk_add_f32 v[182:183], v[182:183], v[190:191]
    v_sub_f32_e64 v200, v200, v32
    v_cvt_pk_bf16_f32 v176, v164, v165
    v_cvt_pk_bf16_f32 v192, v180, v181
    v_cndmask_b32 v196, v200, v196, s[84:85]
    v_cvt_pk_bf16_f32 v177, v166, v167
    v_cvt_pk_bf16_f32 v193, v182, v183
    v_sub_f32_e64 v201, v201, v32
    ds_write_b64 v13, v[176:177]
    ds_write_b64 v13, v[192:193] offset:32
    v_cndmask_b32 v197, v201, v197, s[84:85]
    v_sub_f32_e64 v202, v202, v32
    v_cndmask_b32 v198, v202, v198, s[84:85]
    v_sub_f32_e64 v203, v203, v32
    v_cndmask_b32 v199, v203, v199, s[84:85]
    v_cvt_pk_bf16_f32 v208, v196, v197
    v_cvt_pk_bf16_f32 v209, v198, v199
    ds_write_b64 v13, v[208:209] offset:64
    v_pk_mul_f32 v[196:197], v[44:45], v[144:145] op_sel:[0,0] op_sel_hi:[0,1]
    v_pk_fma_f32 v[212:213], v[46:47], v[128:129], v[32:33] op_sel:[0,0,0] op_sel_hi:[0,1,0]
    v_pk_mul_f32 v[164:165], v[46:47], v[132:133] op_sel:[0,0] op_sel_hi:[0,1]
    v_pk_fma_f32 v[180:181], v[46:47], v[136:137], v[32:33] op_sel:[0,0,0] op_sel_hi:[0,1,0]
    v_pk_mul_f32 v[198:199], v[44:45], v[146:147] op_sel:[0,0] op_sel_hi:[0,1]
    v_pk_fma_f32 v[214:215], v[46:47], v[130:131], v[32:33] op_sel:[0,0,0] op_sel_hi:[0,1,0]
    v_pk_mul_f32 v[166:167], v[46:47], v[134:135] op_sel:[0,0] op_sel_hi:[0,1]
    v_pk_fma_f32 v[182:183], v[46:47], v[138:139], v[32:33] op_sel:[0,0,0] op_sel_hi:[0,1,0]
    v_pk_fma_f32 v[200:201], v[104:105], v[44:45], v[196:197] op_sel:[0,1,0] op_sel_hi:[1,1,1]
    v_pk_fma_f32 v[216:217], v[108:109], v[46:47], v[212:213] op_sel:[0,1,0] op_sel_hi:[1,1,1]
    v_pk_fma_f32 v[168:169], v[112:113], v[46:47], v[164:165] op_sel:[0,1,0] op_sel_hi:[1,1,1]
    v_pk_fma_f32 v[184:185], v[116:117], v[46:47], v[180:181] op_sel:[0,1,0] op_sel_hi:[1,1,1]
    v_pk_fma_f32 v[202:203], v[106:107], v[44:45], v[198:199] op_sel:[0,1,0] op_sel_hi:[1,1,1]
    v_pk_fma_f32 v[218:219], v[110:111], v[46:47], v[214:215] op_sel:[0,1,0] op_sel_hi:[1,1,1]
    v_pk_fma_f32 v[170:171], v[114:115], v[46:47], v[166:167] op_sel:[0,1,0] op_sel_hi:[1,1,1]
    v_pk_fma_f32 v[186:187], v[118:119], v[46:47], v[182:183] op_sel:[0,1,0] op_sel_hi:[1,1,1]
    v_cvt_pk_bf16_f32 v208, v200, v201
    v_pk_fma_f32 v[220:221], v[216:217], v[34:35], v[32:33] op_sel:[0,0,1] op_sel_hi:[1,0,1]
    v_cvt_pk_bf16_f32 v176, v168, v169
    v_pk_fma_f32 v[188:189], v[184:185], v[34:35], v[32:33] op_sel:[0,0,1] op_sel_hi:[1,0,1]
    v_cvt_pk_bf16_f32 v209, v202, v203
    v_pk_fma_f32 v[222:223], v[218:219], v[34:35], v[32:33] op_sel:[0,0,1] op_sel_hi:[1,0,1]
    v_cvt_pk_bf16_f32 v177, v170, v171
    v_pk_fma_f32 v[190:191], v[186:187], v[34:35], v[32:33] op_sel:[0,0,1] op_sel_hi:[1,0,1]
    ds_write_b64 v13, v[208:209] offset:128
    v_exp_f32 v220, v220 clamp
    ds_write_b64 v13, v[176:177] offset:2784
    v_exp_f32 v188, v188 clamp
    v_max_f32 v212, v32, v216
    v_max_f32 v180, v32, v184
    v_exp_f32 v221, v221 clamp
    v_exp_f32 v189, v189 clamp
    v_max_f32 v213, v32, v217
    v_max_f32 v181, v32, v185
    v_exp_f32 v222, v222 clamp
    v_exp_f32 v190, v190 clamp
    v_max_f32 v214, v32, v218
    v_max_f32 v182, v32, v186
    v_exp_f32 v223, v223 clamp
    v_exp_f32 v191, v191 clamp
    v_max_f32 v215, v32, v219
    v_max_f32 v183, v32, v187
    v_pk_add_f32 v[212:213], v[212:213], v[220:221]
    v_pk_add_f32 v[180:181], v[180:181], v[188:189]
    v_pk_add_f32 v[214:215], v[214:215], v[222:223]
    v_pk_add_f32 v[182:183], v[182:183], v[190:191]
    v_sub_f32_e64 v216, v216, v32
    v_cvt_pk_bf16_f32 v192, v180, v181
    v_cndmask_b32 v212, v216, v212, s[84:85]
    v_cvt_pk_bf16_f32 v193, v182, v183
    v_sub_f32_e64 v217, v217, v32
    ds_write_b64 v13, v[192:193] offset:2688
    v_cndmask_b32 v213, v217, v213, s[84:85]
    v_sub_f32_e64 v218, v218, v32
    v_cndmask_b32 v214, v218, v214, s[84:85]
    v_sub_f32_e64 v219, v219, v32
    v_cndmask_b32 v215, v219, v215, s[84:85]
    v_cvt_pk_bf16_f32 v224, v212, v213
    v_cvt_pk_bf16_f32 v225, v214, v215
    ds_write_b64 v13, v[224:225] offset:2752
    v_pk_fma_f32 v[196:197], v[46:47], v[140:141], v[32:33] op_sel:[0,0,0] op_sel_hi:[0,1,0]
    v_pk_mul_f32 v[212:213], v[46:47], v[144:145] op_sel:[0,0] op_sel_hi:[0,1]
    v_pk_fma_f32 v[198:199], v[46:47], v[142:143], v[32:33] op_sel:[0,0,0] op_sel_hi:[0,1,0]
    v_pk_mul_f32 v[214:215], v[46:47], v[146:147] op_sel:[0,0] op_sel_hi:[0,1]
    v_pk_fma_f32 v[200:201], v[120:121], v[46:47], v[196:197] op_sel:[0,1,0] op_sel_hi:[1,1,1]
    v_pk_fma_f32 v[216:217], v[124:125], v[46:47], v[212:213] op_sel:[0,1,0] op_sel_hi:[1,1,1]
    v_pk_fma_f32 v[202:203], v[122:123], v[46:47], v[198:199] op_sel:[0,1,0] op_sel_hi:[1,1,1]
    v_pk_fma_f32 v[218:219], v[126:127], v[46:47], v[214:215] op_sel:[0,1,0] op_sel_hi:[1,1,1]
    v_pk_fma_f32 v[204:205], v[200:201], v[34:35], v[32:33] op_sel:[0,0,1] op_sel_hi:[1,0,1]
    v_cvt_pk_bf16_f32 v224, v216, v217
    v_pk_fma_f32 v[206:207], v[202:203], v[34:35], v[32:33] op_sel:[0,0,1] op_sel_hi:[1,0,1]
    v_cvt_pk_bf16_f32 v225, v218, v219
    v_exp_f32 v204, v204 clamp
    ds_write_b64 v13, v[224:225] offset:2816
    v_max_f32_e64 v196, v32, v200
    v_exp_f32 v205, v205 clamp
    v_max_f32_e64 v197, v32, v201
    v_exp_f32 v206, v206 clamp
    v_max_f32_e64 v198, v32, v202
    v_exp_f32 v207, v207 clamp
    v_max_f32_e64 v199, v32, v203
    v_pk_add_f32 v[196:197], v[196:197], v[204:205]
    v_pk_add_f32 v[198:199], v[198:199], v[206:207]
    v_cvt_pk_bf16_f32 v208, v196, v197
    v_cvt_pk_bf16_f32 v209, v198, v199
    ds_write_b64 v13, v[208:209] offset:2720
L_k1_epi_j:
    s_waitcnt lgkmcnt(0)
    s_barrier
    ds_read_b64_tr_b16 v[48:49], v16
    ds_read_b64_tr_b16 v[64:65], v17
    ds_read_b64_tr_b16 v[80:81], v18
    ds_read_b64_tr_b16 v[50:51], v16 offset:336
    ds_read_b64_tr_b16 v[66:67], v17 offset:336
    ds_read_b64_tr_b16 v[82:83], v18 offset:336
    ds_read_b64_tr_b16 v[52:53], v16 offset:5376
    ds_read_b64_tr_b16 v[68:69], v17 offset:5376
    ds_read_b64_tr_b16 v[84:85], v18 offset:5376
    ds_read_b64_tr_b16 v[54:55], v16 offset:5712
    ds_read_b64_tr_b16 v[70:71], v17 offset:5712
    ds_read_b64_tr_b16 v[86:87], v18 offset:5712
    s_waitcnt lgkmcnt(6)
    s_nop 0
    v_mfma_f32_16x16x32_bf16 v[144:147], v[48:51], v[64:67], 0
    v_mfma_f32_16x16x32_bf16 v[148:151], v[48:51], v[80:83], 0
    ds_read_b64_tr_b16 v[56:57], v16 offset:10752
    ds_read_b64_tr_b16 v[72:73], v17 offset:10752
    ds_read_b64_tr_b16 v[88:89], v18 offset:10752
    ds_read_b64_tr_b16 v[58:59], v16 offset:11088
    ds_read_b64_tr_b16 v[74:75], v17 offset:11088
    ds_read_b64_tr_b16 v[90:91], v18 offset:11088
    s_waitcnt lgkmcnt(6)
    s_nop 0
    v_mfma_f32_16x16x32_bf16 v[144:147], v[52:55], v[68:71], v[144:147]
    v_mfma_f32_16x16x32_bf16 v[148:151], v[52:55], v[84:87], v[148:151]
    ds_read_b64_tr_b16 v[60:61], v16 offset:16128
    ds_read_b64_tr_b16 v[76:77], v17 offset:16128
    ds_read_b64_tr_b16 v[92:93], v18 offset:16128
    ds_read_b64_tr_b16 v[62:63], v16 offset:16464
    ds_read_b64_tr_b16 v[78:79], v17 offset:16464
    ds_read_b64_tr_b16 v[94:95], v18 offset:16464
    s_waitcnt lgkmcnt(6)
    s_nop 0
    v_mfma_f32_16x16x32_bf16 v[144:147], v[56:59], v[72:75], v[144:147]
    v_mfma_f32_16x16x32_bf16 v[148:151], v[56:59], v[88:91], v[148:151]
    ds_read_b64_tr_b16 v[96:97], v16 offset:21504
    ds_read_b64_tr_b16 v[112:113], v17 offset:21504
    ds_read_b64_tr_b16 v[128:129], v18 offset:21504
    ds_read_b64_tr_b16 v[98:99], v16 offset:21840
    ds_read_b64_tr_b16 v[114:115], v17 offset:21840
    ds_read_b64_tr_b16 v[130:131], v18 offset:21840
    s_waitcnt lgkmcnt(6)
    s_nop 0
    v_mfma_f32_16x16x32_bf16 v[144:147], v[60:63], v[76:79], v[144:147]
    v_mfma_f32_16x16x32_bf16 v[148:151], v[60:63], v[92:95], v[148:151]
    ds_read_b64_tr_b16 v[100:101], v16 offset:26880
    ds_read_b64_tr_b16 v[116:117], v17 offset:26880
    ds_read_b64_tr_b16 v[132:133], v18 offset:26880
    ds_read_b64_tr_b16 v[102:103], v16 offset:27216
    ds_read_b64_tr_b16 v[118:119], v17 offset:27216
    ds_read_b64_tr_b16 v[134:135], v18 offset:27216
    s_waitcnt lgkmcnt(6)
    s_nop 0
    v_mfma_f32_16x16x32_bf16 v[152:155], v[96:99], v[112:115], 0
    v_mfma_f32_16x16x32_bf16 v[156:159], v[96:99], v[128:131], 0
    ds_read_b64_tr_b16 v[104:105], v16 offset:32256
    ds_read_b64_tr_b16 v[120:121], v17 offset:32256
    ds_read_b64_tr_b16 v[136:137], v18 offset:32256
    ds_read_b64_tr_b16 v[106:107], v16 offset:32592
    ds_read_b64_tr_b16 v[122:123], v17 offset:32592
    ds_read_b64_tr_b16 v[138:139], v18 offset:32592
    s_waitcnt lgkmcnt(6)
    s_nop 0
    v_mfma_f32_16x16x32_bf16 v[152:155], v[100:103], v[116:119], v[152:155]
    v_mfma_f32_16x16x32_bf16 v[156:159], v[100:103], v[132:135], v[156:159]
    ds_read_b64_tr_b16 v[108:109], v16 offset:37632
    ds_read_b64_tr_b16 v[124:125], v17 offset:37632
    ds_read_b64_tr_b16 v[140:141], v18 offset:37632
    ds_read_b64_tr_b16 v[110:111], v16 offset:37968
    ds_read_b64_tr_b16 v[126:127], v17 offset:37968
    ds_read_b64_tr_b16 v[142:143], v18 offset:37968
    s_waitcnt lgkmcnt(6)
    v_mfma_f32_16x16x32_bf16 v[152:155], v[104:107], v[120:123], v[152:155]
    v_mfma_f32_16x16x32_bf16 v[156:159], v[104:107], v[136:139], v[156:159]
    s_waitcnt lgkmcnt(0)
    v_mfma_f32_16x16x32_bf16 v[152:155], v[108:111], v[124:127], v[152:155]
    v_mfma_f32_16x16x32_bf16 v[156:159], v[108:111], v[140:143], v[156:159]
    ds_write_b32 v19, v144
    ds_write_b32 v20, v148
    ds_write_b32 v238, v145 offset:80
    ds_write_b32 v239, v149 offset:80
    ds_write_b32 v238, v146 offset:160
    ds_write_b32 v239, v150 offset:160
    ds_write_b32 v238, v147 offset:240
    ds_write_b32 v239, v151 offset:240
    ds_write_b32 v19, v152 offset:3360
    ds_write_b32 v20, v156 offset:3360
    ds_write_b32 v238, v153 offset:3440
    ds_write_b32 v239, v157 offset:3440
    ds_write_b32 v238, v154 offset:3520
    ds_write_b32 v239, v158 offset:3520
    ds_write_b32 v238, v155 offset:3600
    ds_write_b32 v239, v159 offset:3600
    s_waitcnt lgkmcnt(0)
    s_barrier
    ds_read_b32 v48, v37
    ds_read_b32 v49, v37 offset:256
    ds_read_b32 v50, v37 offset:512
    ds_read_b32 v51, v37 offset:768
    ds_read_b32 v52, v37 offset:1024
    ds_read_b32 v53, v37 offset:1280
    ds_read_b32 v54, v37 offset:1536
    s_add_u32 s4, s50, 0
    s_addc_u32 s5, s51, 0
    s_mov_b32 s6, 0
    s_mov_b32 s7, 0x20000
    s_add_u32 s4, s4, s67
    s_addc_u32 s5, s5, 0
    s_mov_b32 s6, 0x1a40
    s_waitcnt vmcnt(0)
    v_readfirstlane_b32 s69, v26
    s_mov_b32 s57, 0
L_k1_poll:
    s_nop 0
    s_cmp_lg_u32 s69, 0
    s_cbranch_scc1 L_k1_go
    s_sleep 2
    buffer_load_dword v26, v25, s[16:19], s70 offen sc0 sc1
    s_waitcnt vmcnt(0)
    v_readfirstlane_b32 s69, v26
    s_add_u32 s57, s57, 1
    s_nop 1
    s_cmp_lt_u32 s57, 0x61a80
    s_cbranch_scc1 L_k1_poll
L_k1_go:
    s_nop 7
    s_waitcnt lgkmcnt(6)
    buffer_atomic_add_f32 v48, v36, s[4:7], 0 offen
    s_waitcnt lgkmcnt(5)
    buffer_atomic_add_f32 v49, v36, s[4:7], 0 offen offset:256
    s_waitcnt lgkmcnt(4)
    buffer_atomic_add_f32 v50, v36, s[4:7], 0 offen offset:512
    s_waitcnt lgkmcnt(3)
    buffer_atomic_add_f32 v51, v36, s[4:7], 0 offen offset:768
    s_waitcnt lgkmcnt(2)
    buffer_atomic_add_f32 v52, v36, s[4:7], 0 offen offset:1024
    s_waitcnt lgkmcnt(1)
    buffer_atomic_add_f32 v53, v36, s[4:7], 0 offen offset:1280
    s_waitcnt lgkmcnt(0)
    buffer_atomic_add_f32 v54, v36, s[4:7], 0 offen offset:1536
    s_branch L_k1_fin
L_k1_epiq:
    v_pk_fma_f32 v[164:165], v[40:41], v[128:129], v[32:33] op_sel:[0,0,0] op_sel_hi:[0,1,0]
    v_pk_fma_f32 v[180:181], v[40:41], v[132:133], v[32:33] op_sel:[0,0,0] op_sel_hi:[0,1,0]
    v_pk_fma_f32 v[196:197], v[40:41], v[144:145], v[32:33] op_sel:[0,0,0] op_sel_hi:[0,1,0]
    v_pk_fma_f32 v[212:213], v[42:43], v[128:129], v[32:33] op_sel:[0,0,0] op_sel_hi:[0,1,0]
    v_pk_fma_f32 v[166:167], v[40:41], v[130:131], v[32:33] op_sel:[0,0,0] op_sel_hi:[0,1,0]
    v_pk_fma_f32 v[182:183], v[40:41], v[134:135], v[32:33] op_sel:[0,0,0] op_sel_hi:[0,1,0]
    v_pk_fma_f32 v[198:199], v[40:41], v[146:147], v[32:33] op_sel:[0,0,0] op_sel_hi:[0,1,0]
    v_pk_fma_f32 v[214:215], v[42:43], v[130:131], v[32:33] op_sel:[0,0,0] op_sel_hi:[0,1,0]
    v_pk_fma_f32 v[168:169], v[48:49], v[40:41], v[164:165] op_sel:[0,1,0] op_sel_hi:[1,1,1]
    v_pk_fma_f32 v[184:185], v[52:53], v[40:41], v[180:181] op_sel:[0,1,0] op_sel_hi:[1,1,1]
    v_pk_fma_f32 v[200:201], v[64:65], v[40:41], v[196:197] op_sel:[0,1,0] op_sel_hi:[1,1,1]
    v_pk_fma_f32 v[216:217], v[68:69], v[42:43], v[212:213] op_sel:[0,1,0] op_sel_hi:[1,1,1]
    v_pk_fma_f32 v[170:171], v[50:51], v[40:41], v[166:167] op_sel:[0,1,0] op_sel_hi:[1,1,1]
    v_pk_fma_f32 v[186:187], v[54:55], v[40:41], v[182:183] op_sel:[0,1,0] op_sel_hi:[1,1,1]
    v_pk_fma_f32 v[202:203], v[66:67], v[40:41], v[198:199] op_sel:[0,1,0] op_sel_hi:[1,1,1]
    v_pk_fma_f32 v[218:219], v[70:71], v[42:43], v[214:215] op_sel:[0,1,0] op_sel_hi:[1,1,1]
    v_pk_fma_f32 v[172:173], v[168:169], v[34:35], v[32:33] op_sel:[0,0,1] op_sel_hi:[1,0,1]
    v_pk_fma_f32 v[188:189], v[184:185], v[34:35], v[32:33] op_sel:[0,0,1] op_sel_hi:[1,0,1]
    v_pk_fma_f32 v[204:205], v[200:201], v[34:35], v[32:33] op_sel:[0,0,1] op_sel_hi:[1,0,1]
    v_pk_fma_f32 v[220:221], v[216:217], v[34:35], v[32:33] op_sel:[0,0,1] op_sel_hi:[1,0,1]
    v_pk_fma_f32 v[174:175], v[170:171], v[34:35], v[32:33] op_sel:[0,0,1] op_sel_hi:[1,0,1]
    v_pk_fma_f32 v[190:191], v[186:187], v[34:35], v[32:33] op_sel:[0,0,1] op_sel_hi:[1,0,1]
    v_pk_fma_f32 v[206:207], v[202:203], v[34:35], v[32:33] op_sel:[0,0,1] op_sel_hi:[1,0,1]
    v_pk_fma_f32 v[222:223], v[218:219], v[34:35], v[32:33] op_sel:[0,0,1] op_sel_hi:[1,0,1]
    v_exp_f32 v172, v172 clamp
    v_exp_f32 v188, v188 clamp
    v_exp_f32 v204, v204 clamp
    v_exp_f32 v220, v220 clamp
    v_max_f32 v164, v32, v168
    v_max_f32 v180, v32, v184
    v_max_f32 v196, v32, v200
    v_max_f32 v212, v32, v216
    v_exp_f32 v173, v173 clamp
    v_exp_f32 v189, v189 clamp
    v_exp_f32 v205, v205 clamp
    v_exp_f32 v221, v221 clamp
    v_max_f32 v165, v32, v169
    v_max_f32 v181, v32, v185
    v_max_f32 v197, v32, v201
    v_max_f32 v213, v32, v217
    v_exp_f32 v174, v174 clamp
    v_exp_f32 v190, v190 clamp
    v_exp_f32 v206, v206 clamp
    v_exp_f32 v222, v222 clamp
    v_max_f32 v166, v32, v170
    v_max_f32 v182, v32, v186
    v_max_f32 v198, v32, v202
    v_max_f32 v214, v32, v218
    v_exp_f32 v175, v175 clamp
    v_exp_f32 v191, v191 clamp
    v_exp_f32 v207, v207 clamp
    v_exp_f32 v223, v223 clamp
    v_max_f32 v167, v32, v171
    v_max_f32 v183, v32, v187
    v_max_f32 v199, v32, v203
    v_max_f32 v215, v32, v219
    v_pk_add_f32 v[164:165], v[164:165], v[172:173]
    v_pk_add_f32 v[180:181], v[180:181], v[188:189]
    v_pk_add_f32 v[196:197], v[196:197], v[204:205]
    v_pk_add_f32 v[212:213], v[212:213], v[220:221]
    v_pk_add_f32 v[166:167], v[166:167], v[174:175]
    v_pk_add_f32 v[182:183], v[182:183], v[190:191]
    v_pk_add_f32 v[198:199], v[198:199], v[206:207]
    v_pk_add_f32 v[214:215], v[214:215], v[222:223]
    v_cvt_pk_bf16_f32 v176, v164, v165
    v_cvt_pk_bf16_f32 v192, v180, v181
    v_cvt_pk_bf16_f32 v208, v196, v197
    v_cvt_pk_bf16_f32 v224, v212, v213
    v_cvt_pk_bf16_f32 v177, v166, v167
    v_cvt_pk_bf16_f32 v193, v182, v183
    v_cvt_pk_bf16_f32 v209, v198, v199
    v_cvt_pk_bf16_f32 v225, v214, v215
    buffer_store_dwordx2 v[176:177], v16, s[12:15], s72 offen
    buffer_store_dwordx2 v[192:193], v17, s[12:15], s72 offen
    buffer_store_dwordx2 v[208:209], v20, s[12:15], s72 offen
    buffer_store_dwordx2 v[224:225], v16, s[12:15], s72 offen offset:1024
    v_pk_fma_f32 v[164:165], v[42:43], v[132:133], v[32:33] op_sel:[0,0,0] op_sel_hi:[0,1,0]
    v_pk_fma_f32 v[180:181], v[42:43], v[144:145], v[32:33] op_sel:[0,0,0] op_sel_hi:[0,1,0]
    v_pk_fma_f32 v[166:167], v[42:43], v[134:135], v[32:33] op_sel:[0,0,0] op_sel_hi:[0,1,0]
    v_pk_fma_f32 v[182:183], v[42:43], v[146:147], v[32:33] op_sel:[0,0,0] op_sel_hi:[0,1,0]
    v_pk_fma_f32 v[168:169], v[72:73], v[42:43], v[164:165] op_sel:[0,1,0] op_sel_hi:[1,1,1]
    v_pk_fma_f32 v[184:185], v[84:85], v[42:43], v[180:181] op_sel:[0,1,0] op_sel_hi:[1,1,1]
    v_pk_fma_f32 v[170:171], v[74:75], v[42:43], v[166:167] op_sel:[0,1,0] op_sel_hi:[1,1,1]
    v_pk_fma_f32 v[186:187], v[86:87], v[42:43], v[182:183] op_sel:[0,1,0] op_sel_hi:[1,1,1]
    v_pk_fma_f32 v[172:173], v[168:169], v[34:35], v[32:33] op_sel:[0,0,1] op_sel_hi:[1,0,1]
    v_pk_fma_f32 v[188:189], v[184:185], v[34:35], v[32:33] op_sel:[0,0,1] op_sel_hi:[1,0,1]
    v_pk_fma_f32 v[174:175], v[170:171], v[34:35], v[32:33] op_sel:[0,0,1] op_sel_hi:[1,0,1]
    v_pk_fma_f32 v[190:191], v[186:187], v[34:35], v[32:33] op_sel:[0,0,1] op_sel_hi:[1,0,1]
    v_exp_f32 v172, v172 clamp
    v_exp_f32 v188, v188 clamp
    v_max_f32 v164, v32, v168
    v_max_f32 v180, v32, v184
    v_exp_f32 v173, v173 clamp
    v_exp_f32 v189, v189 clamp
    v_max_f32 v165, v32, v169
    v_max_f32 v181, v32, v185
    v_exp_f32 v174, v174 clamp
    v_exp_f32 v190, v190 clamp
    v_max_f32 v166, v32, v170
    v_max_f32 v182, v32, v186
    v_exp_f32 v175, v175 clamp
    v_exp_f32 v191, v191 clamp
    v_max_f32 v167, v32, v171
    v_max_f32 v183, v32, v187
    v_pk_add_f32 v[164:165], v[164:165], v[172:173]
    v_pk_add_f32 v[180:181], v[180:181], v[188:189]
    v_pk_add_f32 v[166:167], v[166:167], v[174:175]
    v_pk_add_f32 v[182:183], v[182:183], v[190:191]
    v_cvt_pk_bf16_f32 v176, v164, v165
    v_cvt_pk_bf16_f32 v192, v180, v181
    v_cvt_pk_bf16_f32 v177, v166, v167
    v_cvt_pk_bf16_f32 v193, v182, v183
    buffer_store_dwordx2 v[176:177], v17, s[12:15], s72 offen offset:1024
    buffer_store_dwordx2 v[192:193], v20, s[12:15], s72 offen offset:1024
    s_waitcnt lgkmcnt(0)
    s_nop 0
    v_pk_fma_f32 v[196:197], v[40:41], v[136:137], v[32:33] op_sel:[0,0,0] op_sel_hi:[0,1,0]
    v_pk_fma_f32 v[212:213], v[40:41], v[140:141], v[32:33] op_sel:[0,0,0] op_sel_hi:[0,1,0]
    v_pk_fma_f32 v[164:165], v[42:43], v[136:137], v[32:33] op_sel:[0,0,0] op_sel_hi:[0,1,0]
    v_pk_fma_f32 v[180:181], v[42:43], v[140:141], v[32:33] op_sel:[0,0,0] op_sel_hi:[0,1,0]
    v_pk_fma_f32 v[198:199], v[40:41], v[138:139], v[32:33] op_sel:[0,0,0] op_sel_hi:[0,1,0]
    v_pk_fma_f32 v[214:215], v[40:41], v[142:143], v[32:33] op_sel:[0,0,0] op_sel_hi:[0,1,0]
    v_pk_fma_f32 v[166:167], v[42:43], v[138:139], v[32:33] op_sel:[0,0,0] op_sel_hi:[0,1,0]
    v_pk_fma_f32 v[182:183], v[42:43], v[142:143], v[32:33] op_sel:[0,0,0] op_sel_hi:[0,1,0]
    v_pk_fma_f32 v[200:201], v[56:57], v[40:41], v[196:197] op_sel:[0,1,0] op_sel_hi:[1,1,1]
    v_pk_fma_f32 v[216:217], v[60:61], v[40:41], v[212:213] op_sel:[0,1,0] op_sel_hi:[1,1,1]
    v_pk_fma_f32 v[168:169], v[76:77], v[42:43], v[164:165] op_sel:[0,1,0] op_sel_hi:[1,1,1]
    v_pk_fma_f32 v[184:185], v[80:81], v[42:43], v[180:181] op_sel:[0,1,0] op_sel_hi:[1,1,1]
    v_pk_fma_f32 v[202:203], v[58:59], v[40:41], v[198:199] op_sel:[0,1,0] op_sel_hi:[1,1,1]
    v_pk_fma_f32 v[218:219], v[62:63], v[40:41], v[214:215] op_sel:[0,1,0] op_sel_hi:[1,1,1]
    v_pk_fma_f32 v[170:171], v[78:79], v[42:43], v[166:167] op_sel:[0,1,0] op_sel_hi:[1,1,1]
    v_pk_fma_f32 v[186:187], v[82:83], v[42:43], v[182:183] op_sel:[0,1,0] op_sel_hi:[1,1,1]
    v_pk_fma_f32 v[204:205], v[200:201], v[34:35], v[32:33] op_sel:[0,0,1] op_sel_hi:[1,0,1]
    v_pk_fma_f32 v[220:221], v[216:217], v[34:35], v[32:33] op_sel:[0,0,1] op_sel_hi:[1,0,1]
    v_pk_fma_f32 v[172:173], v[168:169], v[34:35], v[32:33] op_sel:[0,0,1] op_sel_hi:[1,0,1]
    v_pk_fma_f32 v[188:189], v[184:185], v[34:35], v[32:33] op_sel:[0,0,1] op_sel_hi:[1,0,1]
    v_pk_fma_f32 v[206:207], v[202:203], v[34:35], v[32:33] op_sel:[0,0,1] op_sel_hi:[1,0,1]
    v_pk_fma_f32 v[222:223], v[218:219], v[34:35], v[32:33] op_sel:[0,0,1] op_sel_hi:[1,0,1]
    v_pk_fma_f32 v[174:175], v[170:171], v[34:35], v[32:33] op_sel:[0,0,1] op_sel_hi:[1,0,1]
    v_pk_fma_f32 v[190:191], v[186:187], v[34:35], v[32:33] op_sel:[0,0,1] op_sel_hi:[1,0,1]
    v_exp_f32 v204, v204 clamp
    v_exp_f32 v220, v220 clamp
    v_exp_f32 v172, v172 clamp
    v_exp_f32 v188, v188 clamp
    v_max_f32 v196, v32, v200
    v_max_f32 v212, v32, v216
    v_max_f32 v164, v32, v168
    v_max_f32 v180, v32, v184
    v_exp_f32 v205, v205 clamp
    v_exp_f32 v221, v221 clamp
    v_exp_f32 v173, v173 clamp
    v_exp_f32 v189, v189 clamp
    v_max_f32 v197, v32, v201
    v_max_f32 v213, v32, v217
    v_max_f32 v165, v32, v169
    v_max_f32 v181, v32, v185
    v_exp_f32 v206, v206 clamp
    v_exp_f32 v222, v222 clamp
    v_exp_f32 v174, v174 clamp
    v_exp_f32 v190, v190 clamp
    v_max_f32 v198, v32, v202
    v_max_f32 v214, v32, v218
    v_max_f32 v166, v32, v170
    v_max_f32 v182, v32, v186
    v_exp_f32 v207, v207 clamp
    v_exp_f32 v223, v223 clamp
    v_exp_f32 v175, v175 clamp
    v_exp_f32 v191, v191 clamp
    v_max_f32 v199, v32, v203
    v_max_f32 v215, v32, v219
    v_max_f32 v167, v32, v171
    v_max_f32 v183, v32, v187
    v_pk_add_f32 v[196:197], v[196:197], v[204:205]
    v_pk_add_f32 v[212:213], v[212:213], v[220:221]
    v_pk_add_f32 v[164:165], v[164:165], v[172:173]
    v_pk_add_f32 v[180:181], v[180:181], v[188:189]
    v_pk_add_f32 v[198:199], v[198:199], v[206:207]
    v_pk_add_f32 v[214:215], v[214:215], v[222:223]
    v_pk_add_f32 v[166:167], v[166:167], v[174:175]
    v_pk_add_f32 v[182:183], v[182:183], v[190:191]
    v_cvt_pk_bf16_f32 v208, v196, v197
    v_cvt_pk_bf16_f32 v224, v212, v213
    v_cvt_pk_bf16_f32 v176, v164, v165
    v_cvt_pk_bf16_f32 v192, v180, v181
    v_cvt_pk_bf16_f32 v209, v198, v199
    v_cvt_pk_bf16_f32 v225, v214, v215
    v_cvt_pk_bf16_f32 v177, v166, v167
    v_cvt_pk_bf16_f32 v193, v182, v183
    buffer_store_dwordx2 v[208:209], v18, s[12:15], s72 offen
    buffer_store_dwordx2 v[224:225], v19, s[12:15], s72 offen
    buffer_store_dwordx2 v[176:177], v18, s[12:15], s72 offen offset:1024
    buffer_store_dwordx2 v[192:193], v19, s[12:15], s72 offen offset:1024
    v_pk_fma_f32 v[196:197], v[44:45], v[128:129], v[32:33] op_sel:[0,0,0] op_sel_hi:[0,1,0]
    v_pk_fma_f32 v[212:213], v[44:45], v[132:133], v[32:33] op_sel:[0,0,0] op_sel_hi:[0,1,0]
    v_pk_fma_f32 v[164:165], v[44:45], v[136:137], v[32:33] op_sel:[0,0,0] op_sel_hi:[0,1,0]
    v_pk_fma_f32 v[180:181], v[44:45], v[140:141], v[32:33] op_sel:[0,0,0] op_sel_hi:[0,1,0]
    v_pk_fma_f32 v[198:199], v[44:45], v[130:131], v[32:33] op_sel:[0,0,0] op_sel_hi:[0,1,0]
    v_pk_fma_f32 v[214:215], v[44:45], v[134:135], v[32:33] op_sel:[0,0,0] op_sel_hi:[0,1,0]
    v_pk_fma_f32 v[166:167], v[44:45], v[138:139], v[32:33] op_sel:[0,0,0] op_sel_hi:[0,1,0]
    v_pk_fma_f32 v[182:183], v[44:45], v[142:143], v[32:33] op_sel:[0,0,0] op_sel_hi:[0,1,0]
    v_pk_fma_f32 v[200:201], v[88:89], v[44:45], v[196:197] op_sel:[0,1,0] op_sel_hi:[1,1,1]
    v_pk_fma_f32 v[216:217], v[92:93], v[44:45], v[212:213] op_sel:[0,1,0] op_sel_hi:[1,1,1]
    v_pk_fma_f32 v[168:169], v[96:97], v[44:45], v[164:165] op_sel:[0,1,0] op_sel_hi:[1,1,1]
    v_pk_fma_f32 v[184:185], v[100:101], v[44:45], v[180:181] op_sel:[0,1,0] op_sel_hi:[1,1,1]
    v_pk_fma_f32 v[202:203], v[90:91], v[44:45], v[198:199] op_sel:[0,1,0] op_sel_hi:[1,1,1]
    v_pk_fma_f32 v[218:219], v[94:95], v[44:45], v[214:215] op_sel:[0,1,0] op_sel_hi:[1,1,1]
    v_pk_fma_f32 v[170:171], v[98:99], v[44:45], v[166:167] op_sel:[0,1,0] op_sel_hi:[1,1,1]
    v_pk_fma_f32 v[186:187], v[102:103], v[44:45], v[182:183] op_sel:[0,1,0] op_sel_hi:[1,1,1]
    v_pk_fma_f32 v[204:205], v[200:201], v[34:35], v[32:33] op_sel:[0,0,1] op_sel_hi:[1,0,1]
    v_pk_fma_f32 v[220:221], v[216:217], v[34:35], v[32:33] op_sel:[0,0,1] op_sel_hi:[1,0,1]
    v_pk_fma_f32 v[172:173], v[168:169], v[34:35], v[32:33] op_sel:[0,0,1] op_sel_hi:[1,0,1]
    v_pk_fma_f32 v[188:189], v[184:185], v[34:35], v[32:33] op_sel:[0,0,1] op_sel_hi:[1,0,1]
    v_pk_fma_f32 v[206:207], v[202:203], v[34:35], v[32:33] op_sel:[0,0,1] op_sel_hi:[1,0,1]
    v_pk_fma_f32 v[222:223], v[218:219], v[34:35], v[32:33] op_sel:[0,0,1] op_sel_hi:[1,0,1]
    v_pk_fma_f32 v[174:175], v[170:171], v[34:35], v[32:33] op_sel:[0,0,1] op_sel_hi:[1,0,1]
    v_pk_fma_f32 v[190:191], v[186:187], v[34:35], v[32:33] op_sel:[0,0,1] op_sel_hi:[1,0,1]
    v_exp_f32 v204, v204 clamp
    v_exp_f32 v220, v220 clamp
    v_exp_f32 v172, v172 clamp
    v_exp_f32 v188, v188 clamp
    v_max_f32 v196, v32, v200
    v_max_f32 v212, v32, v216
    v_max_f32 v164, v32, v168
    v_max_f32 v180, v32, v184
    v_exp_f32 v205, v205 clamp
    v_exp_f32 v221, v221 clamp
    v_exp_f32 v173, v173 clamp
    v_exp_f32 v189, v189 clamp
    v_max_f32 v197, v32, v201
    v_max_f32 v213, v32, v217
    v_max_f32 v165, v32, v169
    v_max_f32 v181, v32, v185
    v_exp_f32 v206, v206 clamp
    v_exp_f32 v222, v222 clamp
    v_exp_f32 v174, v174 clamp
    v_exp_f32 v190, v190 clamp
    v_max_f32 v198, v32, v202
    v_max_f32 v214, v32, v218
    v_max_f32 v166, v32, v170
    v_max_f32 v182, v32, v186
    v_exp_f32 v207, v207 clamp
    v_exp_f32 v223, v223 clamp
    v_exp_f32 v175, v175 clamp
    v_exp_f32 v191, v191 clamp
    v_max_f32 v199, v32, v203
    v_max_f32 v215, v32, v219
    v_max_f32 v167, v32, v171
    v_max_f32 v183, v32, v187
    v_pk_add_f32 v[196:197], v[196:197], v[204:205]
    v_pk_add_f32 v[212:213], v[212:213], v[220:221]
    v_pk_add_f32 v[164:165], v[164:165], v[172:173]
    v_pk_add_f32 v[180:181], v[180:181], v[188:189]
    v_pk_add_f32 v[198:199], v[198:199], v[206:207]
    v_pk_add_f32 v[214:215], v[214:215], v[222:223]
    v_pk_add_f32 v[166:167], v[166:167], v[174:175]
    v_pk_add_f32 v[182:183], v[182:183], v[190:191]
    v_cvt_pk_bf16_f32 v208, v196, v197
    v_cvt_pk_bf16_f32 v224, v212, v213
    v_cvt_pk_bf16_f32 v176, v164, v165
    v_cvt_pk_bf16_f32 v192, v180, v181
    v_cvt_pk_bf16_f32 v209, v198, v199
    v_cvt_pk_bf16_f32 v225, v214, v215
    v_cvt_pk_bf16_f32 v177, v166, v167
    v_cvt_pk_bf16_f32 v193, v182, v183
    buffer_store_dwordx2 v[208:209], v16, s[12:15], s73 offen
    buffer_store_dwordx2 v[224:225], v17, s[12:15], s73 offen
    buffer_store_dwordx2 v[176:177], v18, s[12:15], s73 offen
    buffer_store_dwordx2 v[192:193], v19, s[12:15], s73 offen
    v_pk_fma_f32 v[196:197], v[44:45], v[144:145], v[32:33] op_sel:[0,0,0] op_sel_hi:[0,1,0]
    v_pk_fma_f32 v[212:213], v[46:47], v[128:129], v[32:33] op_sel:[0,0,0] op_sel_hi:[0,1,0]
    v_pk_fma_f32 v[164:165], v[46:47], v[132:133], v[32:33] op_sel:[0,0,0] op_sel_hi:[0,1,0]
    v_pk_fma_f32 v[180:181], v[46:47], v[136:137], v[32:33] op_sel:[0,0,0] op_sel_hi:[0,1,0]
    v_pk_fma_f32 v[198:199], v[44:45], v[146:147], v[32:33] op_sel:[0,0,0] op_sel_hi:[0,1,0]
    v_pk_fma_f32 v[214:215], v[46:47], v[130:131], v[32:33] op_sel:[0,0,0] op_sel_hi:[0,1,0]
    v_pk_fma_f32 v[166:167], v[46:47], v[134:135], v[32:33] op_sel:[0,0,0] op_sel_hi:[0,1,0]
    v_pk_fma_f32 v[182:183], v[46:47], v[138:139], v[32:33] op_sel:[0,0,0] op_sel_hi:[0,1,0]
    v_pk_fma_f32 v[200:201], v[104:105], v[44:45], v[196:197] op_sel:[0,1,0] op_sel_hi:[1,1,1]
    v_pk_fma_f32 v[216:217], v[108:109], v[46:47], v[212:213] op_sel:[0,1,0] op_sel_hi:[1,1,1]
    v_pk_fma_f32 v[168:169], v[112:113], v[46:47], v[164:165] op_sel:[0,1,0] op_sel_hi:[1,1,1]
    v_pk_fma_f32 v[184:185], v[116:117], v[46:47], v[180:181] op_sel:[0,1,0] op_sel_hi:[1,1,1]
    v_pk_fma_f32 v[202:203], v[106:107], v[44:45], v[198:199] op_sel:[0,1,0] op_sel_hi:[1,1,1]
    v_pk_fma_f32 v[218:219], v[110:111], v[46:47], v[214:215] op_sel:[0,1,0] op_sel_hi:[1,1,1]
    v_pk_fma_f32 v[170:171], v[114:115], v[46:47], v[166:167] op_sel:[0,1,0] op_sel_hi:[1,1,1]
    v_pk_fma_f32 v[186:187], v[118:119], v[46:47], v[182:183] op_sel:[0,1,0] op_sel_hi:[1,1,1]
    v_pk_fma_f32 v[204:205], v[200:201], v[34:35], v[32:33] op_sel:[0,0,1] op_sel_hi:[1,0,1]
    v_pk_fma_f32 v[220:221], v[216:217], v[34:35], v[32:33] op_sel:[0,0,1] op_sel_hi:[1,0,1]
    v_pk_fma_f32 v[172:173], v[168:169], v[34:35], v[32:33] op_sel:[0,0,1] op_sel_hi:[1,0,1]
    v_pk_fma_f32 v[188:189], v[184:185], v[34:35], v[32:33] op_sel:[0,0,1] op_sel_hi:[1,0,1]
    v_pk_fma_f32 v[206:207], v[202:203], v[34:35], v[32:33] op_sel:[0,0,1] op_sel_hi:[1,0,1]
    v_pk_fma_f32 v[222:223], v[218:219], v[34:35], v[32:33] op_sel:[0,0,1] op_sel_hi:[1,0,1]
    v_pk_fma_f32 v[174:175], v[170:171], v[34:35], v[32:33] op_sel:[0,0,1] op_sel_hi:[1,0,1]
    v_pk_fma_f32 v[190:191], v[186:187], v[34:35], v[32:33] op_sel:[0,0,1] op_sel_hi:[1,0,1]
    v_exp_f32 v204, v204 clamp
    v_exp_f32 v220, v220 clamp
    v_exp_f32 v172, v172 clamp
    v_exp_f32 v188, v188 clamp
    v_max_f32 v196, v32, v200
    v_max_f32 v212, v32, v216
    v_max_f32 v164, v32, v168
    v_max_f32 v180, v32, v184
    v_exp_f32 v205, v205 clamp
    v_exp_f32 v221, v221 clamp
    v_exp_f32 v173, v173 clamp
    v_exp_f32 v189, v189 clamp
    v_max_f32 v197, v32, v201
    v_max_f32 v213, v32, v217
    v_max_f32 v165, v32, v169
    v_max_f32 v181, v32, v185
    v_exp_f32 v206, v206 clamp
    v_exp_f32 v222, v222 clamp
    v_exp_f32 v174, v174 clamp
    v_exp_f32 v190, v190 clamp
    v_max_f32 v198, v32, v202
    v_max_f32 v214, v32, v218
    v_max_f32 v166, v32, v170
    v_max_f32 v182, v32, v186
    v_exp_f32 v207, v207 clamp
    v_exp_f32 v223, v223 clamp
    v_exp_f32 v175, v175 clamp
    v_exp_f32 v191, v191 clamp
    v_max_f32 v199, v32, v203
    v_max_f32 v215, v32, v219
    v_max_f32 v167, v32, v171
    v_max_f32 v183, v32, v187
    v_pk_add_f32 v[196:197], v[196:197], v[204:205]
    v_pk_add_f32 v[212:213], v[212:213], v[220:221]
    v_pk_add_f32 v[164:165], v[164:165], v[172:173]
    v_pk_add_f32 v[180:181], v[180:181], v[188:189]
    v_pk_add_f32 v[198:199], v[198:199], v[206:207]
    v_pk_add_f32 v[214:215], v[214:215], v[222:223]
    v_pk_add_f32 v[166:167], v[166:167], v[174:175]
    v_pk_add_f32 v[182:183], v[182:183], v[190:191]
    v_cvt_pk_bf16_f32 v208, v196, v197
    v_cvt_pk_bf16_f32 v224, v212, v213
    v_cvt_pk_bf16_f32 v176, v164, v165
    v_cvt_pk_bf16_f32 v192, v180, v181
    v_cvt_pk_bf16_f32 v209, v198, v199
    v_cvt_pk_bf16_f32 v225, v214, v215
    v_cvt_pk_bf16_f32 v177, v166, v167
    v_cvt_pk_bf16_f32 v193, v182, v183
    buffer_store_dwordx2 v[208:209], v20, s[12:15], s73 offen
    buffer_store_dwordx2 v[224:225], v16, s[12:15], s73 offen offset:1024
    buffer_store_dwordx2 v[176:177], v17, s[12:15], s73 offen offset:1024
    buffer_store_dwordx2 v[192:193], v18, s[12:15], s73 offen offset:1024
    v_pk_fma_f32 v[196:197], v[46:47], v[140:141], v[32:33] op_sel:[0,0,0] op_sel_hi:[0,1,0]
    v_pk_fma_f32 v[212:213], v[46:47], v[144:145], v[32:33] op_sel:[0,0,0] op_sel_hi:[0,1,0]
    v_pk_fma_f32 v[198:199], v[46:47], v[142:143], v[32:33] op_sel:[0,0,0] op_sel_hi:[0,1,0]
    v_pk_fma_f32 v[214:215], v[46:47], v[146:147], v[32:33] op_sel:[0,0,0] op_sel_hi:[0,1,0]
    v_pk_fma_f32 v[200:201], v[120:121], v[46:47], v[196:197] op_sel:[0,1,0] op_sel_hi:[1,1,1]
    v_pk_fma_f32 v[216:217], v[124:125], v[46:47], v[212:213] op_sel:[0,1,0] op_sel_hi:[1,1,1]
    v_pk_fma_f32 v[202:203], v[122:123], v[46:47], v[198:199] op_sel:[0,1,0] op_sel_hi:[1,1,1]
    v_pk_fma_f32 v[218:219], v[126:127], v[46:47], v[214:215] op_sel:[0,1,0] op_sel_hi:[1,1,1]
    v_pk_fma_f32 v[204:205], v[200:201], v[34:35], v[32:33] op_sel:[0,0,1] op_sel_hi:[1,0,1]
    v_pk_fma_f32 v[220:221], v[216:217], v[34:35], v[32:33] op_sel:[0,0,1] op_sel_hi:[1,0,1]
    v_pk_fma_f32 v[206:207], v[202:203], v[34:35], v[32:33] op_sel:[0,0,1] op_sel_hi:[1,0,1]
    v_pk_fma_f32 v[222:223], v[218:219], v[34:35], v[32:33] op_sel:[0,0,1] op_sel_hi:[1,0,1]
    v_exp_f32 v204, v204 clamp
    v_exp_f32 v220, v220 clamp
    v_max_f32 v196, v32, v200
    v_max_f32 v212, v32, v216
    v_exp_f32 v205, v205 clamp
    v_exp_f32 v221, v221 clamp
    v_max_f32 v197, v32, v201
    v_max_f32 v213, v32, v217
    v_exp_f32 v206, v206 clamp
    v_exp_f32 v222, v222 clamp
    v_max_f32 v198, v32, v202
    v_max_f32 v214, v32, v218
    v_exp_f32 v207, v207 clamp
    v_exp_f32 v223, v223 clamp
    v_max_f32 v199, v32, v203
    v_max_f32 v215, v32, v219
    v_pk_add_f32 v[196:197], v[196:197], v[204:205]
    v_pk_add_f32 v[212:213], v[212:213], v[220:221]
    v_pk_add_f32 v[198:199], v[198:199], v[206:207]
    v_pk_add_f32 v[214:215], v[214:215], v[222:223]
    v_cvt_pk_bf16_f32 v208, v196, v197
    v_cvt_pk_bf16_f32 v224, v212, v213
    v_cvt_pk_bf16_f32 v209, v198, v199
    v_cvt_pk_bf16_f32 v225, v214, v215
    buffer_store_dwordx2 v[208:209], v19, s[12:15], s73 offen offset:1024
    buffer_store_dwordx2 v[224:225], v20, s[12:15], s73 offen offset:1024
    s_branch L_k1_fin
L_k1_rt2:
    s_nop 0
    s_mul_i32 s80, s52, 0x4c00
    s_add_u32 s85, s80, 0x2800
    v_mov_b32 v8, 0x3f803f80
    v_mov_b32 v12, 0
    v_mov_b32 v13, 0
    v_mov_b32 v14, 0
    v_mov_b32 v15, 0
    v_bfe_u32 v120, v1, 2, 2
    v_lshlrev_b32_e64 v120, 7, v120
    v_lshl_add_u32 v120, v2, 5, v120
    v_lshrrev_b32 v121, 3, v1
    v_and_b32 v122, 7, v1
    v_lshlrev_b32 v122, 4, v122
    s_cmp_ge_u32 s66, 54
    s_cbranch_scc1 L_k1_rt_a_wd
    s_cmp_ge_u32 s66, 27
    s_cselect_b32 s78, 1, 0
    s_cselect_b32 s24, s42, s40
    s_cselect_b32 s25, s43, s41
    s_mov_b32 s26, 0x21c000
    s_mov_b32 s27, 0x20000
    s_mul_i32 s57, s78, 27
    s_sub_u32 s77, s66, s57
    s_mul_i32 s68, s52, 0x6c00
    s_lshl_b32 s57, s77, 7
    s_add_u32 s68, s68, s57
    v_mul_u32_u24 v4, 0xd80, v121
    v_add_u32 v4, v4, v122
    s_add_u32 m0, s80, 0
    s_add_u32 s57, s68, 0
    buffer_load_dwordx4 v4, s[24:27], s57 offen lds
    s_add_u32 m0, s80, 0x400
    s_add_u32 s57, s68, 0x36000
    buffer_load_dwordx4 v4, s[24:27], s57 offen lds
    s_add_u32 m0, s80, 0x800
    s_add_u32 s57, s68, 0x6c000
    buffer_load_dwordx4 v4, s[24:27], s57 offen lds
    s_add_u32 m0, s80, 0xc00
    s_add_u32 s57, s68, 0xa2000
    buffer_load_dwordx4 v4, s[24:27], s57 offen lds
    s_add_u32 m0, s80, 0x1000
    s_add_u32 s57, s68, 0xd8000
    buffer_load_dwordx4 v4, s[24:27], s57 offen lds
    s_add_u32 m0, s80, 0x1400
    s_add_u32 s57, s68, 0x10e000
    buffer_load_dwordx4 v4, s[24:27], s57 offen lds
    s_add_u32 m0, s80, 0x1800
    s_add_u32 s57, s68, 0x144000
    buffer_load_dwordx4 v4, s[24:27], s57 offen lds
    s_add_u32 m0, s80, 0x1c00
    s_add_u32 s57, s68, 0x17a000
    buffer_load_dwordx4 v4, s[24:27], s57 offen lds
    s_add_u32 m0, s80, 0x2000
    s_add_u32 s57, s68, 0x1b0000
    buffer_load_dwordx4 v4, s[24:27], s57 offen lds
    s_add_u32 m0, s80, 0x2400
    s_add_u32 s57, s68, 0x1e6000
    buffer_load_dwordx4 v4, s[24:27], s57 offen lds
    s_mul_i32 s76, s77, 0x28000
    s_lshl_b32 s57, s78, 8
    s_add_u32 s76, s76, s57
    s_lshl_b32 s57, s52, 9
    s_add_u32 s76, s76, s57
    s_add_u32 s76, s76, 0xd00000
    v_and_b32_e64 v123, 1, v1
    v_lshl_add_u32 v16, v123, 4, v120
    v_bfe_u32 v123, v1, 1, 1
    v_lshl_add_u32 v16, v123, 3, v16
    v_add_u32_e64 v16, s80, v16
    v_mul_u32_u24 v18, 0xa000, v2
    v_lshl_add_u32 v18, v3, 4, v18
    v_mov_b32_e64 v7, 0
    s_add_u32 s83, s67, 0xa0
    s_mov_b32 s86, 0
    v_mov_b32 v17, 0
    v_mov_b32 v19, 0
    s_cmp_ge_u32 s67, 40
    s_cbranch_scc1 L_k1_rt_go
    s_branch L_k1_rt_b_wo
L_k1_rt_a_wd:
    s_sub_u32 s78, s67, 0x1b0
    s_lshl_b32 s78, s78, 1
    s_add_u32 s83, s78, 1
    s_mov_b32 s24, s36
    s_mov_b32 s25, s37
    s_mov_b32 s26, 0xc8000
    s_mov_b32 s27, 0x20000
    s_mul_i32 s79, s78, 0x199a
    s_lshr_b32 s79, s79, 16
    s_mul_i32 s57, s79, 10
    s_sub_u32 s77, s78, s57
    s_mul_i32 s57, s79, 0x3334
    s_lshr_b32 s57, s57, 16
    s_mul_i32 s68, s57, 0x32000
    s_mul_i32 s57, s57, 5
    s_sub_u32 s57, s79, s57
    s_lshl_b32 s57, s57, 3
    v_add_u32 v123, s57, v121
    v_mul_u32_u24 v124, 0x3334, v123
    v_lshrrev_b32 v124, 16, v124
    v_mul_u32_u24 v124, 15, v124
    v_add_u32_e64 v123, v123, v124
    v_mul_u32_u24 v4, 0x500, v123
    v_add_u32 v4, v4, v122
    s_lshl_b32 s57, s77, 7
    s_add_u32 s68, s68, s57
    s_add_u32 m0, s80, 0
    s_add_u32 s57, s68, 0
    s_nop 0
    buffer_load_dwordx4 v4, s[24:27], s57 offen lds
    s_add_u32 m0, s80, 0x400
    s_add_u32 s57, s68, 0x1900
    buffer_load_dwordx4 v4, s[24:27], s57 offen lds
    s_add_u32 m0, s80, 0x800
    s_add_u32 s57, s68, 0x3200
    buffer_load_dwordx4 v4, s[24:27], s57 offen lds
    s_add_u32 m0, s80, 0xc00
    s_add_u32 s57, s68, 0x4b00
    buffer_load_dwordx4 v4, s[24:27], s57 offen lds
    v_and_b32_e64 v123, 3, v1
    v_lshl_add_u32 v16, v123, 3, v120
    v_add_u32 v16, s80, v16
    s_lshl_b32 s57, s77, 6
    v_add_u32_e64 v123, s57, v1
    v_mul_u32_u24 v18, 0x334, v123
    v_lshrrev_b32_e64 v18, 16, v18
    v_mul_u32_u24 v125, 0x50, v18
    v_sub_u32 v125, v123, v125
    v_mul_u32_u24 v18, 5, v18
    v_lshrrev_b32 v126, 5, v125
    v_lshlrev_b32 v126, 1, v126
    v_bfe_u32 v127, v125, 2, 1
    v_add_u32_e64 v126, v126, v127
    v_bfe_u32 v127, v125, 3, 2
    v_lshlrev_b32 v127, 2, v127
    v_and_b32 v124, 3, v125
    v_add_u32 v124, v124, v127
    v_cmp_le_u32 vcc, 64, v125
    s_nop 1
    v_cndmask_b32 v126, v126, 4, vcc
    v_and_b32 v127, 15, v125
    v_cndmask_b32 v124, v124, v127, vcc
    v_add_u32 v18, v18, v126
    v_lshlrev_b32_e64 v18, 10, v18
    v_lshl_add_u32 v18, v124, 4, v18
    s_mul_i32 s76, s79, 0xa000
    s_add_u32 s76, s76, 0xc00000
L_k1_rt_b_wo:
    s_mov_b32 s86, 2
    s_mov_b32 s24, s36
    s_mov_b32 s25, s37
    s_nop 0
    s_mov_b32 s26, 0xc8000
    s_mov_b32 s27, 0x20000
    s_mul_i32 s84, s83, 0x199a
    s_lshr_b32 s84, s84, 16
    s_mul_i32 s57, s84, 10
    s_sub_u32 s82, s83, s57
    s_mul_i32 s57, s84, 0x3334
    s_lshr_b32 s57, s57, 16
    s_mul_i32 s68, s57, 0x32000
    s_mul_i32 s57, s57, 5
    s_sub_u32 s57, s84, s57
    s_lshl_b32 s57, s57, 3
    v_add_u32 v123, s57, v121
    v_mul_u32_u24 v124, 0x3334, v123
    v_lshrrev_b32 v124, 16, v124
    v_mul_u32_u24 v124, 15, v124
    v_add_u32_e64 v123, v123, v124
    v_mul_u32_u24 v4, 0x500, v123
    v_add_u32 v4, v4, v122
    s_lshl_b32 s57, s82, 7
    s_add_u32 s68, s68, s57
    s_add_u32 m0, s85, 0
    s_add_u32 s57, s68, 0
    s_nop 0
    buffer_load_dwordx4 v4, s[24:27], s57 offen lds
    s_add_u32 m0, s85, 0x400
    s_add_u32 s57, s68, 0x1900
    buffer_load_dwordx4 v4, s[24:27], s57 offen lds
    s_add_u32 m0, s85, 0x800
    s_add_u32 s57, s68, 0x3200
    buffer_load_dwordx4 v4, s[24:27], s57 offen lds
    s_add_u32 m0, s85, 0xc00
    s_add_u32 s57, s68, 0x4b00
    buffer_load_dwordx4 v4, s[24:27], s57 offen lds
    v_and_b32_e64 v123, 3, v1
    v_lshl_add_u32 v17, v123, 3, v120
    v_add_u32 v17, s85, v17
    s_lshl_b32 s57, s82, 6
    v_add_u32_e64 v123, s57, v1
    v_mul_u32_u24 v19, 0x334, v123
    v_lshrrev_b32_e64 v19, 16, v19
    v_mul_u32_u24 v125, 0x50, v19
    v_sub_u32 v125, v123, v125
    v_mul_u32_u24 v19, 5, v19
    v_lshrrev_b32 v126, 5, v125
    v_lshlrev_b32 v126, 1, v126
    v_bfe_u32 v127, v125, 2, 1
    v_add_u32_e64 v126, v126, v127
    v_bfe_u32 v127, v125, 3, 2
    v_lshlrev_b32 v127, 2, v127
    v_and_b32 v124, 3, v125
    v_add_u32 v124, v124, v127
    v_cmp_le_u32 vcc, 64, v125
    s_nop 1
    v_cndmask_b32 v126, v126, 4, vcc
    v_and_b32 v127, 15, v125
    v_cndmask_b32 v124, v124, v127, vcc
    v_add_u32 v19, v19, v126
    v_lshlrev_b32_e64 v19, 10, v19
    v_lshl_add_u32 v19, v124, 4, v19
    s_mul_i32 s81, s84, 0xa000
    s_add_u32 s81, s81, 0xc00000
L_k1_rt_go:
    s_sub_u32 s57, s64, 24
    s_lshl_b32 s57, s57, 3
    s_add_u32 s57, s57, s52
    s_lshl_b32 s57, s57, 10
    s_add_u32 s57, s57, (k234_kernel-k1_kernel)
    buffer_load_dwordx4 v[24:27], v9, s[20:23], s57 offen
    s_lshl_b32 s57, s67, 10
    s_add_u32 s58, s57, 0x1514000
    s_cmp_ge_u32 s67, 20
    s_cselect_b32 s58, 0x7f000000, s58
    buffer_store_dwordx4 v[12:15], v9, s[12:15], s58 offen
    s_waitcnt vmcnt(2)
    s_cmp_ge_u32 s66, 54
    s_cbranch_scc1 L_k1_rt_fa_wd
    s_nop 0
    ds_read_b64_tr_b16 v[40:41], v16
    ds_read_b64_tr_b16 v[42:43], v16 offset:512
    ds_read_b64_tr_b16 v[44:45], v16 offset:1024
    ds_read_b64_tr_b16 v[46:47], v16 offset:1536
    s_waitcnt lgkmcnt(2)
    s_add_u32 s58, s76, 0
    buffer_store_dwordx4 v[40:43], v18, s[12:15], s58 offen sc1
    v_dot2c_f32_bf16 v7, v40, v8
    v_dot2c_f32_bf16 v7, v41, v8
    v_dot2c_f32_bf16 v7, v42, v8
    v_dot2c_f32_bf16 v7, v43, v8
    ds_read_b64_tr_b16 v[48:49], v16 offset:2048
    ds_read_b64_tr_b16 v[50:51], v16 offset:2560
    s_waitcnt lgkmcnt(2)
    s_add_u32 s58, s76, 0x1000
    buffer_store_dwordx4 v[44:47], v18, s[12:15], s58 offen sc1
    v_dot2c_f32_bf16 v7, v44, v8
    v_dot2c_f32_bf16 v7, v45, v8
    v_dot2c_f32_bf16 v7, v46, v8
    v_dot2c_f32_bf16 v7, v47, v8
    ds_read_b64_tr_b16 v[52:53], v16 offset:3072
    ds_read_b64_tr_b16 v[54:55], v16 offset:3584
    s_waitcnt lgkmcnt(2)
    s_add_u32 s58, s76, 0x2000
    buffer_store_dwordx4 v[48:51], v18, s[12:15], s58 offen sc1
    v_dot2c_f32_bf16 v7, v48, v8
    v_dot2c_f32_bf16 v7, v49, v8
    v_dot2c_f32_bf16 v7, v50, v8
    v_dot2c_f32_bf16 v7, v51, v8
    ds_read_b64_tr_b16 v[56:57], v16 offset:4096
    ds_read_b64_tr_b16 v[58:59], v16 offset:4608
    s_waitcnt lgkmcnt(2)
    s_add_u32 s58, s76, 0x3000
    buffer_store_dwordx4 v[52:55], v18, s[12:15], s58 offen sc1
    v_dot2c_f32_bf16 v7, v52, v8
    v_dot2c_f32_bf16 v7, v53, v8
    v_dot2c_f32_bf16 v7, v54, v8
    v_dot2c_f32_bf16 v7, v55, v8
    ds_read_b64_tr_b16 v[60:61], v16 offset:5120
    ds_read_b64_tr_b16 v[62:63], v16 offset:5632
    s_waitcnt lgkmcnt(2)
    s_add_u32 s58, s76, 0x4000
    buffer_store_dwordx4 v[56:59], v18, s[12:15], s58 offen sc1
    v_dot2c_f32_bf16 v7, v56, v8
    v_dot2c_f32_bf16 v7, v57, v8
    v_dot2c_f32_bf16 v7, v58, v8
    v_dot2c_f32_bf16 v7, v59, v8
    ds_read_b64_tr_b16 v[64:65], v16 offset:6144
    ds_read_b64_tr_b16 v[66:67], v16 offset:6656
    s_waitcnt lgkmcnt(2)
    s_add_u32 s58, s76, 0x5000
    buffer_store_dwordx4 v[60:63], v18, s[12:15], s58 offen sc1
    v_dot2c_f32_bf16 v7, v60, v8
    v_dot2c_f32_bf16 v7, v61, v8
    v_dot2c_f32_bf16 v7, v62, v8
    v_dot2c_f32_bf16 v7, v63, v8
    ds_read_b64_tr_b16 v[68:69], v16 offset:7168
    ds_read_b64_tr_b16 v[70:71], v16 offset:7680
    s_waitcnt lgkmcnt(2)
    s_add_u32 s58, s76, 0x6000
    buffer_store_dwordx4 v[64:67], v18, s[12:15], s58 offen sc1
    v_dot2c_f32_bf16 v7, v64, v8
    v_dot2c_f32_bf16 v7, v65, v8
    v_dot2c_f32_bf16 v7, v66, v8
    v_dot2c_f32_bf16 v7, v67, v8
    ds_read_b64_tr_b16 v[72:73], v16 offset:8192
    ds_read_b64_tr_b16 v[74:75], v16 offset:8704
    s_waitcnt lgkmcnt(2)
    s_add_u32 s58, s76, 0x7000
    buffer_store_dwordx4 v[68:71], v18, s[12:15], s58 offen sc1
    v_dot2c_f32_bf16 v7, v68, v8
    v_dot2c_f32_bf16 v7, v69, v8
    v_dot2c_f32_bf16 v7, v70, v8
    v_dot2c_f32_bf16 v7, v71, v8
    ds_read_b64_tr_b16 v[76:77], v16 offset:9216
    ds_read_b64_tr_b16 v[78:79], v16 offset:9728
    s_waitcnt lgkmcnt(2)
    s_add_u32 s58, s76, 0x8000
    buffer_store_dwordx4 v[72:75], v18, s[12:15], s58 offen sc1
    v_dot2c_f32_bf16 v7, v72, v8
    v_dot2c_f32_bf16 v7, v73, v8
    v_dot2c_f32_bf16 v7, v74, v8
    v_dot2c_f32_bf16 v7, v75, v8
    s_waitcnt lgkmcnt(0)
    s_add_u32 s58, s76, 0x9000
    buffer_store_dwordx4 v[76:79], v18, s[12:15], s58 offen sc1
    v_dot2c_f32_bf16 v7, v76, v8
    v_dot2c_f32_bf16 v7, v77, v8
    v_dot2c_f32_bf16 v7, v78, v8
    v_dot2c_f32_bf16 v7, v79, v8
    v_lshlrev_b32 v123, 2, v1
    s_lshl_b32 s57, s52, 8
    s_add_u32 s57, s57, 0x26000
    v_add_u32 v124, s57, v123
    ds_write_b32 v124, v7
    s_waitcnt lgkmcnt(0)
    s_barrier
    v_add_u32 v124, 0x26000, v123
    ds_read_b32 v126, v124
    ds_read_b32 v127, v124 offset:256
    ds_read_b32 v128, v124 offset:512
    ds_read_b32 v129, v124 offset:768
    ds_read_b32 v130, v124 offset:1024
    ds_read_b32 v131, v124 offset:1280
    ds_read_b32 v132, v124 offset:1536
    ds_read_b32 v133, v124 offset:1792
    s_waitcnt lgkmcnt(0)
    v_add_f32 v126, v126, v127
    v_add_f32 v126, v126, v128
    v_add_f32 v126, v126, v129
    v_add_f32 v126, v126, v130
    v_add_f32 v126, v126, v131
    v_add_f32 v126, v126, v132
    v_add_f32 v126, v126, v133
    v_lshlrev_b32_e64 v124, 7, v2
    v_lshl_add_u32 v124, v3, 2, v124
    s_lshl_b32 s57, s77, 9
    s_lshl_b32 s58, s78, 6
    s_add_u32 s57, s57, s58
    s_add_u32 s57, s57, 0x1510000
    s_cmp_lg_u32 s52, 0
    s_cselect_b32 s57, 0x7f000000, s57
    buffer_store_dword v126, v124, s[12:15], s57 offen
    v_cvt_pk_bf16_f32 v128, v126, v126
    v_and_b32 v128, 0xffff0000, v128
    v_sub_f32_e64 v129, v126, v128
    v_cvt_pk_bf16_f32 v128, v128, v129
    v_mov_b32 v129, 0
    v_mov_b32 v130, 0
    v_mov_b32 v131, 0
    v_lshlrev_b32 v124, 10, v2
    v_lshl_add_u32 v124, v3, 4, v124
    s_lshl_b32 s57, s77, 12
    s_lshl_b32 s58, s78, 8
    s_add_u32 s57, s57, s58
    s_add_u32 s57, s57, 0x1440000
    s_cmp_lg_u32 s52, 0
    s_cselect_b32 s57, 0x7f000000, s57
    buffer_store_dwordx4 v[128:131], v124, s[12:15], s57 offen
    buffer_store_dwordx4 v[12:15], v124, s[12:15], s57 offen offset:512
    s_branch L_k1_rt_fb
L_k1_rt_fa_wd:
    s_nop 0
    ds_read_b64_tr_b16 v[40:41], v16
    ds_read_b64_tr_b16 v[42:43], v16 offset:512
    ds_read_b64_tr_b16 v[44:45], v16 offset:1024
    ds_read_b64_tr_b16 v[46:47], v16 offset:1536
    s_waitcnt lgkmcnt(2)
    s_add_u32 s58, s76, 0
    buffer_store_dwordx4 v[40:43], v18, s[12:15], s58 offen sc1
    ds_read_b64_tr_b16 v[48:49], v16 offset:2048
    ds_read_b64_tr_b16 v[50:51], v16 offset:2560
    s_waitcnt lgkmcnt(2)
    s_nop 0
    s_add_u32 s58, s76, 0x100
    buffer_store_dwordx4 v[44:47], v18, s[12:15], s58 offen sc1
    ds_read_b64_tr_b16 v[52:53], v16 offset:3072
    ds_read_b64_tr_b16 v[54:55], v16 offset:3584
    s_waitcnt lgkmcnt(2)
    s_add_u32 s58, s76, 0x200
    buffer_store_dwordx4 v[48:51], v18, s[12:15], s58 offen sc1
    s_waitcnt lgkmcnt(0)
    s_add_u32 s58, s76, 0x300
    buffer_store_dwordx4 v[52:55], v18, s[12:15], s58 offen sc1
L_k1_rt_fb:
    s_cmp_eq_u32 s86, 0
    s_cbranch_scc1 L_k1_fin
    ds_read_b64_tr_b16 v[80:81], v17
    ds_read_b64_tr_b16 v[82:83], v17 offset:512
    ds_read_b64_tr_b16 v[84:85], v17 offset:1024
    ds_read_b64_tr_b16 v[86:87], v17 offset:1536
    s_waitcnt lgkmcnt(2)
    s_add_u32 s58, s81, 0
    buffer_store_dwordx4 v[80:83], v19, s[12:15], s58 offen sc1
    ds_read_b64_tr_b16 v[88:89], v17 offset:2048
    ds_read_b64_tr_b16 v[90:91], v17 offset:2560
    s_waitcnt lgkmcnt(2)
    s_nop 0
    s_add_u32 s58, s81, 0x100
    buffer_store_dwordx4 v[84:87], v19, s[12:15], s58 offen sc1
    ds_read_b64_tr_b16 v[92:93], v17 offset:3072
    ds_read_b64_tr_b16 v[94:95], v17 offset:3584
    s_waitcnt lgkmcnt(2)
    s_add_u32 s58, s81, 0x200
    buffer_store_dwordx4 v[88:91], v19, s[12:15], s58 offen sc1
    s_waitcnt lgkmcnt(0)
    s_add_u32 s58, s81, 0x300
    buffer_store_dwordx4 v[92:95], v19, s[12:15], s58 offen sc1
L_k1_fin:
L_end_k1_kernel:
    s_endpgm
.globl k234_kernel
.p2align 8
.type k234_kernel,@function
k234_kernel:
    s_cmp_ge_u32 s2, 0x100
    s_cbranch_scc1 L_end_k234_kernel
    s_load_dwordx2 s[36:37], s[0:1], 0x0
    s_load_dwordx2 s[46:47], s[0:1], 0x48
    v_and_b32 v1, 63, v0
    v_lshrrev_b32 v10, 6, v0
    s_nop 0
    v_readfirstlane_b32 s48, v10
    v_lshrrev_b32 v2, 4, v1
    v_and_b32 v3, 15, v1
    v_lshlrev_b32 v4, 4, v1
    s_and_b32 s51, s2, 7
    s_lshr_b32 s52, s2, 3
    s_lshr_b32 s49, s51, 1
    s_lshl_b32 s49, s49, 3
    s_and_b32 s50, s51, 1
    s_lshl_b32 s50, s50, 2
    s_lshr_b32 s51, s52, 2
    s_add_u32 s49, s49, s51
    s_and_b32 s51, s52, 3
    s_add_u32 s50, s50, s51
    s_add_u32 s51, s48, 0
    s_and_b32 s51, s51, 3
    s_lshl_b32 s51, s51, 10
    v_add_u32 v5, s51, v4
    s_add_u32 s51, s48, 1
    s_and_b32 s51, s51, 3
    s_lshl_b32 s51, s51, 10
    v_add_u32 v6, s51, v4
    s_add_u32 s51, s48, 2
    s_and_b32 s51, s51, 3
    s_lshl_b32 s51, s51, 10
    v_add_u32 v7, s51, v4
    s_add_u32 s51, s48, 3
    s_and_b32 s51, s51, 3
    s_lshl_b32 s51, s51, 10
    v_add_u32 v8, s51, v4
    v_add_u32 v9, 0x1000, v4
    s_mul_i32 s58, s48, 0x3800
    s_waitcnt lgkmcnt(0)
    s_mov_b32 s4, s36
    s_mov_b32 s5, s37
    s_mov_b32 s6, 0x280000
    s_mov_b32 s7, 0x20000
    s_mov_b32 s8, s46
    s_mov_b32 s9, s47
    s_nop 0
    s_mov_b32 s10, 0x1800000
    s_mov_b32 s11, 0x20000
    s_add_u32 s12, s46, 0x1500000
    s_addc_u32 s13, s47, 0
    s_nop 0
    s_mov_b32 s14, 0xd200
    s_mov_b32 s15, 0x20000
    s_mul_i32 s51, s48, 0x3480
    s_add_u32 m0, s58, 0
    s_add_u32 s52, s51, 0
    buffer_load_dwordx4 v4, s[12:15], s52 offen lds
    buffer_load_dwordx4 v4, s[12:15], s52 offen offset:1024 lds
    buffer_load_dwordx4 v4, s[12:15], s52 offen offset:2048 lds
    buffer_load_dwordx4 v4, s[12:15], s52 offen offset:3072 lds
    s_add_u32 m0, s58, 0x1000
    s_add_u32 s52, s51, 0x1000
    buffer_load_dwordx4 v4, s[12:15], s52 offen lds
    buffer_load_dwordx4 v4, s[12:15], s52 offen offset:1024 lds
    buffer_load_dwordx4 v4, s[12:15], s52 offen offset:2048 lds
    buffer_load_dwordx4 v4, s[12:15], s52 offen offset:3072 lds
    s_add_u32 m0, s58, 0x2000
    s_add_u32 s52, s51, 0x2000
    buffer_load_dwordx4 v4, s[12:15], s52 offen lds
    buffer_load_dwordx4 v4, s[12:15], s52 offen offset:1024 lds
    buffer_load_dwordx4 v4, s[12:15], s52 offen offset:2048 lds
    buffer_load_dwordx4 v4, s[12:15], s52 offen offset:3072 lds
    s_add_u32 m0, s58, 0x3000
    s_add_u32 s52, s51, 0x3000
    buffer_load_dwordx4 v4, s[12:15], s52 offen lds
    buffer_load_dwordx4 v4, s[12:15], s52 offen offset:1024 lds
    s_mul_i32 s68, s48, 0xa0000
    s_lshl_b32 s52, s49, 12
    s_add_u32 s68, s68, s52
    s_mul_i32 s69, s48, 0x32000
    s_mul_i32 s52, s50, 0x1400
    s_add_u32 s69, s69, s52
    s_nop 0
    s_add_u32 s69, s69, 0xc00000
    s_mov_b32 s60, 0xfffb0
    s_mov_b32 s61, 0xff970
    v_and_b32 v216, 3, v3
    v_lshrrev_b32 v217, 2, v3
    v_mul_u32_u24 v217, 5, v217
    v_add_u32 v218, 0, v216
    v_cmp_le_u32 vcc, 6, v218
    s_nop 1
    v_cndmask_b32 v220, 0, 1, vcc
    v_mul_u32_u24 v219, 6, v220
    v_sub_u32 v218, v218, v219
    v_cmp_eq_u32 vcc, 5, v218
    v_add_u32 v218, v218, v217
    v_mul_u32_u24_e64 v219, s61, v220
    v_cndmask_b32 v218, v218, 20, vcc
    v_mul_u32_u24 v218, 0x50, v218
    v_add_u32 v218, s58, v218
    v_sub_u32 v192, v218, v219
    s_add_u32 s71, s68, 0
    s_nop 0
    buffer_load_dwordx4 a[0:3], v5, s[8:11], s71 offen
    s_add_u32 s71, s68, 0x20000
    buffer_load_dwordx4 a[4:7], v5, s[8:11], s71 offen
    v_add_u32 v218, 4, v216
    v_cmp_le_u32 vcc, 6, v218
    s_nop 1
    v_cndmask_b32 v220, 0, 1, vcc
    v_mul_u32_u24 v219, 6, v220
    v_sub_u32 v218, v218, v219
    v_cmp_eq_u32 vcc, 5, v218
    v_add_u32 v218, v218, v217
    v_mul_u32_u24 v219, s61, v220
    v_cndmask_b32 v218, v218, 20, vcc
    v_mul_u32_u24 v218, 0x50, v218
    v_add_u32 v218, s58, v218
    v_sub_u32 v193, v218, v219
    s_add_u32 s71, s68, 0x40000
    buffer_load_dwordx4 a[8:11], v5, s[8:11], s71 offen
    s_add_u32 s71, s68, 0x60000
    buffer_load_dwordx4 a[12:15], v5, s[8:11], s71 offen
    v_add_u32 v218, 8, v216
    v_cmp_le_u32 vcc, 6, v218
    s_nop 1
    v_cndmask_b32 v220, 0, 1, vcc
    v_mul_u32_u24 v219, 6, v220
    v_sub_u32 v218, v218, v219
    v_cmp_eq_u32 vcc, 5, v218
    v_add_u32 v218, v218, v217
    v_mul_u32_u24 v219, s61, v220
    v_cndmask_b32 v218, v218, 20, vcc
    v_mul_u32_u24 v218, 0x50, v218
    v_add_u32 v218, s58, v218
    v_sub_u32 v194, v218, v219
    s_add_u32 s71, s68, 0x80000
    buffer_load_dwordx4 a[16:19], v5, s[8:11], s71 offen
    s_add_u32 s71, s68, 0
    s_nop 0
    buffer_load_dwordx4 a[20:23], v6, s[8:11], s71 offen
    v_add_u32 v195, 0xffe00d20, v192
    v_add_u32 v196, 0xffe00d20, v193
    v_add_u32 v197, 0xffe00d20, v194
    v_add_u32 v198, 0xffe00d20, v195
    v_add_u32 v199, 0xffe00d20, v196
    v_add_u32 v200, 0xffe00d20, v197
    v_add_u32 v201, 0xffe00d20, v198
    v_add_u32 v202, 0xffe00d20, v199
    v_add_u32 v203, 0xffe00d20, v200
    v_mul_u32_u24 v216, 0x6668, v2
    v_lshlrev_b32_e64 v217, 5, v2
    s_add_u32 s71, s68, 0x20000
    buffer_load_dwordx4 a[24:27], v6, s[8:11], s71 offen
    s_add_u32 s71, s68, 0x40000
    buffer_load_dwordx4 a[28:31], v6, s[8:11], s71 offen
    v_add_u32_e64 v204, 0, v216
    v_add_u32 v205, 0x3334, v216
    v_add_u32 v206, 0x199a0, v216
    v_add_u32 v207, 0x1ccd4, v216
    v_add_u32 v208, 0x33340, v216
    v_add_u32 v209, 0x36674, v216
    v_add_u32 v210, 0x4cce0, v216
    v_add_u32 v211, 0x50014, v216
    v_add_u32 v212, 0x66680, v216
    v_add_u32 v213, 0x699b4, v216
    v_lshrrev_b32 v204, 16, v204
    v_lshrrev_b32 v205, 16, v205
    v_lshrrev_b32 v206, 16, v206
    v_lshrrev_b32 v207, 16, v207
    v_lshrrev_b32 v208, 16, v208
    v_lshrrev_b32 v209, 16, v209
    v_lshrrev_b32 v210, 16, v210
    v_lshrrev_b32 v211, 16, v211
    v_lshrrev_b32 v212, 16, v212
    v_lshrrev_b32 v213, 16, v213
    s_add_u32 s71, s68, 0x60000
    buffer_load_dwordx4 a[32:35], v6, s[8:11], s71 offen
    s_add_u32 s71, s68, 0x80000
    buffer_load_dwordx4 a[36:39], v6, s[8:11], s71 offen
    v_mad_u32_u24 v204, v204, s60, v217
    v_mad_u32_u24 v205, v205, s60, v217
    v_mad_u32_u24 v206, v206, s60, v217
    v_mad_u32_u24 v207, v207, s60, v217
    v_mad_u32_u24 v208, v208, s60, v217
    v_mad_u32_u24 v209, v209, s60, v217
    v_mad_u32_u24 v210, v210, s60, v217
    v_mad_u32_u24 v211, v211, s60, v217
    v_mad_u32_u24 v212, v212, s60, v217
    v_mad_u32_u24 v213, v213, s60, v217
    s_add_u32 s71, s68, 0
    s_nop 0
    buffer_load_dwordx4 a[40:43], v7, s[8:11], s71 offen
    s_add_u32 s71, s68, 0x20000
    buffer_load_dwordx4 a[44:47], v7, s[8:11], s71 offen
    v_add_u32 v144, v192, v204
    v_add_u32 v145, v192, v205
    v_add_u32 v146, v193, v204
    v_add_u32 v147, v193, v205
    s_add_u32 s71, s68, 0x40000
    buffer_load_dwordx4 a[48:51], v7, s[8:11], s71 offen
    v_add_u32 v148, v193, v206
    v_add_u32 v149, v193, v207
    v_add_u32 v150, v194, v204
    v_add_u32 v151, v194, v205
    s_add_u32 s71, s68, 0x60000
    buffer_load_dwordx4 a[52:55], v7, s[8:11], s71 offen
    v_add_u32 v152, v194, v206
    v_add_u32 v153, v194, v207
    v_add_u32 v154, v195, v206
    v_add_u32 v155, v195, v207
    s_add_u32 s71, s68, 0x80000
    buffer_load_dwordx4 a[56:59], v7, s[8:11], s71 offen
    v_add_u32 v156, v196, v206
    v_add_u32 v157, v196, v207
    v_add_u32 v158, v196, v208
    v_add_u32 v159, v196, v209
    s_add_u32 s71, s68, 0
    buffer_load_dwordx4 a[60:63], v8, s[8:11], s71 offen
    v_add_u32 v160, v197, v206
    v_add_u32 v161, v197, v207
    v_add_u32 v162, v197, v208
    v_add_u32_e64 v163, v197, v209
    s_add_u32 s71, s68, 0x20000
    buffer_load_dwordx4 a[64:67], v8, s[8:11], s71 offen
    v_add_u32 v164, v198, v208
    v_add_u32 v165, v198, v209
    v_add_u32 v166, v198, v210
    v_add_u32 v167, v198, v211
    s_add_u32 s71, s68, 0x40000
    buffer_load_dwordx4 a[68:71], v8, s[8:11], s71 offen
    v_add_u32 v168, v199, v208
    v_add_u32 v169, v199, v209
    v_add_u32 v170, v199, v210
    v_add_u32 v171, v199, v211
    s_add_u32 s71, s68, 0x60000
    buffer_load_dwordx4 a[72:75], v8, s[8:11], s71 offen
    v_add_u32 v172, v200, v210
    v_add_u32 v173, v200, v211
    v_add_u32 v174, v201, v210
    v_add_u32 v175, v201, v211
    s_add_u32 s71, s68, 0x80000
    buffer_load_dwordx4 a[76:79], v8, s[8:11], s71 offen
    v_add_u32 v176, v201, v212
    v_add_u32 v177, v201, v213
    v_add_u32 v178, v202, v210
    v_add_u32 v179, v202, v211
    buffer_load_dwordx4 a[80:83], v4, s[8:11], s69 offen
    v_add_u32 v180, v202, v212
    v_add_u32 v181, v202, v213
    v_add_u32 v182, v203, v212
    v_add_u32 v183, v203, v213
    buffer_load_dwordx4 a[84:87], v4, s[8:11], s69 offen offset:1024
    s_mov_b32 s59, 0x358637bd
    s_waitcnt vmcnt(22)
    s_nop 0
    ds_read_b128 v[96:99], v144
    ds_read_b128 v[100:103], v145 offset:16
    ds_read_b128 v[104:107], v146
    ds_read_b128 v[108:111], v147 offset:16
    ds_read_b128 v[112:115], v148 offset:128
    ds_read_b128 v[116:119], v149 offset:144
    ds_read_b128 v[120:123], v150
    ds_read_b128 v[124:127], v151 offset:16
    ds_read_b128 v[128:131], v152 offset:128
    ds_read_b128 v[132:135], v153 offset:144
    ds_read_b128 v[136:139], v154 offset:128
    ds_read_b128 v[140:143], v155 offset:144
    s_waitcnt lgkmcnt(6)
    s_nop 0
    v_cvt_pk_bf16_f32 v16, v96, v97
    v_cvt_pk_bf16_f32 v17, v98, v99
    v_cvt_pk_bf16_f32 v18, v100, v101
    v_cvt_pk_bf16_f32 v19, v102, v103
    buffer_load_dwordx4 a[88:91], v4, s[8:11], s69 offen offset:2048
    v_cvt_pk_bf16_f32 v20, v104, v105
    v_cvt_pk_bf16_f32 v21, v106, v107
    v_cvt_pk_bf16_f32 v22, v108, v109
    v_cvt_pk_bf16_f32 v23, v110, v111
    buffer_load_dwordx4 a[92:95], v4, s[8:11], s69 offen offset:3072
    v_cvt_pk_bf16_f32 v24, v112, v113
    v_cvt_pk_bf16_f32 v25, v114, v115
    v_cvt_pk_bf16_f32 v26, v116, v117
    v_cvt_pk_bf16_f32 v27, v118, v119
    buffer_load_dwordx4 a[96:99], v9, s[8:11], s69 offen
    s_add_u32 s69, s69, 0xa000
    ds_read_b128 v[96:99], v156 offset:128
    ds_read_b128 v[100:103], v157 offset:144
    ds_read_b128 v[104:107], v158 offset:256
    ds_read_b128 v[108:111], v159 offset:272
    ds_read_b128 v[112:115], v160 offset:128
    ds_read_b128 v[116:119], v161 offset:144
    s_waitcnt lgkmcnt(6)
    s_nop 0
    v_cvt_pk_bf16_f32 v28, v120, v121
    v_cvt_pk_bf16_f32 v29, v122, v123
    v_cvt_pk_bf16_f32 v30, v124, v125
    v_cvt_pk_bf16_f32 v31, v126, v127
    buffer_load_dwordx4 a[100:103], v4, s[8:11], s69 offen
    v_cvt_pk_bf16_f32 v32, v128, v129
    v_cvt_pk_bf16_f32 v33, v130, v131
    v_cvt_pk_bf16_f32 v34, v132, v133
    v_cvt_pk_bf16_f32 v35, v134, v135
    buffer_load_dwordx4 a[104:107], v4, s[8:11], s69 offen offset:1024
    v_cvt_pk_bf16_f32 v36, v136, v137
    v_cvt_pk_bf16_f32 v37, v138, v139
    v_cvt_pk_bf16_f32 v38, v140, v141
    v_cvt_pk_bf16_f32 v39, v142, v143
    buffer_load_dwordx4 a[108:111], v4, s[8:11], s69 offen offset:2048
    ds_read_b128 v[120:123], v162 offset:256
    ds_read_b128 v[124:127], v163 offset:272
    ds_read_b128 v[128:131], v164 offset:256
    ds_read_b128 v[132:135], v165 offset:272
    ds_read_b128 v[136:139], v166 offset:384
    ds_read_b128 v[140:143], v167 offset:400
    s_waitcnt lgkmcnt(6)
    s_nop 0
    v_cvt_pk_bf16_f32 v40, v96, v97
    v_cvt_pk_bf16_f32 v41, v98, v99
    v_cvt_pk_bf16_f32 v42, v100, v101
    v_cvt_pk_bf16_f32 v43, v102, v103
    buffer_load_dwordx4 a[112:115], v4, s[8:11], s69 offen offset:3072
    v_cvt_pk_bf16_f32 v44, v104, v105
    v_cvt_pk_bf16_f32 v45, v106, v107
    v_cvt_pk_bf16_f32 v46, v108, v109
    v_cvt_pk_bf16_f32 v47, v110, v111
    buffer_load_dwordx4 a[116:119], v9, s[8:11], s69 offen
    s_add_u32 s69, s69, 0xa000
    v_cvt_pk_bf16_f32 v48, v112, v113
    v_cvt_pk_bf16_f32 v49, v114, v115
    v_cvt_pk_bf16_f32 v50, v116, v117
    v_cvt_pk_bf16_f32 v51, v118, v119
    buffer_load_dwordx4 a[120:123], v4, s[8:11], s69 offen
    ds_read_b128 v[96:99], v168 offset:256
    ds_read_b128 v[100:103], v169 offset:272
    ds_read_b128 v[104:107], v170 offset:384
    ds_read_b128 v[108:111], v171 offset:400
    ds_read_b128 v[112:115], v172 offset:384
    ds_read_b128 v[116:119], v173 offset:400
    s_waitcnt lgkmcnt(6)
    s_nop 0
    v_cvt_pk_bf16_f32 v52, v120, v121
    v_cvt_pk_bf16_f32 v53, v122, v123
    v_cvt_pk_bf16_f32 v54, v124, v125
    v_cvt_pk_bf16_f32 v55, v126, v127
    buffer_load_dwordx4 a[124:127], v4, s[8:11], s69 offen offset:1024
    v_cvt_pk_bf16_f32 v56, v128, v129
    v_cvt_pk_bf16_f32 v57, v130, v131
    v_cvt_pk_bf16_f32 v58, v132, v133
    v_cvt_pk_bf16_f32 v59, v134, v135
    buffer_load_dwordx4 a[128:131], v4, s[8:11], s69 offen offset:2048
    v_cvt_pk_bf16_f32 v60, v136, v137
    v_cvt_pk_bf16_f32 v61, v138, v139
    v_cvt_pk_bf16_f32 v62, v140, v141
    v_cvt_pk_bf16_f32 v63, v142, v143
    buffer_load_dwordx4 a[132:135], v4, s[8:11], s69 offen offset:3072
    ds_read_b128 v[120:123], v174 offset:384
    ds_read_b128 v[124:127], v175 offset:400
    ds_read_b128 v[128:131], v176 offset:512
    ds_read_b128 v[132:135], v177 offset:528
    ds_read_b128 v[136:139], v178 offset:384
    ds_read_b128 v[140:143], v179 offset:400
    s_waitcnt lgkmcnt(6)
    s_nop 0
    v_cvt_pk_bf16_f32 v64, v96, v97
    v_cvt_pk_bf16_f32 v65, v98, v99
    v_cvt_pk_bf16_f32 v66, v100, v101
    v_cvt_pk_bf16_f32 v67, v102, v103
    buffer_load_dwordx4 a[136:139], v9, s[8:11], s69 offen
    s_add_u32 s69, s69, 0xa000
    v_cvt_pk_bf16_f32 v68, v104, v105
    v_cvt_pk_bf16_f32 v69, v106, v107
    v_cvt_pk_bf16_f32 v70, v108, v109
    v_cvt_pk_bf16_f32 v71, v110, v111
    buffer_load_dwordx4 a[140:143], v4, s[8:11], s69 offen
    v_cvt_pk_bf16_f32 v72, v112, v113
    v_cvt_pk_bf16_f32 v73, v114, v115
    v_cvt_pk_bf16_f32 v74, v116, v117
    v_cvt_pk_bf16_f32 v75, v118, v119
    buffer_load_dwordx4 a[144:147], v4, s[8:11], s69 offen offset:1024
    ds_read_b128 v[96:99], v180 offset:512
    ds_read_b128 v[100:103], v181 offset:528
    ds_read_b128 v[104:107], v182 offset:512
    ds_read_b128 v[108:111], v183 offset:528
    s_waitcnt lgkmcnt(4)
    s_nop 0
    v_cvt_pk_bf16_f32 v76, v120, v121
    v_cvt_pk_bf16_f32 v77, v122, v123
    v_cvt_pk_bf16_f32 v78, v124, v125
    v_cvt_pk_bf16_f32 v79, v126, v127
    buffer_load_dwordx4 a[148:151], v4, s[8:11], s69 offen offset:2048
    v_cvt_pk_bf16_f32 v80, v128, v129
    v_cvt_pk_bf16_f32 v81, v130, v131
    v_cvt_pk_bf16_f32 v82, v132, v133
    v_cvt_pk_bf16_f32 v83, v134, v135
    buffer_load_dwordx4 a[152:155], v4, s[8:11], s69 offen offset:3072
    v_cvt_pk_bf16_f32 v84, v136, v137
    v_cvt_pk_bf16_f32 v85, v138, v139
    v_cvt_pk_bf16_f32 v86, v140, v141
    v_cvt_pk_bf16_f32 v87, v142, v143
    buffer_load_dwordx4 a[156:159], v9, s[8:11], s69 offen
    s_add_u32 s69, s69, 0xa000
    s_waitcnt lgkmcnt(0)
    s_nop 0
    v_cvt_pk_bf16_f32 v88, v96, v97
    v_cvt_pk_bf16_f32 v89, v98, v99
    v_cvt_pk_bf16_f32 v90, v100, v101
    v_cvt_pk_bf16_f32 v91, v102, v103
    buffer_load_dwordx4 a[160:163], v4, s[8:11], s69 offen
    v_cvt_pk_bf16_f32 v92, v104, v105
    v_cvt_pk_bf16_f32 v93, v106, v107
    v_cvt_pk_bf16_f32 v94, v108, v109
    v_cvt_pk_bf16_f32 v95, v110, v111
    buffer_load_dwordx4 a[164:167], v4, s[8:11], s69 offen offset:1024
    s_waitcnt vmcnt(37)
    s_nop 0
    v_mfma_f32_16x16x32_bf16 v[96:99], v[16:19], a[0:3], 0
    v_mfma_f32_16x16x32_bf16 v[100:103], v[20:23], a[0:3], 0
    buffer_load_dwordx4 a[168:171], v4, s[8:11], s69 offen offset:2048
    v_mfma_f32_16x16x32_bf16 v[100:103], v[24:27], a[4:7], v[100:103]
    v_mfma_f32_16x16x32_bf16 v[104:107], v[28:31], a[0:3], 0
    buffer_load_dwordx4 a[172:175], v4, s[8:11], s69 offen offset:3072
    v_mfma_f32_16x16x32_bf16 v[104:107], v[32:35], a[4:7], v[104:107]
    v_mfma_f32_16x16x32_bf16 v[108:111], v[36:39], a[4:7], 0
    buffer_load_dwordx4 a[176:179], v9, s[8:11], s69 offen
    s_add_u32 s69, s69, 0xa000
    v_mfma_f32_16x16x32_bf16 v[112:115], v[40:43], a[4:7], 0
    v_mfma_f32_16x16x32_bf16 v[112:115], v[44:47], a[8:11], v[112:115]
    v_mfma_f32_16x16x32_bf16 v[116:119], v[48:51], a[4:7], 0
    v_mfma_f32_16x16x32_bf16 v[116:119], v[52:55], a[8:11], v[116:119]
    v_mfma_f32_16x16x32_bf16 v[120:123], v[56:59], a[8:11], 0
    v_mfma_f32_16x16x32_bf16 v[120:123], v[60:63], a[12:15], v[120:123]
    v_mfma_f32_16x16x32_bf16 v[124:127], v[64:67], a[8:11], 0
    v_mfma_f32_16x16x32_bf16 v[124:127], v[68:71], a[12:15], v[124:127]
    v_mfma_f32_16x16x32_bf16 v[128:131], v[72:75], a[12:15], 0
    v_mfma_f32_16x16x32_bf16 v[132:135], v[76:79], a[12:15], 0
    v_mfma_f32_16x16x32_bf16 v[132:135], v[80:83], a[16:19], v[132:135]
    v_mfma_f32_16x16x32_bf16 v[136:139], v[84:87], a[12:15], 0
    v_mfma_f32_16x16x32_bf16 v[136:139], v[88:91], a[16:19], v[136:139]
    v_mfma_f32_16x16x32_bf16 v[140:143], v[92:95], a[16:19], 0
    s_waitcnt vmcnt(35)
    v_mfma_f32_16x16x32_bf16 v[144:147], v[16:19], a[20:23], 0
    v_add_f32 v101, s59, v101
    v_add_f32 v107, s59, v107
    v_add_f32 v113, s59, v113
    v_mfma_f32_16x16x32_bf16 v[148:151], v[20:23], a[20:23], 0
    v_add_f32 v119, s59, v119
    v_add_f32 v125, s59, v125
    v_add_f32_e64 v131, s59, v131
    v_mfma_f32_16x16x32_bf16 v[148:151], v[24:27], a[24:27], v[148:151]
    v_add_f32 v137, s59, v137
    v_add_f32 v143, s59, v143
    v_rcp_f32_e64 v101, v101
    v_mfma_f32_16x16x32_bf16 v[152:155], v[28:31], a[20:23], 0
    v_rcp_f32 v107, v107
    v_rcp_f32 v113, v113
    v_rcp_f32_e64 v119, v119
    v_mfma_f32_16x16x32_bf16 v[152:155], v[32:35], a[24:27], v[152:155]
    v_rcp_f32 v125, v125
    v_rcp_f32 v131, v131
    v_rcp_f32_e64 v137, v137
    v_mfma_f32_16x16x32_bf16 v[156:159], v[36:39], a[24:27], 0
    v_rcp_f32_e64 v143, v143
    v_pk_mul_f32 v[96:97], v[96:97], v[100:101] op_sel:[0,1] op_sel_hi:[1,1]
    v_pk_mul_f32 v[98:99], v[98:99], v[100:101] op_sel:[0,1] op_sel_hi:[1,1]
    v_mfma_f32_16x16x32_bf16 v[160:163], v[40:43], a[24:27], 0
    v_mul_f32_e64 v100, v100, v101
    v_cvt_pk_bf16_f32 v192, v96, v97
    v_cvt_pk_bf16_f32 v193, v98, v99
    v_mfma_f32_16x16x32_bf16 v[160:163], v[44:47], a[28:31], v[160:163]
    v_pk_mul_f32 v[102:103], v[102:103], v[106:107] op_sel:[0,1] op_sel_hi:[1,1]
    v_pk_mul_f32 v[104:105], v[104:105], v[106:107] op_sel:[0,1] op_sel_hi:[1,1]
    v_mul_f32_e64 v106, v106, v107
    v_mfma_f32_16x16x32_bf16 v[164:167], v[48:51], a[24:27], 0
    v_cvt_pk_bf16_f32 v194, v100, v102
    v_cvt_pk_bf16_f32 v195, v103, v104
    v_cvt_pk_bf16_f32 v196, v105, v106
    v_mfma_f32_16x16x32_bf16 v[164:167], v[52:55], a[28:31], v[164:167]
    v_pk_mul_f32 v[108:109], v[108:109], v[112:113] op_sel:[0,1] op_sel_hi:[1,1]
    v_pk_mul_f32 v[110:111], v[110:111], v[112:113] op_sel:[0,1] op_sel_hi:[1,1]
    v_mul_f32_e64 v112, v112, v113
    v_mfma_f32_16x16x32_bf16 v[168:171], v[56:59], a[28:31], 0
    v_cvt_pk_bf16_f32 v197, v108, v109
    v_cvt_pk_bf16_f32 v198, v110, v111
    v_pk_mul_f32 v[114:115], v[114:115], v[118:119] op_sel:[0,1] op_sel_hi:[1,1]
    v_mfma_f32_16x16x32_bf16 v[168:171], v[60:63], a[32:35], v[168:171]
    v_pk_mul_f32 v[116:117], v[116:117], v[118:119] op_sel:[0,1] op_sel_hi:[1,1]
    v_mul_f32_e64 v118, v118, v119
    v_cvt_pk_bf16_f32 v199, v112, v114
    v_mfma_f32_16x16x32_bf16 v[172:175], v[64:67], a[28:31], 0
    v_cvt_pk_bf16_f32 v200, v115, v116
    v_cvt_pk_bf16_f32 v201, v117, v118
    v_pk_mul_f32 v[120:121], v[120:121], v[124:125] op_sel:[0,1] op_sel_hi:[1,1]
    v_mfma_f32_16x16x32_bf16 v[172:175], v[68:71], a[32:35], v[172:175]
    v_pk_mul_f32 v[122:123], v[122:123], v[124:125] op_sel:[0,1] op_sel_hi:[1,1]
    v_mul_f32_e64 v124, v124, v125
    v_cvt_pk_bf16_f32 v202, v120, v121
    v_mfma_f32_16x16x32_bf16 v[176:179], v[72:75], a[32:35], 0
    v_cvt_pk_bf16_f32 v203, v122, v123
    v_pk_mul_f32 v[126:127], v[126:127], v[130:131] op_sel:[0,1] op_sel_hi:[1,1]
    v_pk_mul_f32 v[128:129], v[128:129], v[130:131] op_sel:[0,1] op_sel_hi:[1,1]
    v_mfma_f32_16x16x32_bf16 v[180:183], v[76:79], a[32:35], 0
    v_mul_f32_e64 v130, v130, v131
    v_cvt_pk_bf16_f32 v204, v124, v126
    v_cvt_pk_bf16_f32 v205, v127, v128
    v_mfma_f32_16x16x32_bf16 v[180:183], v[80:83], a[36:39], v[180:183]
    v_cvt_pk_bf16_f32 v206, v129, v130
    v_pk_mul_f32 v[132:133], v[132:133], v[136:137] op_sel:[0,1] op_sel_hi:[1,1]
    v_pk_mul_f32 v[134:135], v[134:135], v[136:137] op_sel:[0,1] op_sel_hi:[1,1]
    v_mfma_f32_16x16x32_bf16 v[184:187], v[84:87], a[32:35], 0
    v_mul_f32_e64 v136, v136, v137
    v_cvt_pk_bf16_f32 v207, v132, v133
    v_cvt_pk_bf16_f32 v208, v134, v135
    v_mfma_f32_16x16x32_bf16 v[184:187], v[88:91], a[36:39], v[184:187]
    v_pk_mul_f32 v[138:139], v[138:139], v[142:143] op_sel:[0,1] op_sel_hi:[1,1]
    v_pk_mul_f32 v[140:141], v[140:141], v[142:143] op_sel:[0,1] op_sel_hi:[1,1]
    v_mul_f32_e64 v142, v142, v143
    v_mfma_f32_16x16x32_bf16 v[188:191], v[92:95], a[36:39], 0
    v_cvt_pk_bf16_f32 v209, v136, v138
    v_cvt_pk_bf16_f32 v210, v139, v140
    v_cvt_pk_bf16_f32 v211, v141, v142
    s_waitcnt vmcnt(30)
    v_mfma_f32_16x16x32_bf16 v[96:99], v[16:19], a[40:43], 0
    v_add_f32 v149, s59, v149
    v_add_f32 v155, s59, v155
    v_add_f32 v161, s59, v161
    v_mfma_f32_16x16x32_bf16 v[100:103], v[20:23], a[40:43], 0
    v_add_f32 v167, s59, v167
    v_add_f32 v173, s59, v173
    v_add_f32_e64 v179, s59, v179
    v_mfma_f32_16x16x32_bf16 v[100:103], v[24:27], a[44:47], v[100:103]
    v_add_f32 v185, s59, v185
    v_add_f32 v191, s59, v191
    v_rcp_f32_e64 v149, v149
    v_mfma_f32_16x16x32_bf16 v[104:107], v[28:31], a[40:43], 0
    v_rcp_f32 v155, v155
    v_rcp_f32 v161, v161
    v_rcp_f32_e64 v167, v167
    v_mfma_f32_16x16x32_bf16 v[104:107], v[32:35], a[44:47], v[104:107]
    v_rcp_f32 v173, v173
    v_rcp_f32 v179, v179
    v_rcp_f32_e64 v185, v185
    v_mfma_f32_16x16x32_bf16 v[108:111], v[36:39], a[44:47], 0
    v_rcp_f32_e64 v191, v191
    v_pk_mul_f32 v[144:145], v[144:145], v[148:149] op_sel:[0,1] op_sel_hi:[1,1]
    v_pk_mul_f32 v[146:147], v[146:147], v[148:149] op_sel:[0,1] op_sel_hi:[1,1]
    v_mfma_f32_16x16x32_bf16 v[112:115], v[40:43], a[44:47], 0
    v_mul_f32_e64 v148, v148, v149
    v_cvt_pk_bf16_f32 v212, v144, v145
    v_cvt_pk_bf16_f32 v213, v146, v147
    v_mfma_f32_16x16x32_bf16 v[112:115], v[44:47], a[48:51], v[112:115]
    v_pk_mul_f32 v[150:151], v[150:151], v[154:155] op_sel:[0,1] op_sel_hi:[1,1]
    v_pk_mul_f32 v[152:153], v[152:153], v[154:155] op_sel:[0,1] op_sel_hi:[1,1]
    v_mul_f32_e64 v154, v154, v155
    v_mfma_f32_16x16x32_bf16 v[116:119], v[48:51], a[44:47], 0
    v_cvt_pk_bf16_f32 v214, v148, v150
    v_cvt_pk_bf16_f32 v215, v151, v152
    v_cvt_pk_bf16_f32 v216, v153, v154
    v_mfma_f32_16x16x32_bf16 v[116:119], v[52:55], a[48:51], v[116:119]
    v_pk_mul_f32 v[156:157], v[156:157], v[160:161] op_sel:[0,1] op_sel_hi:[1,1]
    v_pk_mul_f32 v[158:159], v[158:159], v[160:161] op_sel:[0,1] op_sel_hi:[1,1]
    v_mul_f32_e64 v160, v160, v161
    v_mfma_f32_16x16x32_bf16 v[120:123], v[56:59], a[48:51], 0
    v_cvt_pk_bf16_f32 v217, v156, v157
    v_cvt_pk_bf16_f32 v218, v158, v159
    v_pk_mul_f32 v[162:163], v[162:163], v[166:167] op_sel:[0,1] op_sel_hi:[1,1]
    v_mfma_f32_16x16x32_bf16 v[120:123], v[60:63], a[52:55], v[120:123]
    v_pk_mul_f32 v[164:165], v[164:165], v[166:167] op_sel:[0,1] op_sel_hi:[1,1]
    v_mul_f32_e64 v166, v166, v167
    v_cvt_pk_bf16_f32 v219, v160, v162
    v_mfma_f32_16x16x32_bf16 v[124:127], v[64:67], a[48:51], 0
    v_cvt_pk_bf16_f32 v220, v163, v164
    v_cvt_pk_bf16_f32 v221, v165, v166
    v_pk_mul_f32 v[168:169], v[168:169], v[172:173] op_sel:[0,1] op_sel_hi:[1,1]
    v_mfma_f32_16x16x32_bf16 v[124:127], v[68:71], a[52:55], v[124:127]
    v_pk_mul_f32 v[170:171], v[170:171], v[172:173] op_sel:[0,1] op_sel_hi:[1,1]
    v_mul_f32_e64 v172, v172, v173
    v_cvt_pk_bf16_f32 v222, v168, v169
    v_mfma_f32_16x16x32_bf16 v[128:131], v[72:75], a[52:55], 0
    v_cvt_pk_bf16_f32 v223, v170, v171
    v_pk_mul_f32 v[174:175], v[174:175], v[178:179] op_sel:[0,1] op_sel_hi:[1,1]
    v_pk_mul_f32 v[176:177], v[176:177], v[178:179] op_sel:[0,1] op_sel_hi:[1,1]
    v_mfma_f32_16x16x32_bf16 v[132:135], v[76:79], a[52:55], 0
    v_mul_f32_e64 v178, v178, v179
    v_cvt_pk_bf16_f32 v224, v172, v174
    v_cvt_pk_bf16_f32 v225, v175, v176
    v_mfma_f32_16x16x32_bf16 v[132:135], v[80:83], a[56:59], v[132:135]
    v_cvt_pk_bf16_f32 v226, v177, v178
    v_pk_mul_f32 v[180:181], v[180:181], v[184:185] op_sel:[0,1] op_sel_hi:[1,1]
    v_pk_mul_f32 v[182:183], v[182:183], v[184:185] op_sel:[0,1] op_sel_hi:[1,1]
    v_mfma_f32_16x16x32_bf16 v[136:139], v[84:87], a[52:55], 0
    v_mul_f32_e64 v184, v184, v185
    v_cvt_pk_bf16_f32 v227, v180, v181
    v_cvt_pk_bf16_f32 v228, v182, v183
    v_mfma_f32_16x16x32_bf16 v[136:139], v[88:91], a[56:59], v[136:139]
    v_pk_mul_f32 v[186:187], v[186:187], v[190:191] op_sel:[0,1] op_sel_hi:[1,1]
    v_pk_mul_f32 v[188:189], v[188:189], v[190:191] op_sel:[0,1] op_sel_hi:[1,1]
    v_mul_f32_e64 v190, v190, v191
    v_mfma_f32_16x16x32_bf16 v[140:143], v[92:95], a[56:59], 0
    v_cvt_pk_bf16_f32 v229, v184, v186
    v_cvt_pk_bf16_f32 v230, v187, v188
    v_cvt_pk_bf16_f32 v231, v189, v190
    s_waitcnt vmcnt(25)
    v_mfma_f32_16x16x32_bf16 v[144:147], v[16:19], a[60:63], 0
    v_add_f32 v101, s59, v101
    v_add_f32 v107, s59, v107
    v_add_f32 v113, s59, v113
    v_mfma_f32_16x16x32_bf16 v[148:151], v[20:23], a[60:63], 0
    v_add_f32 v119, s59, v119
    v_add_f32 v125, s59, v125
    v_add_f32_e64 v131, s59, v131
    v_mfma_f32_16x16x32_bf16 v[148:151], v[24:27], a[64:67], v[148:151]
    v_add_f32 v137, s59, v137
    v_add_f32 v143, s59, v143
    v_rcp_f32_e64 v101, v101
    v_mfma_f32_16x16x32_bf16 v[152:155], v[28:31], a[60:63], 0
    v_rcp_f32 v107, v107
    v_rcp_f32 v113, v113
    v_rcp_f32_e64 v119, v119
    v_mfma_f32_16x16x32_bf16 v[152:155], v[32:35], a[64:67], v[152:155]
    v_rcp_f32 v125, v125
    v_rcp_f32 v131, v131
    v_rcp_f32_e64 v137, v137
    v_mfma_f32_16x16x32_bf16 v[156:159], v[36:39], a[64:67], 0
    v_rcp_f32_e64 v143, v143
    v_pk_mul_f32 v[96:97], v[96:97], v[100:101] op_sel:[0,1] op_sel_hi:[1,1]
    v_pk_mul_f32 v[98:99], v[98:99], v[100:101] op_sel:[0,1] op_sel_hi:[1,1]
    v_mfma_f32_16x16x32_bf16 v[160:163], v[40:43], a[64:67], 0
    v_mul_f32_e64 v100, v100, v101
    v_cvt_pk_bf16_f32 v232, v96, v97
    v_cvt_pk_bf16_f32 v233, v98, v99
    v_mfma_f32_16x16x32_bf16 v[160:163], v[44:47], a[68:71], v[160:163]
    v_pk_mul_f32 v[102:103], v[102:103], v[106:107] op_sel:[0,1] op_sel_hi:[1,1]
    v_pk_mul_f32 v[104:105], v[104:105], v[106:107] op_sel:[0,1] op_sel_hi:[1,1]
    v_mul_f32_e64 v106, v106, v107
    v_mfma_f32_16x16x32_bf16 v[164:167], v[48:51], a[64:67], 0
    v_cvt_pk_bf16_f32 v234, v100, v102
    v_cvt_pk_bf16_f32 v235, v103, v104
    v_cvt_pk_bf16_f32 v236, v105, v106
    v_mfma_f32_16x16x32_bf16 v[164:167], v[52:55], a[68:71], v[164:167]
    v_pk_mul_f32 v[108:109], v[108:109], v[112:113] op_sel:[0,1] op_sel_hi:[1,1]
    v_pk_mul_f32 v[110:111], v[110:111], v[112:113] op_sel:[0,1] op_sel_hi:[1,1]
    v_mul_f32_e64 v112, v112, v113
    v_mfma_f32_16x16x32_bf16 v[168:171], v[56:59], a[68:71], 0
    v_cvt_pk_bf16_f32 v237, v108, v109
    v_cvt_pk_bf16_f32 v238, v110, v111
    v_pk_mul_f32 v[114:115], v[114:115], v[118:119] op_sel:[0,1] op_sel_hi:[1,1]
    v_mfma_f32_16x16x32_bf16 v[168:171], v[60:63], a[72:75], v[168:171]
    v_pk_mul_f32 v[116:117], v[116:117], v[118:119] op_sel:[0,1] op_sel_hi:[1,1]
    v_mul_f32_e64 v118, v118, v119
    v_cvt_pk_bf16_f32 v239, v112, v114
    v_mfma_f32_16x16x32_bf16 v[172:175], v[64:67], a[68:71], 0
    v_cvt_pk_bf16_f32 v240, v115, v116
    v_cvt_pk_bf16_f32 v241, v117, v118
    v_pk_mul_f32 v[120:121], v[120:121], v[124:125] op_sel:[0,1] op_sel_hi:[1,1]
    v_mfma_f32_16x16x32_bf16 v[172:175], v[68:71], a[72:75], v[172:175]
    v_pk_mul_f32 v[122:123], v[122:123], v[124:125] op_sel:[0,1] op_sel_hi:[1,1]
    v_mul_f32_e64 v124, v124, v125
    v_cvt_pk_bf16_f32 v242, v120, v121
    v_mfma_f32_16x16x32_bf16 v[176:179], v[72:75], a[72:75], 0
    v_cvt_pk_bf16_f32 v243, v122, v123
    v_pk_mul_f32 v[126:127], v[126:127], v[130:131] op_sel:[0,1] op_sel_hi:[1,1]
    v_pk_mul_f32 v[128:129], v[128:129], v[130:131] op_sel:[0,1] op_sel_hi:[1,1]
    v_mfma_f32_16x16x32_bf16 v[180:183], v[76:79], a[72:75], 0
    v_mul_f32_e64 v130, v130, v131
    v_cvt_pk_bf16_f32 v244, v124, v126
    v_cvt_pk_bf16_f32 v245, v127, v128
    v_mfma_f32_16x16x32_bf16 v[180:183], v[80:83], a[76:79], v[180:183]
    v_cvt_pk_bf16_f32 v246, v129, v130
    v_pk_mul_f32 v[132:133], v[132:133], v[136:137] op_sel:[0,1] op_sel_hi:[1,1]
    v_pk_mul_f32 v[134:135], v[134:135], v[136:137] op_sel:[0,1] op_sel_hi:[1,1]
    v_mfma_f32_16x16x32_bf16 v[184:187], v[84:87], a[72:75], 0
    v_mul_f32_e64 v136, v136, v137
    v_cvt_pk_bf16_f32 v247, v132, v133
    v_cvt_pk_bf16_f32 v248, v134, v135
    v_mfma_f32_16x16x32_bf16 v[184:187], v[88:91], a[76:79], v[184:187]
    v_pk_mul_f32 v[138:139], v[138:139], v[142:143] op_sel:[0,1] op_sel_hi:[1,1]
    v_pk_mul_f32 v[140:141], v[140:141], v[142:143] op_sel:[0,1] op_sel_hi:[1,1]
    v_mul_f32_e64 v142, v142, v143
    v_mfma_f32_16x16x32_bf16 v[188:191], v[92:95], a[76:79], 0
    v_cvt_pk_bf16_f32 v249, v136, v138
    v_cvt_pk_bf16_f32 v250, v139, v140
    v_cvt_pk_bf16_f32 v251, v141, v142
    s_lshl_b32 s51, s49, 6
    s_lshl_b32 s52, s48, 4
    s_add_u32 s51, s51, s52
    s_mul_i32 s51, s51, 0x500
    s_mul_i32 s52, s50, 0xa0
    s_add_u32 s51, s51, s52
    v_mul_u32_u24 v10, 0x500, v3
    v_lshl_add_u32 v11, v2, 3, v10
    v_lshl_add_u32 v10, v2, 4, v10
    buffer_load_dwordx4 v[96:99], v10, s[4:7], s51 offen
    buffer_load_dwordx4 v[100:103], v10, s[4:7], s51 offen offset:64
    buffer_load_dwordx2 v[104:105], v11, s[4:7], s51 offen offset:128
    s_waitcnt vmcnt(3)
    s_add_u32 s51, s48, 1
    s_and_b32 s51, s51, 3
    s_mul_i32 s51, s51, 0x3c00
    s_add_u32 s51, s51, 0x10000
    v_add_u32 v253, s51, v4
    s_add_u32 s51, s48, 2
    s_and_b32 s51, s51, 3
    s_mul_i32 s51, s51, 0x3c00
    s_add_u32 s51, s51, 0x11400
    v_add_u32 v254, s51, v4
    s_add_u32 s51, s48, 3
    s_and_b32 s51, s51, 3
    s_mul_i32 s51, s51, 0x3c00
    s_add_u32 s51, s51, 0x12800
    v_add_u32 v255, s51, v4
    s_mul_i32 s51, s48, 0x3c00
    s_add_u32 s51, s51, 0x10000
    v_add_u32_e64 v252, s51, v4
    v_mfma_f32_16x16x32_bf16 a[180:183], a[80:83], v[212:215], 0
    v_add_f32 v149, s59, v149
    v_add_f32 v155, s59, v155
    v_mfma_f32_16x16x32_bf16 a[184:187], a[84:87], v[212:215], 0
    v_add_f32 v161, s59, v161
    v_add_f32 v167, s59, v167
    v_mfma_f32_16x16x32_bf16 a[188:191], a[88:91], v[212:215], 0
    v_add_f32 v173, s59, v173
    v_add_f32 v179, s59, v179
    v_mfma_f32_16x16x32_bf16 a[192:195], a[92:95], v[212:215], 0
    v_add_f32 v185, s59, v185
    v_add_f32 v191, s59, v191
    v_mfma_f32_16x16x32_bf16 a[196:199], a[96:99], v[212:215], 0
    v_rcp_f32 v149, v149
    v_rcp_f32 v155, v155
    v_mfma_f32_16x16x32_bf16 a[180:183], a[100:103], v[216:219], a[180:183]
    v_rcp_f32 v161, v161
    v_rcp_f32 v167, v167
    v_mfma_f32_16x16x32_bf16 a[184:187], a[104:107], v[216:219], a[184:187]
    v_rcp_f32 v173, v173
    v_rcp_f32 v179, v179
    v_mfma_f32_16x16x32_bf16 a[188:191], a[108:111], v[216:219], a[188:191]
    v_rcp_f32 v185, v185
    v_rcp_f32 v191, v191
    v_mfma_f32_16x16x32_bf16 a[192:195], a[112:115], v[216:219], a[192:195]
    v_pk_mul_f32 v[144:145], v[144:145], v[148:149] op_sel:[0,1] op_sel_hi:[1,1]
    v_pk_mul_f32 v[146:147], v[146:147], v[148:149] op_sel:[0,1] op_sel_hi:[1,1]
    v_mfma_f32_16x16x32_bf16 a[196:199], a[116:119], v[216:219], a[196:199]
    v_mul_f32_e64 v148, v148, v149
    v_cvt_pk_bf16_f32 v16, v144, v145
    v_mfma_f32_16x16x32_bf16 a[180:183], a[120:123], v[220:223], a[180:183]
    v_cvt_pk_bf16_f32 v17, v146, v147
    v_pk_mul_f32 v[150:151], v[150:151], v[154:155] op_sel:[0,1] op_sel_hi:[1,1]
    v_mfma_f32_16x16x32_bf16 a[184:187], a[124:127], v[220:223], a[184:187]
    v_pk_mul_f32 v[152:153], v[152:153], v[154:155] op_sel:[0,1] op_sel_hi:[1,1]
    v_mul_f32_e64 v154, v154, v155
    v_mfma_f32_16x16x32_bf16 a[188:191], a[128:131], v[220:223], a[188:191]
    v_cvt_pk_bf16_f32 v18, v148, v150
    v_cvt_pk_bf16_f32 v19, v151, v152
    v_mfma_f32_16x16x32_bf16 a[192:195], a[132:135], v[220:223], a[192:195]
    v_cvt_pk_bf16_f32 v20, v153, v154
    v_pk_mul_f32 v[156:157], v[156:157], v[160:161] op_sel:[0,1] op_sel_hi:[1,1]
    v_mfma_f32_16x16x32_bf16 a[196:199], a[136:139], v[220:223], a[196:199]
    v_pk_mul_f32 v[158:159], v[158:159], v[160:161] op_sel:[0,1] op_sel_hi:[1,1]
    v_mul_f32_e64 v160, v160, v161
    v_mfma_f32_16x16x32_bf16 a[180:183], a[140:143], v[224:227], a[180:183]
    v_cvt_pk_bf16_f32 v21, v156, v157
    v_cvt_pk_bf16_f32 v22, v158, v159
    v_mfma_f32_16x16x32_bf16 a[184:187], a[144:147], v[224:227], a[184:187]
    v_pk_mul_f32 v[162:163], v[162:163], v[166:167] op_sel:[0,1] op_sel_hi:[1,1]
    v_pk_mul_f32 v[164:165], v[164:165], v[166:167] op_sel:[0,1] op_sel_hi:[1,1]
    v_mfma_f32_16x16x32_bf16 a[188:191], a[148:151], v[224:227], a[188:191]
    v_mul_f32_e64 v166, v166, v167
    v_cvt_pk_bf16_f32 v23, v160, v162
    v_mfma_f32_16x16x32_bf16 a[192:195], a[152:155], v[224:227], a[192:195]
    v_cvt_pk_bf16_f32 v24, v163, v164
    v_cvt_pk_bf16_f32 v25, v165, v166
    v_mfma_f32_16x16x32_bf16 a[196:199], a[156:159], v[224:227], a[196:199]
    v_pk_mul_f32 v[168:169], v[168:169], v[172:173] op_sel:[0,1] op_sel_hi:[1,1]
    v_pk_mul_f32 v[170:171], v[170:171], v[172:173] op_sel:[0,1] op_sel_hi:[1,1]
    v_mfma_f32_16x16x32_bf16 a[180:183], a[160:163], v[228:231], a[180:183]
    v_mul_f32_e64 v172, v172, v173
    v_cvt_pk_bf16_f32 v26, v168, v169
    v_mfma_f32_16x16x32_bf16 a[184:187], a[164:167], v[228:231], a[184:187]
    v_cvt_pk_bf16_f32 v27, v170, v171
    v_pk_mul_f32 v[174:175], v[174:175], v[178:179] op_sel:[0,1] op_sel_hi:[1,1]
    v_mfma_f32_16x16x32_bf16 a[188:191], a[168:171], v[228:231], a[188:191]
    v_pk_mul_f32 v[176:177], v[176:177], v[178:179] op_sel:[0,1] op_sel_hi:[1,1]
    v_mul_f32_e64 v178, v178, v179
    v_mfma_f32_16x16x32_bf16 a[192:195], a[172:175], v[228:231], a[192:195]
    v_cvt_pk_bf16_f32 v28, v172, v174
    v_cvt_pk_bf16_f32 v29, v175, v176
    v_mfma_f32_16x16x32_bf16 a[196:199], a[176:179], v[228:231], a[196:199]
    v_cvt_pk_bf16_f32 v30, v177, v178
    v_pk_mul_f32 v[180:181], v[180:181], v[184:185] op_sel:[0,1] op_sel_hi:[1,1]
    v_mfma_f32_16x16x32_bf16 a[200:203], a[80:83], v[232:235], 0
    v_pk_mul_f32 v[182:183], v[182:183], v[184:185] op_sel:[0,1] op_sel_hi:[1,1]
    v_mul_f32_e64 v184, v184, v185
    v_mfma_f32_16x16x32_bf16 a[204:207], a[84:87], v[232:235], 0
    v_cvt_pk_bf16_f32 v31, v180, v181
    v_cvt_pk_bf16_f32 v32, v182, v183
    v_mfma_f32_16x16x32_bf16 a[208:211], a[88:91], v[232:235], 0
    v_pk_mul_f32 v[186:187], v[186:187], v[190:191] op_sel:[0,1] op_sel_hi:[1,1]
    v_pk_mul_f32 v[188:189], v[188:189], v[190:191] op_sel:[0,1] op_sel_hi:[1,1]
    v_mfma_f32_16x16x32_bf16 a[212:215], a[92:95], v[232:235], 0
    v_mul_f32_e64 v190, v190, v191
    v_cvt_pk_bf16_f32 v33, v184, v186
    v_mfma_f32_16x16x32_bf16 a[216:219], a[96:99], v[232:235], 0
    v_cvt_pk_bf16_f32 v34, v187, v188
    v_cvt_pk_bf16_f32 v35, v189, v190
    v_mfma_f32_16x16x32_bf16 a[200:203], a[100:103], v[236:239], a[200:203]
    v_mfma_f32_16x16x32_bf16 a[204:207], a[104:107], v[236:239], a[204:207]
    v_mfma_f32_16x16x32_bf16 a[208:211], a[108:111], v[236:239], a[208:211]
    v_mfma_f32_16x16x32_bf16 a[212:215], a[112:115], v[236:239], a[212:215]
    v_mfma_f32_16x16x32_bf16 a[216:219], a[116:119], v[236:239], a[216:219]
    v_mfma_f32_16x16x32_bf16 a[200:203], a[120:123], v[240:243], a[200:203]
    v_mfma_f32_16x16x32_bf16 a[204:207], a[124:127], v[240:243], a[204:207]
    v_mfma_f32_16x16x32_bf16 a[208:211], a[128:131], v[240:243], a[208:211]
    v_mfma_f32_16x16x32_bf16 a[212:215], a[132:135], v[240:243], a[212:215]
    v_mfma_f32_16x16x32_bf16 a[216:219], a[136:139], v[240:243], a[216:219]
    v_mfma_f32_16x16x32_bf16 a[200:203], a[140:143], v[244:247], a[200:203]
    v_mfma_f32_16x16x32_bf16 a[204:207], a[144:147], v[244:247], a[204:207]
    v_mfma_f32_16x16x32_bf16 a[208:211], a[148:151], v[244:247], a[208:211]
    v_mfma_f32_16x16x32_bf16 a[212:215], a[152:155], v[244:247], a[212:215]
    v_mfma_f32_16x16x32_bf16 a[216:219], a[156:159], v[244:247], a[216:219]
    v_mfma_f32_16x16x32_bf16 a[200:203], a[160:163], v[248:251], a[200:203]
    v_mfma_f32_16x16x32_bf16 a[204:207], a[164:167], v[248:251], a[204:207]
    v_mfma_f32_16x16x32_bf16 a[208:211], a[168:171], v[248:251], a[208:211]
    v_mfma_f32_16x16x32_bf16 a[212:215], a[172:175], v[248:251], a[212:215]
    v_mfma_f32_16x16x32_bf16 a[216:219], a[176:179], v[248:251], a[216:219]
    v_mfma_f32_16x16x32_bf16 a[220:223], a[80:83], v[16:19], 0
    ds_write_b128 v253, a[180:183]
    v_mfma_f32_16x16x32_bf16 a[224:227], a[84:87], v[16:19], 0
    ds_write_b128 v253, a[184:187] offset:1024
    v_mfma_f32_16x16x32_bf16 a[228:231], a[88:91], v[16:19], 0
    ds_write_b128 v253, a[188:191] offset:2048
    v_mfma_f32_16x16x32_bf16 a[232:235], a[92:95], v[16:19], 0
    ds_write_b128 v253, a[192:195] offset:3072
    v_mfma_f32_16x16x32_bf16 a[236:239], a[96:99], v[16:19], 0
    ds_write_b128 v253, a[196:199] offset:4096
    v_mfma_f32_16x16x32_bf16 a[220:223], a[100:103], v[20:23], a[220:223]
    v_mfma_f32_16x16x32_bf16 a[224:227], a[104:107], v[20:23], a[224:227]
    v_mfma_f32_16x16x32_bf16 a[228:231], a[108:111], v[20:23], a[228:231]
    ds_write_b128 v254, a[200:203]
    v_mfma_f32_16x16x32_bf16 a[232:235], a[112:115], v[20:23], a[232:235]
    ds_write_b128 v254, a[204:207] offset:1024
    v_mfma_f32_16x16x32_bf16 a[236:239], a[116:119], v[20:23], a[236:239]
    ds_write_b128 v254, a[208:211] offset:2048
    v_mfma_f32_16x16x32_bf16 a[220:223], a[120:123], v[24:27], a[220:223]
    ds_write_b128 v254, a[212:215] offset:3072
    v_mfma_f32_16x16x32_bf16 a[224:227], a[124:127], v[24:27], a[224:227]
    ds_write_b128 v254, a[216:219] offset:4096
    v_mfma_f32_16x16x32_bf16 a[228:231], a[128:131], v[24:27], a[228:231]
    v_mfma_f32_16x16x32_bf16 a[232:235], a[132:135], v[24:27], a[232:235]
    v_mfma_f32_16x16x32_bf16 a[236:239], a[136:139], v[24:27], a[236:239]
    v_mfma_f32_16x16x32_bf16 a[220:223], a[140:143], v[28:31], a[220:223]
    v_mfma_f32_16x16x32_bf16 a[224:227], a[144:147], v[28:31], a[224:227]
    v_mfma_f32_16x16x32_bf16 a[228:231], a[148:151], v[28:31], a[228:231]
    v_mfma_f32_16x16x32_bf16 a[232:235], a[152:155], v[28:31], a[232:235]
    v_mfma_f32_16x16x32_bf16 a[236:239], a[156:159], v[28:31], a[236:239]
    v_mfma_f32_16x16x32_bf16 a[220:223], a[160:163], v[32:35], a[220:223]
    v_mfma_f32_16x16x32_bf16 a[224:227], a[164:167], v[32:35], a[224:227]
    v_mfma_f32_16x16x32_bf16 a[228:231], a[168:171], v[32:35], a[228:231]
    v_mfma_f32_16x16x32_bf16 a[232:235], a[172:175], v[32:35], a[232:235]
    v_mfma_f32_16x16x32_bf16 a[236:239], a[176:179], v[32:35], a[236:239]
    v_mfma_f32_16x16x32_bf16 v[36:39], a[80:83], v[192:195], 0
    v_mfma_f32_16x16x32_bf16 v[40:43], a[84:87], v[192:195], 0
    v_mfma_f32_16x16x32_bf16 v[44:47], a[88:91], v[192:195], 0
    v_mfma_f32_16x16x32_bf16 v[48:51], a[92:95], v[192:195], 0
    v_mfma_f32_16x16x32_bf16 v[52:55], a[96:99], v[192:195], 0
    ds_write_b128 v255, a[220:223]
    v_mfma_f32_16x16x32_bf16 v[36:39], a[100:103], v[196:199], v[36:39]
    ds_write_b128 v255, a[224:227] offset:1024
    v_mfma_f32_16x16x32_bf16 v[40:43], a[104:107], v[196:199], v[40:43]
    ds_write_b128 v255, a[228:231] offset:2048
    v_mfma_f32_16x16x32_bf16 v[44:47], a[108:111], v[196:199], v[44:47]
    ds_write_b128 v255, a[232:235] offset:3072
    v_mfma_f32_16x16x32_bf16 v[48:51], a[112:115], v[196:199], v[48:51]
    ds_write_b128 v255, a[236:239] offset:4096
    v_mfma_f32_16x16x32_bf16 v[52:55], a[116:119], v[196:199], v[52:55]
    v_mfma_f32_16x16x32_bf16 v[36:39], a[120:123], v[200:203], v[36:39]
    v_mfma_f32_16x16x32_bf16 v[40:43], a[124:127], v[200:203], v[40:43]
    v_mfma_f32_16x16x32_bf16 v[44:47], a[128:131], v[200:203], v[44:47]
    v_mfma_f32_16x16x32_bf16 v[48:51], a[132:135], v[200:203], v[48:51]
    v_mfma_f32_16x16x32_bf16 v[52:55], a[136:139], v[200:203], v[52:55]
    v_mfma_f32_16x16x32_bf16 v[36:39], a[140:143], v[204:207], v[36:39]
    v_mfma_f32_16x16x32_bf16 v[40:43], a[144:147], v[204:207], v[40:43]
    v_mfma_f32_16x16x32_bf16 v[44:47], a[148:151], v[204:207], v[44:47]
    v_mfma_f32_16x16x32_bf16 v[48:51], a[152:155], v[204:207], v[48:51]
    v_mfma_f32_16x16x32_bf16 v[52:55], a[156:159], v[204:207], v[52:55]
    v_mfma_f32_16x16x32_bf16 v[36:39], a[160:163], v[208:211], v[36:39]
    v_mfma_f32_16x16x32_bf16 v[40:43], a[164:167], v[208:211], v[40:43]
    v_mfma_f32_16x16x32_bf16 v[44:47], a[168:171], v[208:211], v[44:47]
    v_mfma_f32_16x16x32_bf16 v[48:51], a[172:175], v[208:211], v[48:51]
    v_mfma_f32_16x16x32_bf16 v[52:55], a[176:179], v[208:211], v[52:55]
    s_waitcnt lgkmcnt(0)
    s_barrier
    ds_read_b128 v[144:147], v252
    ds_read_b128 v[164:167], v252 offset:5120
    ds_read_b128 v[184:187], v252 offset:10240
    ds_read_b128 v[148:151], v252 offset:1024
    ds_read_b128 v[168:171], v252 offset:6144
    ds_read_b128 v[188:191], v252 offset:11264
    ds_read_b128 v[152:155], v252 offset:2048
    ds_read_b128 v[172:175], v252 offset:7168
    ds_read_b128 v[192:195], v252 offset:12288
    ds_read_b128 v[156:159], v252 offset:3072
    ds_read_b128 v[176:179], v252 offset:8192
    ds_read_b128 v[196:199], v252 offset:13312
    ds_read_b128 v[160:163], v252 offset:4096
    ds_read_b128 v[180:183], v252 offset:9216
    ds_read_b128 v[200:203], v252 offset:14336
    s_waitcnt lgkmcnt(13)
    v_pk_add_f32 v[144:145], v[144:145], v[164:165]
    v_pk_add_f32 v[146:147], v[146:147], v[166:167]
    s_waitcnt lgkmcnt(12)
    v_pk_add_f32 v[36:37], v[36:37], v[184:185]
    v_pk_add_f32 v[38:39], v[38:39], v[186:187]
    s_waitcnt lgkmcnt(10)
    v_pk_add_f32 v[148:149], v[148:149], v[168:169]
    v_pk_add_f32 v[150:151], v[150:151], v[170:171]
    s_waitcnt lgkmcnt(9)
    v_pk_add_f32 v[40:41], v[40:41], v[188:189]
    v_pk_add_f32 v[42:43], v[42:43], v[190:191]
    s_waitcnt lgkmcnt(7)
    v_pk_add_f32 v[152:153], v[152:153], v[172:173]
    v_pk_add_f32 v[154:155], v[154:155], v[174:175]
    s_waitcnt lgkmcnt(6)
    v_pk_add_f32 v[44:45], v[44:45], v[192:193]
    v_pk_add_f32 v[46:47], v[46:47], v[194:195]
    s_waitcnt lgkmcnt(4)
    v_pk_add_f32 v[156:157], v[156:157], v[176:177]
    v_pk_add_f32 v[158:159], v[158:159], v[178:179]
    s_waitcnt lgkmcnt(3)
    v_pk_add_f32 v[48:49], v[48:49], v[196:197]
    v_pk_add_f32 v[50:51], v[50:51], v[198:199]
    s_waitcnt lgkmcnt(1)
    v_pk_add_f32 v[160:161], v[160:161], v[180:181]
    v_pk_add_f32 v[162:163], v[162:163], v[182:183]
    s_waitcnt lgkmcnt(0)
    v_pk_add_f32 v[52:53], v[52:53], v[200:201]
    v_pk_add_f32 v[54:55], v[54:55], v[202:203]
    v_pk_add_f32 v[36:37], v[36:37], v[144:145]
    v_pk_add_f32 v[38:39], v[38:39], v[146:147]
    v_pk_add_f32 v[40:41], v[40:41], v[148:149]
    v_pk_add_f32 v[42:43], v[42:43], v[150:151]
    v_pk_add_f32 v[44:45], v[44:45], v[152:153]
    v_pk_add_f32 v[46:47], v[46:47], v[154:155]
    v_pk_add_f32 v[48:49], v[48:49], v[156:157]
    v_pk_add_f32 v[50:51], v[50:51], v[158:159]
    v_pk_add_f32 v[52:53], v[52:53], v[160:161]
    v_pk_add_f32 v[54:55], v[54:55], v[162:163]
    s_lshl_b32 s51, s49, 1
    s_lshr_b32 s52, s48, 1
    s_add_u32 s51, s51, s52
    s_mul_i32 s51, s51, 0xa000
    s_mul_i32 s52, s50, 0x1400
    s_add_u32 s51, s51, s52
    s_and_b32 s52, s48, 1
    s_lshl_b32 s52, s52, 8
    s_add_u32 s51, s51, s52
    s_add_u32 s51, s51, 0x280000
    v_lshlrev_b32 v134, 4, v3
    v_add_u32 v134, s51, v134
    v_lshrrev_b32 v132, 1, v2
    v_lshl_add_u32 v132, v132, 10, v134
    v_and_b32_e64 v133, 1, v2
    v_lshl_add_u32 v132, v133, 9, v132
    v_lshl_add_u32 v134, v133, 3, v134
    v_lshrrev_b32_e64 v133, 1, v2
    v_lshl_add_u32 v133, v133, 9, v134
    v_add_u32 v133, 0x1000, v133
    s_waitcnt vmcnt(0)
    v_cvt_pk_bf16_f32 v124, v36, v37
    v_lshlrev_b32 v36, 16, v124
    v_and_b32 v37, 0xffff0000, v124
    v_lshlrev_b32_e64 v126, 16, v96
    v_and_b32 v127, 0xffff0000, v96
    v_pk_add_f32 v[36:37], v[36:37], v[126:127]
    v_cvt_pk_bf16_f32 v112, v36, v37
    v_cvt_pk_bf16_f32 v128, v38, v39
    v_lshlrev_b32_e64 v38, 16, v128
    v_and_b32 v39, 0xffff0000, v128
    v_lshlrev_b32_e64 v130, 16, v97
    v_and_b32 v131, 0xffff0000, v97
    v_pk_add_f32 v[38:39], v[38:39], v[130:131]
    v_cvt_pk_bf16_f32 v113, v38, v39
    v_cvt_pk_bf16_f32 v124, v40, v41
    v_lshlrev_b32_e64 v40, 16, v124
    v_and_b32 v41, 0xffff0000, v124
    v_lshlrev_b32_e64 v126, 16, v98
    v_and_b32 v127, 0xffff0000, v98
    v_pk_add_f32 v[40:41], v[40:41], v[126:127]
    v_cvt_pk_bf16_f32 v114, v40, v41
    v_cvt_pk_bf16_f32 v128, v42, v43
    v_lshlrev_b32_e64 v42, 16, v128
    v_and_b32 v43, 0xffff0000, v128
    v_lshlrev_b32_e64 v130, 16, v99
    v_and_b32 v131, 0xffff0000, v99
    v_pk_add_f32 v[42:43], v[42:43], v[130:131]
    v_cvt_pk_bf16_f32 v115, v42, v43
    v_cvt_pk_bf16_f32 v124, v44, v45
    v_lshlrev_b32_e64 v44, 16, v124
    v_and_b32 v45, 0xffff0000, v124
    v_lshlrev_b32_e64 v126, 16, v100
    v_and_b32 v127, 0xffff0000, v100
    v_pk_add_f32 v[44:45], v[44:45], v[126:127]
    v_cvt_pk_bf16_f32 v116, v44, v45
    v_cvt_pk_bf16_f32 v128, v46, v47
    v_lshlrev_b32_e64 v46, 16, v128
    v_and_b32 v47, 0xffff0000, v128
    v_lshlrev_b32_e64 v130, 16, v101
    v_and_b32 v131, 0xffff0000, v101
    v_pk_add_f32 v[46:47], v[46:47], v[130:131]
    v_cvt_pk_bf16_f32 v117, v46, v47
    v_cvt_pk_bf16_f32 v124, v48, v49
    v_lshlrev_b32_e64 v48, 16, v124
    v_and_b32 v49, 0xffff0000, v124
    v_lshlrev_b32_e64 v126, 16, v102
    v_and_b32 v127, 0xffff0000, v102
    v_pk_add_f32 v[48:49], v[48:49], v[126:127]
    v_cvt_pk_bf16_f32 v118, v48, v49
    v_cvt_pk_bf16_f32 v128, v50, v51
    v_lshlrev_b32_e64 v50, 16, v128
    v_and_b32 v51, 0xffff0000, v128
    v_lshlrev_b32_e64 v130, 16, v103
    v_and_b32 v131, 0xffff0000, v103
    v_pk_add_f32 v[50:51], v[50:51], v[130:131]
    v_cvt_pk_bf16_f32 v119, v50, v51
    v_cvt_pk_bf16_f32 v124, v52, v53
    v_lshlrev_b32_e64 v52, 16, v124
    v_and_b32 v53, 0xffff0000, v124
    v_lshlrev_b32_e64 v126, 16, v104
    v_and_b32 v127, 0xffff0000, v104
    v_pk_add_f32 v[52:53], v[52:53], v[126:127]
    v_cvt_pk_bf16_f32 v120, v52, v53
    v_cvt_pk_bf16_f32 v128, v54, v55
    v_lshlrev_b32_e64 v54, 16, v128
    v_and_b32 v55, 0xffff0000, v128
    v_lshlrev_b32_e64 v130, 16, v105
    v_and_b32 v131, 0xffff0000, v105
    v_pk_add_f32 v[54:55], v[54:55], v[130:131]
    v_cvt_pk_bf16_f32 v121, v54, v55
    buffer_store_dwordx4 v[112:115], v132, s[8:11], 0 offen sc1
    buffer_store_dwordx4 v[116:119], v132, s[8:11], 0 offen offset:2048 sc1
    buffer_store_dwordx2 v[120:121], v133, s[8:11], 0 offen sc1
    v_mov_b32 v136, 0
    v_mov_b32 v137, 0
    v_mov_b32 v138, 0x3f803f80
    v_dot2c_f32_bf16 v136, v112, v138
    v_dot2c_f32_bf16 v137, v112, v112
    v_dot2c_f32_bf16 v136, v113, v138
    v_dot2c_f32_bf16 v137, v113, v113
    v_dot2c_f32_bf16 v136, v114, v138
    v_dot2c_f32_bf16 v137, v114, v114
    v_dot2c_f32_bf16 v136, v115, v138
    v_dot2c_f32_bf16 v137, v115, v115
    v_dot2c_f32_bf16 v136, v116, v138
    v_dot2c_f32_bf16 v137, v116, v116
    v_dot2c_f32_bf16 v136, v117, v138
    v_dot2c_f32_bf16 v137, v117, v117
    v_dot2c_f32_bf16 v136, v118, v138
    v_dot2c_f32_bf16 v137, v118, v118
    v_dot2c_f32_bf16 v136, v119, v138
    v_dot2c_f32_bf16 v137, v119, v119
    v_dot2c_f32_bf16 v136, v120, v138
    v_dot2c_f32_bf16 v137, v120, v120
    v_dot2c_f32_bf16 v136, v121, v138
    v_dot2c_f32_bf16 v137, v121, v121
    s_nop 1
    v_mov_b32 v139, v136
    s_nop 1
    v_permlane32_swap_b32 v136, v139
    v_add_f32 v136, v136, v139
    v_mov_b32 v139, v136
    s_nop 1
    v_permlane16_swap_b32 v136, v139
    v_add_f32 v136, v136, v139
    v_mov_b32 v140, v137
    s_nop 1
    v_permlane32_swap_b32 v137, v140
    v_add_f32 v137, v137, v140
    v_mov_b32 v140, v137
    s_nop 1
    v_permlane16_swap_b32 v137, v140
    v_add_f32 v137, v137, v140
    v_cmp_eq_u32 vcc, 1, v2
    s_nop 1
    v_cndmask_b32 v136, v136, v137, vcc
    v_lshlrev_b32_e64 v139, 3, v3
    v_lshl_add_u32 v139, v2, 2, v139
    v_mov_b32 v140, 0x7f000000
    v_cmp_gt_u32 vcc, 2, v2
    s_nop 1
    v_cndmask_b32 v139, v140, v139, vcc
    s_lshl_b32 s51, s49, 9
    s_lshl_b32 s52, s48, 7
    s_add_u32 s51, s51, s52
    s_add_u32 s51, s51, 0x1514000
    buffer_atomic_add_f32 v136, v139, s[8:11], s51 offen
    v_mov_b32 v240, v112
    v_mov_b32 v241, v113
    v_mov_b32 v242, v114
    v_mov_b32 v243, v115
    v_mov_b32 v244, v116
    v_mov_b32 v245, v117
    v_mov_b32 v246, v118
    v_mov_b32 v247, v119
    v_mov_b32 v248, v120
    v_mov_b32 v249, v121
    s_lshr_b32 s51, s49, 1
    s_lshl_b32 s51, s51, 7
    s_and_b32 s52, s49, 1
    s_lshl_b32 s52, s52, 5
    s_add_u32 s51, s51, s52
    s_lshl_b32 s52, s50, 2
    s_add_u32 s51, s51, s52
    s_add_u32 s51, s51, 0x1518000
    s_waitcnt vmcnt(0) lgkmcnt(0)
    s_barrier
    s_cmp_lg_u32 s48, 0
    s_cbranch_scc1 L_pub_h
    v_mov_b32 v136, 0x7f000000
    v_cmp_eq_u32 vcc, 0, v1
    s_nop 1
    v_cndmask_b32 v136, v136, 0, vcc
    v_mov_b32 v137, 1
    buffer_store_dword v137, v136, s[8:11], s51 offen sc1
L_pub_h:
    s_load_dwordx2 s[46:47], s[0:1], 0x48
    v_and_b32 v1, 63, v0
    v_lshrrev_b32 v16, 6, v0
    s_nop 0
    v_readfirstlane_b32 s48, v16
    v_lshrrev_b32 v2, 5, v1
    v_and_b32 v3, 31, v1
    v_lshlrev_b32 v4, 4, v1
    v_lshrrev_b32 v24, 4, v1
    v_and_b32 v25, 15, v1
    s_and_b32 s51, s2, 7
    s_lshr_b32 s52, s2, 3
    s_lshr_b32 s49, s51, 1
    s_lshl_b32 s49, s49, 2
    s_lshr_b32 s53, s52, 3
    s_add_u32 s49, s49, s53
    s_and_b32 s50, s51, 1
    s_lshl_b32 s50, s50, 3
    s_and_b32 s53, s52, 7
    s_add_u32 s50, s50, s53
    s_mul_i32 s54, s50, 7
    s_min_u32 s54, s54, 0x65
    s_mul_i32 s55, s54, 0xa000
    s_add_u32 s55, s55, 0xd00000
    s_mul_i32 s56, s48, 0xa000
    s_add_u32 s56, s56, s55
    s_lshl_b32 s71, s48, 10
    s_add_u32 s57, s55, s71
    s_lshl_b32 s59, s48, 12
    s_and_b32 s51, s48, 1
    s_mul_i32 s72, s51, 0xa000
    s_lshr_b32 s51, s48, 1
    s_lshl_b32 s51, s51, 12
    s_add_u32 s72, s72, s51
    s_add_u32 s72, s72, s55
    s_lshl_b32 s51, s49, 2
    s_add_u32 s51, s51, s48
    s_mul_i32 s58, s51, 0xa000
    s_add_u32 s58, s58, 0x280000
    s_waitcnt lgkmcnt(0)
    s_mov_b32 s4, s46
    s_mov_b32 s5, s47
    s_mov_b32 s6, 0x1800000
    s_mov_b32 s7, 0x20000
    s_mov_b32 s60, s51
    s_add_u32 m0, s59, 0
    s_add_u32 s53, s56, 0
    s_nop 0
    buffer_load_dwordx4 v4, s[4:7], s53 offen lds
    buffer_load_dwordx4 v4, s[4:7], s53 offen offset:1024 lds
    buffer_load_dwordx4 v4, s[4:7], s53 offen offset:2048 lds
    buffer_load_dwordx4 v4, s[4:7], s53 offen offset:3072 lds
    s_add_u32 m0, s59, 0x4000
    s_add_u32 s53, s56, 0x1000
    buffer_load_dwordx4 v4, s[4:7], s53 offen lds
    buffer_load_dwordx4 v4, s[4:7], s53 offen offset:1024 lds
    buffer_load_dwordx4 v4, s[4:7], s53 offen offset:2048 lds
    buffer_load_dwordx4 v4, s[4:7], s53 offen offset:3072 lds
    s_add_u32 m0, s59, 0x8000
    s_add_u32 s53, s56, 0x2000
    buffer_load_dwordx4 v4, s[4:7], s53 offen lds
    buffer_load_dwordx4 v4, s[4:7], s53 offen offset:1024 lds
    buffer_load_dwordx4 v4, s[4:7], s53 offen offset:2048 lds
    buffer_load_dwordx4 v4, s[4:7], s53 offen offset:3072 lds
    s_lshl_b32 s51, s48, 11
    s_add_u32 m0, s51, 0x20000
    s_lshl_b32 s52, s54, 10
    s_add_u32 s51, s51, s52
    s_nop 0
    s_add_u32 s51, s51, 0x1440000
    buffer_load_dwordx4 v4, s[4:7], s51 offen lds
    buffer_load_dwordx4 v4, s[4:7], s51 offen offset:1024 lds
    v_add_u32_e64 v5, 0, v4
    v_add_u32 v6, 0x10000, v4
    v_add_u32 v7, 0x20000, v4
    v_lshlrev_b32_e64 v8, 4, v2
    v_add_u32 v8, 0x20000, v8
    s_lshl_b32 s51, s49, 3
    s_lshl_b32 s52, s48, 1
    s_add_u32 s51, s51, s52
    s_lshl_b32 s51, s51, 10
    v_bfe_u32 v9, v1, 4, 1
    v_lshlrev_b32_e64 v9, 10, v9
    v_lshl_add_u32 v9, v2, 8, v9
    v_lshl_add_u32 v9, v25, 4, v9
    v_add_u32 v9, s51, v9
    s_add_u32 s51, s54, 0
    s_lshr_b32 s52, s51, 1
    s_lshl_b32 s52, s52, 17
    s_and_b32 s51, s51, 1
    s_lshl_b32 s51, s51, 9
    s_add_u32 s51, s51, s52
    s_add_u32 s64, s51, 0x500000
    s_add_u32 s51, s54, 1
    s_lshr_b32 s52, s51, 1
    s_lshl_b32 s52, s52, 17
    s_and_b32 s51, s51, 1
    s_lshl_b32 s51, s51, 9
    s_add_u32 s51, s51, s52
    s_add_u32 s65, s51, 0x500000
    s_add_u32 s51, s54, 2
    s_lshr_b32 s52, s51, 1
    s_lshl_b32 s52, s52, 17
    s_and_b32 s51, s51, 1
    s_lshl_b32 s51, s51, 9
    s_add_u32 s51, s51, s52
    s_add_u32 s66, s51, 0x500000
    s_add_u32 s51, s54, 3
    s_lshr_b32 s52, s51, 1
    s_lshl_b32 s52, s52, 17
    s_and_b32 s51, s51, 1
    s_lshl_b32 s51, s51, 9
    s_add_u32 s51, s51, s52
    s_add_u32 s67, s51, 0x500000
    s_add_u32 s51, s54, 4
    s_lshr_b32 s52, s51, 1
    s_lshl_b32 s52, s52, 17
    s_and_b32 s51, s51, 1
    s_lshl_b32 s51, s51, 9
    s_add_u32 s51, s51, s52
    s_add_u32 s68, s51, 0x500000
    s_add_u32 s51, s54, 5
    s_lshr_b32 s52, s51, 1
    s_lshl_b32 s52, s52, 17
    s_and_b32 s51, s51, 1
    s_lshl_b32 s51, s51, 9
    s_add_u32 s51, s51, s52
    s_add_u32 s69, s51, 0x500000
    s_add_u32 s51, s54, 6
    s_lshr_b32 s52, s51, 1
    s_lshl_b32 s52, s52, 17
    s_and_b32 s51, s51, 1
    s_lshl_b32 s51, s51, 9
    s_add_u32 s51, s51, s52
    s_add_u32 s70, s51, 0x500000
    s_mov_b32 s63, 0x3acccccd
    s_and_b32 s51, s2, 7
    s_lshr_b32 s52, s2, 3
    s_lshr_b32 s76, s51, 1
    s_lshl_b32 s76, s76, 3
    s_and_b32 s77, s51, 1
    s_lshl_b32 s77, s77, 2
    s_lshr_b32 s51, s52, 2
    s_add_u32 s76, s76, s51
    s_and_b32 s51, s52, 3
    s_add_u32 s77, s77, s51
    s_mul_i32 s74, s48, 0xa000
    s_mul_i32 s51, s77, 0x1400
    s_add_u32 s74, s74, s51
    s_add_u32 s74, s74, 0x1200000
    s_mul_i32 s75, s48, 0x1400
    s_lshl_b32 s51, s49, 7
    s_add_u32 s51, s51, 0x1518000
    s_cmp_lg_u32 s48, 0
    s_cbranch_scc1 L_aw_done_h
    v_and_b32 v16, 15, v1
    v_lshlrev_b32 v16, 2, v16
    s_mov_b32 s52, 0
L_aw_h:
    buffer_load_dword v17, v16, s[4:7], s51 offen sc1
    s_waitcnt vmcnt(0)
    v_cmp_ne_u32 vcc, 1, v17
    s_add_u32 s52, s52, 1
    s_nop 0
    s_cmp_eq_u64 vcc, 0
    s_cbranch_scc1 L_aw_done_h
    s_sleep 1
    s_cmp_lt_u32 s52, 0x61a80
    s_cbranch_scc1 L_aw_h
L_aw_done_h:
    s_barrier
    s_add_u32 s52, s58, 0
    buffer_load_dwordx4 a[0:3], v4, s[4:7], s52 offen sc1
    buffer_load_dwordx4 a[4:7], v4, s[4:7], s52 offen offset:1024 sc1
    buffer_load_dwordx4 a[8:11], v4, s[4:7], s52 offen offset:2048 sc1
    buffer_load_dwordx4 a[12:15], v4, s[4:7], s52 offen offset:3072 sc1
    s_lshl_b32 s51, s60, 8
    s_add_u32 s51, s51, 0x1514000
    v_lshlrev_b32 v16, 3, v3
    buffer_load_dwordx2 v[18:19], v16, s[4:7], s51 offen sc1
    s_add_u32 s52, s58, 0x1000
    buffer_load_dwordx4 a[16:19], v4, s[4:7], s52 offen sc1
    buffer_load_dwordx4 a[20:23], v4, s[4:7], s52 offen offset:1024 sc1
    buffer_load_dwordx4 a[24:27], v4, s[4:7], s52 offen offset:2048 sc1
    buffer_load_dwordx4 a[28:31], v4, s[4:7], s52 offen offset:3072 sc1
    s_add_u32 s52, s58, 0x2000
    buffer_load_dwordx4 a[32:35], v4, s[4:7], s52 offen sc1
    buffer_load_dwordx4 a[36:39], v4, s[4:7], s52 offen offset:1024 sc1
    buffer_load_dwordx4 a[40:43], v4, s[4:7], s52 offen offset:2048 sc1
    buffer_load_dwordx4 a[44:47], v4, s[4:7], s52 offen offset:3072 sc1
    s_waitcnt vmcnt(9)
    s_barrier
    ds_read_b128 a[160:163], v5
    ds_read_b128 a[164:167], v5 offset:4096
    ds_read_b128 a[168:171], v5 offset:8192
    ds_read_b128 a[172:175], v5 offset:12288
    ds_read_b128 a[176:179], v5 offset:1024
    ds_read_b128 a[180:183], v5 offset:5120
    ds_read_b128 a[184:187], v5 offset:9216
    ds_read_b128 a[188:191], v5 offset:13312
    ds_read_b128 a[192:195], v5 offset:2048
    s_waitcnt lgkmcnt(7)
    s_nop 0
    v_mfma_f32_32x32x16_bf16 v[32:47], a[160:163], a[0:3], 0
    ds_read_b128 a[196:199], v5 offset:6144
    v_mfma_f32_32x32x16_bf16 v[48:63], a[164:167], a[0:3], 0
    ds_read_b128 a[200:203], v5 offset:10240
    s_waitcnt lgkmcnt(7)
    s_nop 0
    v_mfma_f32_32x32x16_bf16 v[64:79], a[168:171], a[0:3], 0
    ds_read_b128 a[204:207], v5 offset:14336
    v_mfma_f32_32x32x16_bf16 v[80:95], a[172:175], a[0:3], 0
    ds_read_b128 a[160:163], v5 offset:3072
    s_waitcnt lgkmcnt(7)
    s_nop 0
    v_mfma_f32_32x32x16_bf16 v[32:47], a[176:179], a[4:7], v[32:47]
    ds_read_b128 a[164:167], v5 offset:7168
    v_mfma_f32_32x32x16_bf16 v[48:63], a[180:183], a[4:7], v[48:63]
    ds_read_b128 a[168:171], v5 offset:11264
    s_waitcnt lgkmcnt(7)
    s_nop 0
    v_mfma_f32_32x32x16_bf16 v[64:79], a[184:187], a[4:7], v[64:79]
    ds_read_b128 a[172:175], v5 offset:15360
    v_mfma_f32_32x32x16_bf16 v[80:95], a[188:191], a[4:7], v[80:95]
    s_waitcnt vmcnt(4)
    s_barrier
    ds_read_b128 a[176:179], v5 offset:16384
    s_waitcnt lgkmcnt(7)
    s_nop 0
    v_mfma_f32_32x32x16_bf16 v[32:47], a[192:195], a[8:11], v[32:47]
    s_add_u32 s52, s58, 0x3000
    buffer_load_dwordx4 a[48:51], v4, s[4:7], s52 offen sc1
    ds_read_b128 a[180:183], v5 offset:20480
    v_mfma_f32_32x32x16_bf16 v[48:63], a[196:199], a[8:11], v[48:63]
    buffer_load_dwordx4 a[52:55], v4, s[4:7], s52 offen offset:1024 sc1
    ds_read_b128 a[184:187], v5 offset:24576
    s_waitcnt lgkmcnt(7)
    s_nop 0
    v_mfma_f32_32x32x16_bf16 v[64:79], a[200:203], a[8:11], v[64:79]
    buffer_load_dwordx4 a[56:59], v4, s[4:7], s52 offen offset:2048 sc1
    ds_read_b128 a[188:191], v5 offset:28672
    v_mfma_f32_32x32x16_bf16 v[80:95], a[204:207], a[8:11], v[80:95]
    buffer_load_dwordx4 a[60:63], v4, s[4:7], s52 offen offset:3072 sc1
    ds_read_b128 a[192:195], v5 offset:17408
    s_waitcnt lgkmcnt(7)
    s_nop 0
    v_mfma_f32_32x32x16_bf16 v[32:47], a[160:163], a[12:15], v[32:47]
    s_add_u32 m0, s59, 0xc000
    s_add_u32 s53, s56, 0x3000
    buffer_load_dwordx4 v4, s[4:7], s53 offen lds
    ds_read_b128 a[196:199], v5 offset:21504
    v_mfma_f32_32x32x16_bf16 v[48:63], a[164:167], a[12:15], v[48:63]
    buffer_load_dwordx4 v4, s[4:7], s53 offen offset:1024 lds
    ds_read_b128 a[200:203], v5 offset:25600
    s_waitcnt lgkmcnt(7)
    s_nop 0
    v_mfma_f32_32x32x16_bf16 v[64:79], a[168:171], a[12:15], v[64:79]
    buffer_load_dwordx4 v4, s[4:7], s53 offen offset:2048 lds
    ds_read_b128 a[204:207], v5 offset:29696
    v_mfma_f32_32x32x16_bf16 v[80:95], a[172:175], a[12:15], v[80:95]
    buffer_load_dwordx4 v4, s[4:7], s53 offen offset:3072 lds
    ds_read_b128 a[160:163], v5 offset:18432
    s_waitcnt lgkmcnt(7)
    s_nop 0
    v_mfma_f32_32x32x16_bf16 v[32:47], a[176:179], a[16:19], v[32:47]
    s_add_u32 s52, s58, 0x4000
    buffer_load_dwordx4 a[64:67], v4, s[4:7], s52 offen sc1
    ds_read_b128 a[164:167], v5 offset:22528
    v_mfma_f32_32x32x16_bf16 v[48:63], a[180:183], a[16:19], v[48:63]
    buffer_load_dwordx4 a[68:71], v4, s[4:7], s52 offen offset:1024 sc1
    ds_read_b128 a[168:171], v5 offset:26624
    s_waitcnt lgkmcnt(7)
    s_nop 0
    v_mfma_f32_32x32x16_bf16 v[64:79], a[184:187], a[16:19], v[64:79]
    buffer_load_dwordx4 a[72:75], v4, s[4:7], s52 offen offset:2048 sc1
    ds_read_b128 a[172:175], v5 offset:30720
    v_mfma_f32_32x32x16_bf16 v[80:95], a[188:191], a[16:19], v[80:95]
    buffer_load_dwordx4 a[76:79], v4, s[4:7], s52 offen offset:3072 sc1
    ds_read_b128 a[176:179], v5 offset:19456
    s_waitcnt lgkmcnt(7)
    s_nop 0
    v_mfma_f32_32x32x16_bf16 v[32:47], a[192:195], a[20:23], v[32:47]
    s_add_u32 m0, s59, 0x10000
    s_add_u32 s53, s56, 0x4000
    buffer_load_dwordx4 v4, s[4:7], s53 offen lds
    ds_read_b128 a[180:183], v5 offset:23552
    v_mfma_f32_32x32x16_bf16 v[48:63], a[196:199], a[20:23], v[48:63]
    buffer_load_dwordx4 v4, s[4:7], s53 offen offset:1024 lds
    ds_read_b128 a[184:187], v5 offset:27648
    s_waitcnt lgkmcnt(7)
    s_nop 0
    v_mfma_f32_32x32x16_bf16 v[64:79], a[200:203], a[20:23], v[64:79]
    buffer_load_dwordx4 v4, s[4:7], s53 offen offset:2048 lds
    ds_read_b128 a[188:191], v5 offset:31744
    v_mfma_f32_32x32x16_bf16 v[80:95], a[204:207], a[20:23], v[80:95]
    buffer_load_dwordx4 v4, s[4:7], s53 offen offset:3072 lds
    s_waitcnt vmcnt(16)
    s_barrier
    ds_read_b128 a[192:195], v5 offset:32768
    s_waitcnt lgkmcnt(7)
    s_nop 0
    v_mfma_f32_32x32x16_bf16 v[32:47], a[160:163], a[24:27], v[32:47]
    s_add_u32 s52, s58, 0x5000
    buffer_load_dwordx4 a[80:83], v4, s[4:7], s52 offen sc1
    ds_read_b128 a[196:199], v5 offset:36864
    v_mfma_f32_32x32x16_bf16 v[48:63], a[164:167], a[24:27], v[48:63]
    buffer_load_dwordx4 a[84:87], v4, s[4:7], s52 offen offset:1024 sc1
    ds_read_b128 a[200:203], v5 offset:40960
    s_waitcnt lgkmcnt(7)
    s_nop 0
    v_mfma_f32_32x32x16_bf16 v[64:79], a[168:171], a[24:27], v[64:79]
    buffer_load_dwordx4 a[88:91], v4, s[4:7], s52 offen offset:2048 sc1
    ds_read_b128 a[204:207], v5 offset:45056
    v_mfma_f32_32x32x16_bf16 v[80:95], a[172:175], a[24:27], v[80:95]
    buffer_load_dwordx4 a[92:95], v4, s[4:7], s52 offen offset:3072 sc1
    ds_read_b128 a[160:163], v5 offset:33792
    s_waitcnt lgkmcnt(7)
    s_nop 0
    v_mfma_f32_32x32x16_bf16 v[32:47], a[176:179], a[28:31], v[32:47]
    s_add_u32 m0, s59, 0x14000
    s_add_u32 s53, s56, 0x5000
    buffer_load_dwordx4 v4, s[4:7], s53 offen lds
    ds_read_b128 a[164:167], v5 offset:37888
    v_mfma_f32_32x32x16_bf16 v[48:63], a[180:183], a[28:31], v[48:63]
    buffer_load_dwordx4 v4, s[4:7], s53 offen offset:1024 lds
    ds_read_b128 a[168:171], v5 offset:41984
    s_waitcnt lgkmcnt(7)
    s_nop 0
    v_mfma_f32_32x32x16_bf16 v[64:79], a[184:187], a[28:31], v[64:79]
    buffer_load_dwordx4 v4, s[4:7], s53 offen offset:2048 lds
    ds_read_b128 a[172:175], v5 offset:46080
    v_mfma_f32_32x32x16_bf16 v[80:95], a[188:191], a[28:31], v[80:95]
    buffer_load_dwordx4 v4, s[4:7], s53 offen offset:3072 lds
    ds_read_b128 a[176:179], v5 offset:34816
    s_waitcnt lgkmcnt(7)
    s_nop 0
    v_mfma_f32_32x32x16_bf16 v[32:47], a[192:195], a[32:35], v[32:47]
    ds_read_b128 a[180:183], v5 offset:38912
    v_mfma_f32_32x32x16_bf16 v[48:63], a[196:199], a[32:35], v[48:63]
    ds_read_b128 a[184:187], v5 offset:43008
    s_waitcnt lgkmcnt(7)
    s_nop 0
    v_mfma_f32_32x32x16_bf16 v[64:79], a[200:203], a[32:35], v[64:79]
    ds_read_b128 a[188:191], v5 offset:47104
    v_mfma_f32_32x32x16_bf16 v[80:95], a[204:207], a[32:35], v[80:95]
    ds_read_b128 a[192:195], v5 offset:35840
    s_waitcnt lgkmcnt(7)
    s_nop 0
    v_mfma_f32_32x32x16_bf16 v[32:47], a[160:163], a[36:39], v[32:47]
    ds_read_b128 a[196:199], v5 offset:39936
    v_mfma_f32_32x32x16_bf16 v[48:63], a[164:167], a[36:39], v[48:63]
    ds_read_b128 a[200:203], v5 offset:44032
    s_waitcnt lgkmcnt(7)
    s_nop 0
    v_mfma_f32_32x32x16_bf16 v[64:79], a[168:171], a[36:39], v[64:79]
    ds_read_b128 a[204:207], v5 offset:48128
    v_mfma_f32_32x32x16_bf16 v[80:95], a[172:175], a[36:39], v[80:95]
    s_waitcnt vmcnt(16)
    s_barrier
    ds_read_b128 a[160:163], v5 offset:49152
    s_waitcnt lgkmcnt(7)
    s_nop 0
    v_mfma_f32_32x32x16_bf16 v[32:47], a[176:179], a[40:43], v[32:47]
    s_add_u32 s52, s58, 0x6000
    buffer_load_dwordx4 a[96:99], v4, s[4:7], s52 offen sc1
    ds_read_b128 a[164:167], v5 offset:53248
    v_mfma_f32_32x32x16_bf16 v[48:63], a[180:183], a[40:43], v[48:63]
    buffer_load_dwordx4 a[100:103], v4, s[4:7], s52 offen offset:1024 sc1
    ds_read_b128 a[168:171], v5 offset:57344
    s_waitcnt lgkmcnt(7)
    s_nop 0
    v_mfma_f32_32x32x16_bf16 v[64:79], a[184:187], a[40:43], v[64:79]
    buffer_load_dwordx4 a[104:107], v4, s[4:7], s52 offen offset:2048 sc1
    ds_read_b128 a[172:175], v5 offset:61440
    v_mfma_f32_32x32x16_bf16 v[80:95], a[188:191], a[40:43], v[80:95]
    buffer_load_dwordx4 a[108:111], v4, s[4:7], s52 offen offset:3072 sc1
    ds_read_b128 a[176:179], v5 offset:50176
    s_waitcnt lgkmcnt(7)
    s_nop 0
    v_mfma_f32_32x32x16_bf16 v[32:47], a[192:195], a[44:47], v[32:47]
    s_add_u32 m0, s59, 0x18000
    s_add_u32 s53, s56, 0x6000
    buffer_load_dwordx4 v4, s[4:7], s53 offen lds
    ds_read_b128 a[180:183], v5 offset:54272
    v_mfma_f32_32x32x16_bf16 v[48:63], a[196:199], a[44:47], v[48:63]
    buffer_load_dwordx4 v4, s[4:7], s53 offen offset:1024 lds
    ds_read_b128 a[184:187], v5 offset:58368
    s_waitcnt lgkmcnt(7)
    s_nop 0
    v_mfma_f32_32x32x16_bf16 v[64:79], a[200:203], a[44:47], v[64:79]
    buffer_load_dwordx4 v4, s[4:7], s53 offen offset:2048 lds
    ds_read_b128 a[188:191], v5 offset:62464
    v_mfma_f32_32x32x16_bf16 v[80:95], a[204:207], a[44:47], v[80:95]
    buffer_load_dwordx4 v4, s[4:7], s53 offen offset:3072 lds
    ds_read_b128 a[192:195], v5 offset:51200
    s_waitcnt lgkmcnt(7)
    s_nop 0
    v_mfma_f32_32x32x16_bf16 v[32:47], a[160:163], a[48:51], v[32:47]
    ds_read_b128 a[196:199], v5 offset:55296
    v_mfma_f32_32x32x16_bf16 v[48:63], a[164:167], a[48:51], v[48:63]
    ds_read_b128 a[200:203], v5 offset:59392
    s_waitcnt lgkmcnt(7)
    s_nop 0
    v_mfma_f32_32x32x16_bf16 v[64:79], a[168:171], a[48:51], v[64:79]
    ds_read_b128 a[204:207], v5 offset:63488
    v_mfma_f32_32x32x16_bf16 v[80:95], a[172:175], a[48:51], v[80:95]
    ds_read_b128 a[160:163], v5 offset:52224
    s_waitcnt lgkmcnt(7)
    s_nop 0
    v_mfma_f32_32x32x16_bf16 v[32:47], a[176:179], a[52:55], v[32:47]
    ds_read_b128 a[164:167], v5 offset:56320
    v_mfma_f32_32x32x16_bf16 v[48:63], a[180:183], a[52:55], v[48:63]
    ds_read_b128 a[168:171], v5 offset:60416
    s_waitcnt lgkmcnt(7)
    s_nop 0
    v_mfma_f32_32x32x16_bf16 v[64:79], a[184:187], a[52:55], v[64:79]
    ds_read_b128 a[172:175], v5 offset:64512
    v_mfma_f32_32x32x16_bf16 v[80:95], a[188:191], a[52:55], v[80:95]
    s_waitcnt vmcnt(16)
    s_barrier
    ds_read_b128 a[176:179], v6
    s_waitcnt lgkmcnt(7)
    s_nop 0
    v_mfma_f32_32x32x16_bf16 v[32:47], a[192:195], a[56:59], v[32:47]
    s_add_u32 s52, s58, 0x7000
    buffer_load_dwordx4 a[112:115], v4, s[4:7], s52 offen sc1
    ds_read_b128 a[180:183], v6 offset:4096
    v_mfma_f32_32x32x16_bf16 v[48:63], a[196:199], a[56:59], v[48:63]
    buffer_load_dwordx4 a[116:119], v4, s[4:7], s52 offen offset:1024 sc1
    ds_read_b128 a[184:187], v6 offset:8192
    s_waitcnt lgkmcnt(7)
    s_nop 0
    v_mfma_f32_32x32x16_bf16 v[64:79], a[200:203], a[56:59], v[64:79]
    buffer_load_dwordx4 a[120:123], v4, s[4:7], s52 offen offset:2048 sc1
    ds_read_b128 a[188:191], v6 offset:12288
    v_mfma_f32_32x32x16_bf16 v[80:95], a[204:207], a[56:59], v[80:95]
    buffer_load_dwordx4 a[124:127], v4, s[4:7], s52 offen offset:3072 sc1
    ds_read_b128 a[192:195], v6 offset:1024
    s_waitcnt lgkmcnt(7)
    s_nop 0
    v_mfma_f32_32x32x16_bf16 v[32:47], a[160:163], a[60:63], v[32:47]
    s_add_u32 m0, s59, 0x1c000
    s_add_u32 s53, s56, 0x7000
    buffer_load_dwordx4 v4, s[4:7], s53 offen lds
    ds_read_b128 a[196:199], v6 offset:5120
    v_mfma_f32_32x32x16_bf16 v[48:63], a[164:167], a[60:63], v[48:63]
    buffer_load_dwordx4 v4, s[4:7], s53 offen offset:1024 lds
    ds_read_b128 a[200:203], v6 offset:9216
    s_waitcnt lgkmcnt(7)
    s_nop 0
    v_mfma_f32_32x32x16_bf16 v[64:79], a[168:171], a[60:63], v[64:79]
    buffer_load_dwordx4 v4, s[4:7], s53 offen offset:2048 lds
    ds_read_b128 a[204:207], v6 offset:13312
    v_mfma_f32_32x32x16_bf16 v[80:95], a[172:175], a[60:63], v[80:95]
    buffer_load_dwordx4 v4, s[4:7], s53 offen offset:3072 lds
    ds_read_b128 a[160:163], v6 offset:2048
    s_waitcnt lgkmcnt(7)
    v_mfma_f32_32x32x16_bf16 v[32:47], a[176:179], a[64:67], v[32:47]
    v_mul_f32 v18, s63, v18
    v_mul_f32_e64 v19, s63, v19
    v_fma_f32 v19, -v18, v18, v19
    v_max_f32_e64 v19, 0, v19
    v_cvt_pk_bf16_f32 v10, v18, v18
    v_lshlrev_b32_e64 v10, 16, v10
    v_cvt_pk_bf16_f32 v16, v19, v19
    v_lshlrev_b32_e64 v16, 16, v16
    v_add_f32 v16, 0x3727c5ac, v16
    v_cvt_pk_bf16_f32 v16, v16, v16
    v_lshlrev_b32 v16, 16, v16
    v_sqrt_f32 v16, v16
    s_nop 0
    v_cvt_pk_bf16_f32 v16, v16, v16
    v_lshlrev_b32 v16, 16, v16
    v_rcp_f32 v12, v16
    v_mul_f32 v14, v16, v16
    v_sub_f32_e64 v10, 0, v10
    v_mul_f32 v12, 0xbfb8aa3b, v12
    v_cvt_pk_bf16_f32 v208, v10, v10
    v_cmp_eq_u32 vcc, 0, v2
    s_nop 1
    v_cndmask_b32 v208, 0, v208, vcc
    v_mov_b32 v209, 0
    v_mov_b32 v210, 0
    v_mov_b32 v211, 0
    ds_read_b128 a[208:211], v7
    ds_read_b128 a[212:215], v7 offset:1024
    ds_read_b128 a[216:219], v7 offset:2048
    ds_read_b128 a[220:223], v7 offset:3072
    ds_read_b128 a[224:227], v7 offset:4096
    ds_read_b128 a[228:231], v7 offset:5120
    ds_read_b128 a[232:235], v7 offset:6144
    ds_read_b128 a[164:167], v6 offset:6144
    v_mfma_f32_32x32x16_bf16 v[48:63], a[180:183], a[64:67], v[48:63]
    ds_read_b128 a[168:171], v6 offset:10240
    s_waitcnt lgkmcnt(14)
    s_nop 0
    v_mfma_f32_32x32x16_bf16 v[64:79], a[184:187], a[64:67], v[64:79]
    ds_read_b128 a[172:175], v6 offset:14336
    v_mfma_f32_32x32x16_bf16 v[80:95], a[188:191], a[64:67], v[80:95]
    ds_read_b128 a[176:179], v6 offset:3072
    s_waitcnt lgkmcnt(14)
    s_nop 0
    v_mfma_f32_32x32x16_bf16 v[32:47], a[192:195], a[68:71], v[32:47]
    ds_read_b128 a[180:183], v6 offset:7168
    v_mfma_f32_32x32x16_bf16 v[48:63], a[196:199], a[68:71], v[48:63]
    ds_read_b128 a[184:187], v6 offset:11264
    s_waitcnt lgkmcnt(14)
    s_nop 0
    v_mfma_f32_32x32x16_bf16 v[64:79], a[200:203], a[68:71], v[64:79]
    ds_read_b128 a[188:191], v6 offset:15360
    v_mfma_f32_32x32x16_bf16 v[80:95], a[204:207], a[68:71], v[80:95]
    s_waitcnt vmcnt(16)
    s_barrier
    ds_read_b128 a[192:195], v6 offset:16384
    s_waitcnt lgkmcnt(7)
    s_nop 0
    v_mfma_f32_32x32x16_bf16 v[32:47], a[160:163], a[72:75], v[32:47]
    s_add_u32 s52, s58, 0x8000
    buffer_load_dwordx4 a[128:131], v4, s[4:7], s52 offen sc1
    ds_read_b128 a[196:199], v6 offset:20480
    v_mfma_f32_32x32x16_bf16 v[48:63], a[164:167], a[72:75], v[48:63]
    buffer_load_dwordx4 a[132:135], v4, s[4:7], s52 offen offset:1024 sc1
    ds_read_b128 a[200:203], v6 offset:24576
    s_waitcnt lgkmcnt(7)
    s_nop 0
    v_mfma_f32_32x32x16_bf16 v[64:79], a[168:171], a[72:75], v[64:79]
    buffer_load_dwordx4 a[136:139], v4, s[4:7], s52 offen offset:2048 sc1
    ds_read_b128 a[204:207], v6 offset:28672
    v_mfma_f32_32x32x16_bf16 v[80:95], a[172:175], a[72:75], v[80:95]
    buffer_load_dwordx4 a[140:143], v4, s[4:7], s52 offen offset:3072 sc1
    ds_read_b128 a[160:163], v6 offset:17408
    s_waitcnt lgkmcnt(7)
    v_mfma_f32_32x32x16_bf16 v[32:47], a[176:179], a[76:79], v[32:47]
    s_add_u32 m0, s59, 0
    s_add_u32 s53, s56, 0x8000
    buffer_load_dwordx4 v4, s[4:7], s53 offen lds
    ds_read_b128 a[164:167], v6 offset:21504
    v_mfma_f32_32x32x16_bf16 v[48:63], a[180:183], a[76:79], v[48:63]
    buffer_load_dwordx4 v4, s[4:7], s53 offen offset:1024 lds
    ds_read_b128 a[168:171], v6 offset:25600
    s_waitcnt lgkmcnt(7)
    s_nop 0
    v_mfma_f32_32x32x16_bf16 v[64:79], a[184:187], a[76:79], v[64:79]
    buffer_load_dwordx4 v4, s[4:7], s53 offen offset:2048 lds
    ds_read_b128 a[172:175], v6 offset:29696
    v_mfma_f32_32x32x16_bf16 v[80:95], a[188:191], a[76:79], v[80:95]
    buffer_load_dwordx4 v4, s[4:7], s53 offen offset:3072 lds
    ds_read_b128 a[176:179], v6 offset:18432
    s_waitcnt lgkmcnt(7)
    s_nop 0
    v_mfma_f32_32x32x16_bf16 v[32:47], a[192:195], a[80:83], v[32:47]
    ds_read_b128 a[180:183], v6 offset:22528
    v_mfma_f32_32x32x16_bf16 v[48:63], a[196:199], a[80:83], v[48:63]
    ds_read_b128 a[184:187], v6 offset:26624
    s_waitcnt lgkmcnt(7)
    s_nop 0
    v_mfma_f32_32x32x16_bf16 v[64:79], a[200:203], a[80:83], v[64:79]
    ds_read_b128 a[188:191], v6 offset:30720
    v_mfma_f32_32x32x16_bf16 v[80:95], a[204:207], a[80:83], v[80:95]
    ds_read_b128 a[192:195], v6 offset:19456
    s_waitcnt lgkmcnt(7)
    s_nop 0
    v_mfma_f32_32x32x16_bf16 v[32:47], a[160:163], a[84:87], v[32:47]
    ds_read_b128 a[196:199], v6 offset:23552
    v_mfma_f32_32x32x16_bf16 v[48:63], a[164:167], a[84:87], v[48:63]
    ds_read_b128 a[200:203], v6 offset:27648
    s_waitcnt lgkmcnt(7)
    s_nop 0
    v_mfma_f32_32x32x16_bf16 v[64:79], a[168:171], a[84:87], v[64:79]
    ds_read_b128 a[204:207], v6 offset:31744
    v_mfma_f32_32x32x16_bf16 v[80:95], a[172:175], a[84:87], v[80:95]
    s_waitcnt vmcnt(16)
    s_barrier
    ds_read_b128 a[160:163], v6 offset:32768
    s_waitcnt lgkmcnt(7)
    s_nop 0
    v_mfma_f32_32x32x16_bf16 v[32:47], a[176:179], a[88:91], v[32:47]
    s_add_u32 s52, s58, 0x9000
    buffer_load_dwordx4 a[144:147], v4, s[4:7], s52 offen sc1
    ds_read_b128 a[164:167], v6 offset:36864
    v_mfma_f32_32x32x16_bf16 v[48:63], a[180:183], a[88:91], v[48:63]
    buffer_load_dwordx4 a[148:151], v4, s[4:7], s52 offen offset:1024 sc1
    ds_read_b128 a[168:171], v6 offset:40960
    s_waitcnt lgkmcnt(7)
    s_nop 0
    v_mfma_f32_32x32x16_bf16 v[64:79], a[184:187], a[88:91], v[64:79]
    buffer_load_dwordx4 a[152:155], v4, s[4:7], s52 offen offset:2048 sc1
    ds_read_b128 a[172:175], v6 offset:45056
    v_mfma_f32_32x32x16_bf16 v[80:95], a[188:191], a[88:91], v[80:95]
    buffer_load_dwordx4 a[156:159], v4, s[4:7], s52 offen offset:3072 sc1
    ds_read_b128 a[176:179], v6 offset:33792
    s_waitcnt lgkmcnt(7)
    s_nop 0
    v_mfma_f32_32x32x16_bf16 v[32:47], a[192:195], a[92:95], v[32:47]
    s_add_u32 m0, s59, 0x4000
    s_add_u32 s53, s56, 0x9000
    buffer_load_dwordx4 v4, s[4:7], s53 offen lds
    ds_read_b128 a[180:183], v6 offset:37888
    v_mfma_f32_32x32x16_bf16 v[48:63], a[196:199], a[92:95], v[48:63]
    buffer_load_dwordx4 v4, s[4:7], s53 offen offset:1024 lds
    ds_read_b128 a[184:187], v6 offset:41984
    s_waitcnt lgkmcnt(7)
    s_nop 0
    v_mfma_f32_32x32x16_bf16 v[64:79], a[200:203], a[92:95], v[64:79]
    buffer_load_dwordx4 v4, s[4:7], s53 offen offset:2048 lds
    ds_read_b128 a[188:191], v6 offset:46080
    v_mfma_f32_32x32x16_bf16 v[80:95], a[204:207], a[92:95], v[80:95]
    buffer_load_dwordx4 v4, s[4:7], s53 offen offset:3072 lds
    ds_read_b128 a[192:195], v6 offset:34816
    s_waitcnt lgkmcnt(7)
    s_nop 0
    v_mfma_f32_32x32x16_bf16 v[32:47], a[160:163], a[96:99], v[32:47]
    ds_read_b128 a[196:199], v6 offset:38912
    v_mfma_f32_32x32x16_bf16 v[48:63], a[164:167], a[96:99], v[48:63]
    ds_read_b128 a[200:203], v6 offset:43008
    s_waitcnt lgkmcnt(7)
    s_nop 0
    v_mfma_f32_32x32x16_bf16 v[64:79], a[168:171], a[96:99], v[64:79]
    ds_read_b128 a[204:207], v6 offset:47104
    v_mfma_f32_32x32x16_bf16 v[80:95], a[172:175], a[96:99], v[80:95]
    ds_read_b128 a[160:163], v6 offset:35840
    s_waitcnt lgkmcnt(7)
    s_nop 0
    v_mfma_f32_32x32x16_bf16 v[32:47], a[176:179], a[100:103], v[32:47]
    ds_read_b128 a[164:167], v6 offset:39936
    v_mfma_f32_32x32x16_bf16 v[48:63], a[180:183], a[100:103], v[48:63]
    ds_read_b128 a[168:171], v6 offset:44032
    s_waitcnt lgkmcnt(7)
    s_nop 0
    v_mfma_f32_32x32x16_bf16 v[64:79], a[184:187], a[100:103], v[64:79]
    ds_read_b128 a[172:175], v6 offset:48128
    v_mfma_f32_32x32x16_bf16 v[80:95], a[188:191], a[100:103], v[80:95]
    s_waitcnt vmcnt(16)
    s_barrier
    ds_read_b128 a[176:179], v6 offset:49152
    s_waitcnt lgkmcnt(7)
    s_nop 0
    v_mfma_f32_32x32x16_bf16 v[32:47], a[192:195], a[104:107], v[32:47]
    s_add_u32 m0, s59, 0x8000
    s_add_u32 s53, s72, 0x28000
    buffer_load_dwordx4 v4, s[4:7], s53 offen lds
    ds_read_b128 a[180:183], v6 offset:53248
    v_mfma_f32_32x32x16_bf16 v[48:63], a[196:199], a[104:107], v[48:63]
    buffer_load_dwordx4 v4, s[4:7], s53 offen offset:1024 lds
    ds_read_b128 a[184:187], v6 offset:57344
    s_waitcnt lgkmcnt(7)
    s_nop 0
    v_mfma_f32_32x32x16_bf16 v[64:79], a[200:203], a[104:107], v[64:79]
    buffer_load_dwordx4 v4, s[4:7], s53 offen offset:2048 lds
    ds_read_b128 a[188:191], v6 offset:61440
    v_mfma_f32_32x32x16_bf16 v[80:95], a[204:207], a[104:107], v[80:95]
    buffer_load_dwordx4 v4, s[4:7], s53 offen offset:3072 lds
    ds_read_b128 a[192:195], v6 offset:50176
    s_waitcnt lgkmcnt(7)
    s_nop 0
    v_mfma_f32_32x32x16_bf16 v[32:47], a[160:163], a[108:111], v[32:47]
    ds_read_b128 a[196:199], v6 offset:54272
    v_mfma_f32_32x32x16_bf16 v[48:63], a[164:167], a[108:111], v[48:63]
    ds_read_b128 a[200:203], v6 offset:58368
    s_waitcnt lgkmcnt(7)
    s_nop 0
    v_mfma_f32_32x32x16_bf16 v[64:79], a[168:171], a[108:111], v[64:79]
    ds_read_b128 a[204:207], v6 offset:62464
    v_mfma_f32_32x32x16_bf16 v[80:95], a[172:175], a[108:111], v[80:95]
    ds_read_b128 a[160:163], v6 offset:51200
    s_waitcnt lgkmcnt(7)
    s_nop 0
    v_mfma_f32_32x32x16_bf16 v[32:47], a[176:179], a[112:115], v[32:47]
    ds_read_b128 a[164:167], v6 offset:55296
    v_mfma_f32_32x32x16_bf16 v[48:63], a[180:183], a[112:115], v[48:63]
    ds_read_b128 a[168:171], v6 offset:59392
    s_waitcnt lgkmcnt(7)
    s_nop 0
    v_mfma_f32_32x32x16_bf16 v[64:79], a[184:187], a[112:115], v[64:79]
    ds_read_b128 a[172:175], v6 offset:63488
    v_mfma_f32_32x32x16_bf16 v[80:95], a[188:191], a[112:115], v[80:95]
    ds_read_b128 a[176:179], v6 offset:52224
    s_waitcnt lgkmcnt(7)
    s_nop 0
    v_mfma_f32_32x32x16_bf16 v[32:47], a[192:195], a[116:119], v[32:47]
    ds_read_b128 a[180:183], v6 offset:56320
    v_mfma_f32_32x32x16_bf16 v[48:63], a[196:199], a[116:119], v[48:63]
    ds_read_b128 a[184:187], v6 offset:60416
    s_waitcnt lgkmcnt(7)
    s_nop 0
    v_mfma_f32_32x32x16_bf16 v[64:79], a[200:203], a[116:119], v[64:79]
    ds_read_b128 a[188:191], v6 offset:64512
    v_mfma_f32_32x32x16_bf16 v[80:95], a[204:207], a[116:119], v[80:95]
    s_waitcnt vmcnt(12)
    s_barrier
    ds_read_b128 a[192:195], v5
    s_waitcnt lgkmcnt(7)
    s_nop 0
    v_mfma_f32_32x32x16_bf16 v[32:47], a[160:163], a[120:123], v[32:47]
    s_add_u32 m0, s59, 0xc000
    s_add_u32 s53, s72, 0x2a000
    buffer_load_dwordx4 v4, s[4:7], s53 offen lds
    ds_read_b128 a[196:199], v5 offset:4096
    v_mfma_f32_32x32x16_bf16 v[48:63], a[164:167], a[120:123], v[48:63]
    buffer_load_dwordx4 v4, s[4:7], s53 offen offset:1024 lds
    ds_read_b128 a[200:203], v5 offset:8192
    s_waitcnt lgkmcnt(7)
    s_nop 0
    v_mfma_f32_32x32x16_bf16 v[64:79], a[168:171], a[120:123], v[64:79]
    buffer_load_dwordx4 v4, s[4:7], s53 offen offset:2048 lds
    ds_read_b128 a[204:207], v5 offset:12288
    v_mfma_f32_32x32x16_bf16 v[80:95], a[172:175], a[120:123], v[80:95]
    buffer_load_dwordx4 v4, s[4:7], s53 offen offset:3072 lds
    ds_read_b128 a[160:163], v5 offset:1024
    s_waitcnt lgkmcnt(7)
    s_nop 0
    v_mfma_f32_32x32x16_bf16 v[32:47], a[176:179], a[124:127], v[32:47]
    ds_read_b128 a[164:167], v5 offset:5120
    v_mfma_f32_32x32x16_bf16 v[48:63], a[180:183], a[124:127], v[48:63]
    ds_read_b128 a[168:171], v5 offset:9216
    s_waitcnt lgkmcnt(7)
    s_nop 0
    v_mfma_f32_32x32x16_bf16 v[64:79], a[184:187], a[124:127], v[64:79]
    ds_read_b128 a[172:175], v5 offset:13312
    v_mfma_f32_32x32x16_bf16 v[80:95], a[188:191], a[124:127], v[80:95]
    ds_read_b128 a[176:179], v5 offset:2048
    s_waitcnt lgkmcnt(7)
    s_nop 0
    v_mfma_f32_32x32x16_bf16 v[32:47], a[192:195], a[128:131], v[32:47]
    ds_read_b128 a[180:183], v5 offset:6144
    v_mfma_f32_32x32x16_bf16 v[48:63], a[196:199], a[128:131], v[48:63]
    ds_read_b128 a[184:187], v5 offset:10240
    s_waitcnt lgkmcnt(7)
    s_nop 0
    v_mfma_f32_32x32x16_bf16 v[64:79], a[200:203], a[128:131], v[64:79]
    ds_read_b128 a[188:191], v5 offset:14336
    v_mfma_f32_32x32x16_bf16 v[80:95], a[204:207], a[128:131], v[80:95]
    ds_read_b128 a[192:195], v5 offset:3072
    s_waitcnt lgkmcnt(7)
    s_nop 0
    v_mfma_f32_32x32x16_bf16 v[32:47], a[160:163], a[132:135], v[32:47]
    ds_read_b128 a[196:199], v5 offset:7168
    v_mfma_f32_32x32x16_bf16 v[48:63], a[164:167], a[132:135], v[48:63]
    ds_read_b128 a[200:203], v5 offset:11264
    s_waitcnt lgkmcnt(7)
    s_nop 0
    v_mfma_f32_32x32x16_bf16 v[64:79], a[168:171], a[132:135], v[64:79]
    ds_read_b128 a[204:207], v5 offset:15360
    v_mfma_f32_32x32x16_bf16 v[80:95], a[172:175], a[132:135], v[80:95]
    s_waitcnt vmcnt(8)
    s_barrier
    ds_read_b128 a[160:163], v5 offset:16384
    s_waitcnt lgkmcnt(7)
    s_nop 0
    v_mfma_f32_32x32x16_bf16 v[32:47], a[176:179], a[136:139], v[32:47]
    s_add_u32 m0, s59, 0x10000
    s_add_u32 s53, s72, 0x2c000
    buffer_load_dwordx4 v4, s[4:7], s53 offen lds
    ds_read_b128 a[164:167], v5 offset:20480
    v_mfma_f32_32x32x16_bf16 v[48:63], a[180:183], a[136:139], v[48:63]
    buffer_load_dwordx4 v4, s[4:7], s53 offen offset:1024 lds
    ds_read_b128 a[168:171], v5 offset:24576
    s_waitcnt lgkmcnt(7)
    s_nop 0
    v_mfma_f32_32x32x16_bf16 v[64:79], a[184:187], a[136:139], v[64:79]
    buffer_load_dwordx4 v4, s[4:7], s53 offen offset:2048 lds
    ds_read_b128 a[172:175], v5 offset:28672
    v_mfma_f32_32x32x16_bf16 v[80:95], a[188:191], a[136:139], v[80:95]
    buffer_load_dwordx4 v4, s[4:7], s53 offen offset:3072 lds
    ds_read_b128 a[176:179], v5 offset:17408
    s_waitcnt lgkmcnt(7)
    s_nop 0
    v_mfma_f32_32x32x16_bf16 v[32:47], a[192:195], a[140:143], v[32:47]
    ds_read_b128 a[180:183], v5 offset:21504
    v_mfma_f32_32x32x16_bf16 v[48:63], a[196:199], a[140:143], v[48:63]
    ds_read_b128 a[184:187], v5 offset:25600
    s_waitcnt lgkmcnt(7)
    s_nop 0
    v_mfma_f32_32x32x16_bf16 v[64:79], a[200:203], a[140:143], v[64:79]
    ds_read_b128 a[188:191], v5 offset:29696
    v_mfma_f32_32x32x16_bf16 v[80:95], a[204:207], a[140:143], v[80:95]
    ds_read_b128 a[192:195], v5 offset:18432
    s_waitcnt lgkmcnt(7)
    s_nop 0
    v_mfma_f32_32x32x16_bf16 v[32:47], a[160:163], a[144:147], v[32:47]
    ds_read_b128 a[196:199], v5 offset:22528
    v_mfma_f32_32x32x16_bf16 v[48:63], a[164:167], a[144:147], v[48:63]
    ds_read_b128 a[200:203], v5 offset:26624
    s_waitcnt lgkmcnt(7)
    s_nop 0
    v_mfma_f32_32x32x16_bf16 v[64:79], a[168:171], a[144:147], v[64:79]
    ds_read_b128 a[204:207], v5 offset:30720
    v_mfma_f32_32x32x16_bf16 v[80:95], a[172:175], a[144:147], v[80:95]
    ds_read_b128 a[160:163], v5 offset:19456
    s_waitcnt lgkmcnt(7)
    s_nop 0
    v_mfma_f32_32x32x16_bf16 v[32:47], a[176:179], a[148:151], v[32:47]
    ds_read_b128 a[164:167], v5 offset:23552
    v_mfma_f32_32x32x16_bf16 v[48:63], a[180:183], a[148:151], v[48:63]
    ds_read_b128 a[168:171], v5 offset:27648
    s_waitcnt lgkmcnt(7)
    s_nop 0
    v_mfma_f32_32x32x16_bf16 v[64:79], a[184:187], a[148:151], v[64:79]
    ds_read_b128 a[172:175], v5 offset:31744
    v_mfma_f32_32x32x16_bf16 v[80:95], a[188:191], a[148:151], v[80:95]
    s_waitcnt vmcnt(8)
    s_barrier
    ds_read_b128 a[176:179], v5 offset:32768
    s_waitcnt lgkmcnt(7)
    s_nop 0
    v_mfma_f32_32x32x16_bf16 v[32:47], a[192:195], a[152:155], v[32:47]
    s_add_u32 m0, s59, 0x14000
    s_add_u32 s53, s72, 0x2e000
    buffer_load_dwordx4 v4, s[4:7], s53 offen lds
    ds_read_b128 a[180:183], v5 offset:36864
    v_mfma_f32_32x32x16_bf16 v[48:63], a[196:199], a[152:155], v[48:63]
    buffer_load_dwordx4 v4, s[4:7], s53 offen offset:1024 lds
    ds_read_b128 a[184:187], v5 offset:33792
    s_waitcnt lgkmcnt(7)
    s_nop 0
    v_mfma_f32_32x32x16_bf16 v[64:79], a[200:203], a[152:155], v[64:79]
    buffer_load_dwordx4 v4, s[4:7], s53 offen offset:2048 lds
    ds_read_b128 a[188:191], v5 offset:37888
    v_mfma_f32_32x32x16_bf16 v[80:95], a[204:207], a[152:155], v[80:95]
    buffer_load_dwordx4 v4, s[4:7], s53 offen offset:3072 lds
    ds_read_b128 a[192:195], v5 offset:34816
    s_waitcnt lgkmcnt(7)
    s_nop 0
    v_mfma_f32_32x32x16_bf16 v[32:47], a[160:163], a[156:159], v[32:47]
    v_mfma_f32_32x32x16_bf16 v[32:47], a[208:211], v[208:211], v[32:47]
    s_add_u32 m0, s59, 0x18000
    s_add_u32 s53, s72, 0x30000
    buffer_load_dwordx4 v4, s[4:7], s53 offen lds
    ds_read_b128 a[196:199], v5 offset:38912
    v_mfma_f32_32x32x16_bf16 v[48:63], a[164:167], a[156:159], v[48:63]
    v_mfma_f32_32x32x16_bf16 v[48:63], a[212:215], v[208:211], v[48:63]
    buffer_load_dwordx4 v4, s[4:7], s53 offen offset:1024 lds
    ds_read_b128 a[200:203], v5 offset:35840
    s_waitcnt lgkmcnt(7)
    s_nop 0
    v_mfma_f32_32x32x16_bf16 v[64:79], a[168:171], a[156:159], v[64:79]
    v_mfma_f32_32x32x16_bf16 v[64:79], a[216:219], v[208:211], v[64:79]
    buffer_load_dwordx4 v4, s[4:7], s53 offen offset:2048 lds
    ds_read_b128 a[204:207], v5 offset:39936
    v_mfma_f32_32x32x16_bf16 v[80:95], a[172:175], a[156:159], v[80:95]
    v_mfma_f32_32x32x16_bf16 v[80:95], a[220:223], v[208:211], v[80:95]
    buffer_load_dwordx4 v4, s[4:7], s53 offen offset:3072 lds
    ds_read_b128 a[160:163], v5 offset:40960
    s_waitcnt lgkmcnt(7)
    s_nop 0
    v_mfma_f32_32x32x16_bf16 v[96:111], a[176:179], a[0:3], 0
    s_add_u32 m0, s59, 0x1c000
    s_add_u32 s53, s55, 0x3c000
    s_add_u32 s53, s53, s59
    s_nop 0
    buffer_load_dwordx4 v4, s[4:7], s53 offen lds
    ds_read_b128 a[164:167], v5 offset:45056
    v_mfma_f32_32x32x16_bf16 v[112:127], a[180:183], a[0:3], 0
    buffer_load_dwordx4 v4, s[4:7], s53 offen offset:1024 lds
    v_mul_f32_e64 v176, v12, v32
    ds_read_b128 a[168:171], v5 offset:41984
    s_waitcnt lgkmcnt(7)
    v_mfma_f32_32x32x16_bf16 v[96:111], a[184:187], a[4:7], v[96:111]
    buffer_load_dwordx4 v4, s[4:7], s53 offen offset:2048 lds
    v_mul_f32 v177, v12, v33
    v_mul_f32_e64 v178, v12, v34
    ds_read_b128 a[172:175], v5 offset:46080
    v_mfma_f32_32x32x16_bf16 v[112:127], a[188:191], a[4:7], v[112:127]
    buffer_load_dwordx4 v4, s[4:7], s53 offen offset:3072 lds
    v_mul_f32 v179, v12, v35
    v_mul_f32 v180, v12, v36
    ds_read_b128 a[176:179], v5 offset:43008
    s_waitcnt lgkmcnt(7)
    v_mfma_f32_32x32x16_bf16 v[96:111], a[192:195], a[8:11], v[96:111]
    v_mul_f32 v181, v12, v37
    v_mul_f32 v182, v12, v38
    v_mul_f32 v183, v12, v39
    v_exp_f32_e64 v176, v176
    ds_read_b128 a[180:183], v5 offset:47104
    v_mfma_f32_32x32x16_bf16 v[112:127], a[196:199], a[8:11], v[112:127]
    v_mul_f32 v32, v32, v40
    v_exp_f32 v177, v177
    v_mul_f32 v33, v33, v41
    v_exp_f32 v178, v178
    ds_read_b128 a[184:187], v5 offset:44032
    s_waitcnt lgkmcnt(7)
    v_mfma_f32_32x32x16_bf16 v[96:111], a[200:203], a[12:15], v[96:111]
    v_mul_f32 v34, v34, v42
    v_exp_f32 v179, v179
    v_mul_f32 v35, v35, v43
    v_exp_f32_e64 v180, v180
    ds_read_b128 a[188:191], v5 offset:48128
    v_mfma_f32_32x32x16_bf16 v[112:127], a[204:207], a[12:15], v[112:127]
    v_mul_f32 v36, v36, v44
    v_exp_f32 v181, v181
    v_mul_f32 v37, v37, v45
    v_exp_f32 v182, v182
    s_waitcnt vmcnt(16)
    s_barrier
    ds_read_b128 a[192:195], v5 offset:49152
    s_waitcnt lgkmcnt(7)
    v_mfma_f32_32x32x16_bf16 v[96:111], a[160:163], a[16:19], v[96:111]
    s_add_u32 m0, s59, 0
    s_add_u32 s53, s55, 0x40000
    s_add_u32 s53, s53, s59
    buffer_load_dwordx4 v4, s[4:7], s53 offen lds
    v_mul_f32 v38, v38, v46
    v_exp_f32_e64 v183, v183
    ds_read_b128 a[196:199], v5 offset:53248
    v_mfma_f32_32x32x16_bf16 v[112:127], a[164:167], a[16:19], v[112:127]
    buffer_load_dwordx4 v4, s[4:7], s53 offen offset:1024 lds
    v_mul_f32_e64 v39, v39, v47
    v_fma_f32 v176, v176, v14, v14
    ds_read_b128 a[200:203], v5 offset:50176
    s_waitcnt lgkmcnt(7)
    s_nop 0
    v_mfma_f32_32x32x16_bf16 v[96:111], a[168:171], a[20:23], v[96:111]
    buffer_load_dwordx4 v4, s[4:7], s53 offen offset:2048 lds
    v_fma_f32 v177, v177, v14, v14
    v_fma_f32 v178, v178, v14, v14
    ds_read_b128 a[204:207], v5 offset:54272
    v_mfma_f32_32x32x16_bf16 v[112:127], a[172:175], a[20:23], v[112:127]
    buffer_load_dwordx4 v4, s[4:7], s53 offen offset:3072 lds
    v_fma_f32 v179, v179, v14, v14
    v_fma_f32 v180, v180, v14, v14
    ds_read_b128 a[160:163], v5 offset:51200
    s_waitcnt lgkmcnt(7)
    s_nop 0
    v_mfma_f32_32x32x16_bf16 v[96:111], a[176:179], a[24:27], v[96:111]
    v_fma_f32 v181, v181, v14, v14
    v_fma_f32 v182, v182, v14, v14
    v_fma_f32 v183, v183, v14, v14
    v_rcp_f32_e64 v176, v176
    ds_read_b128 a[164:167], v5 offset:55296
    v_mfma_f32_32x32x16_bf16 v[112:127], a[180:183], a[24:27], v[112:127]
    v_rcp_f32 v177, v177
    v_rcp_f32 v178, v178
    v_rcp_f32 v179, v179
    v_rcp_f32 v180, v180
    ds_read_b128 a[168:171], v5 offset:52224
    s_waitcnt lgkmcnt(7)
    v_mfma_f32_32x32x16_bf16 v[96:111], a[184:187], a[28:31], v[96:111]
    v_rcp_f32 v181, v181
    v_rcp_f32 v182, v182
    v_rcp_f32 v183, v183
    v_mul_f32_e64 v32, v32, v176
    ds_read_b128 a[172:175], v5 offset:56320
    v_mfma_f32_32x32x16_bf16 v[112:127], a[188:191], a[28:31], v[112:127]
    v_mul_f32 v33, v33, v177
    v_mul_f32 v34, v34, v178
    v_mul_f32 v35, v35, v179
    v_mul_f32 v36, v36, v180
    ds_read_b128 a[176:179], v5 offset:57344
    s_waitcnt lgkmcnt(7)
    v_mfma_f32_32x32x16_bf16 v[96:111], a[192:195], a[32:35], v[96:111]
    v_mul_f32 v37, v37, v181
    v_mul_f32 v38, v38, v182
    v_mul_f32 v39, v39, v183
    v_cvt_pk_bf16_f32 v184, v32, v33
    ds_read_b128 a[180:183], v5 offset:61440
    v_mfma_f32_32x32x16_bf16 v[112:127], a[196:199], a[32:35], v[112:127]
    v_cvt_pk_bf16_f32 v185, v34, v35
    v_cvt_pk_bf16_f32 v186, v36, v37
    v_cvt_pk_bf16_f32 v187, v38, v39
    buffer_store_dwordx4 v[184:187], v9, s[4:7], s64 offen sc1
    ds_read_b128 a[184:187], v5 offset:58368
    s_waitcnt lgkmcnt(7)
    v_mfma_f32_32x32x16_bf16 v[96:111], a[200:203], a[36:39], v[96:111]
    v_mul_f32 v192, v12, v48
    v_mul_f32 v193, v12, v49
    v_mul_f32 v194, v12, v50
    ds_read_b128 a[188:191], v5 offset:62464
    v_mfma_f32_32x32x16_bf16 v[112:127], a[204:207], a[36:39], v[112:127]
    v_mul_f32 v195, v12, v51
    v_mul_f32 v196, v12, v52
    v_mul_f32 v197, v12, v53
    v_mul_f32 v198, v12, v54
    ds_read_b128 a[192:195], v5 offset:59392
    s_waitcnt lgkmcnt(7)
    v_mfma_f32_32x32x16_bf16 v[96:111], a[160:163], a[40:43], v[96:111]
    v_mul_f32 v199, v12, v55
    v_exp_f32 v192, v192
    v_mul_f32 v48, v48, v56
    v_exp_f32_e64 v193, v193
    ds_read_b128 a[196:199], v5 offset:63488
    v_mfma_f32_32x32x16_bf16 v[112:127], a[164:167], a[40:43], v[112:127]
    v_mul_f32 v49, v49, v57
    v_exp_f32 v194, v194
    v_mul_f32 v50, v50, v58
    v_exp_f32 v195, v195
    ds_read_b128 a[200:203], v5 offset:60416
    s_waitcnt lgkmcnt(7)
    v_mfma_f32_32x32x16_bf16 v[96:111], a[168:171], a[44:47], v[96:111]
    v_mul_f32 v51, v51, v59
    v_exp_f32 v196, v196
    v_mul_f32 v52, v52, v60
    v_exp_f32_e64 v197, v197
    ds_read_b128 a[204:207], v5 offset:64512
    v_mfma_f32_32x32x16_bf16 v[112:127], a[172:175], a[44:47], v[112:127]
    v_mul_f32 v53, v53, v61
    v_exp_f32 v198, v198
    v_mul_f32 v54, v54, v62
    v_exp_f32 v199, v199
    s_waitcnt vmcnt(17)
    s_barrier
    ds_read_b128 a[160:163], v6
    s_waitcnt lgkmcnt(7)
    s_nop 0
    v_mfma_f32_32x32x16_bf16 v[96:111], a[176:179], a[48:51], v[96:111]
    s_add_u32 m0, s59, 0x4000
    s_add_u32 s53, s55, 0x44000
    s_add_u32 s53, s53, s59
    buffer_load_dwordx4 v4, s[4:7], s53 offen lds
    v_mul_f32 v55, v55, v63
    v_fma_f32 v192, v192, v14, v14
    ds_read_b128 a[164:167], v6 offset:4096
    v_mfma_f32_32x32x16_bf16 v[112:127], a[180:183], a[48:51], v[112:127]
    buffer_load_dwordx4 v4, s[4:7], s53 offen offset:1024 lds
    v_fma_f32 v193, v193, v14, v14
    v_fma_f32 v194, v194, v14, v14
    ds_read_b128 a[168:171], v6 offset:1024
    s_waitcnt lgkmcnt(7)
    s_nop 0
    v_mfma_f32_32x32x16_bf16 v[96:111], a[184:187], a[52:55], v[96:111]
    buffer_load_dwordx4 v4, s[4:7], s53 offen offset:2048 lds
    v_fma_f32 v195, v195, v14, v14
    v_fma_f32 v196, v196, v14, v14
    ds_read_b128 a[172:175], v6 offset:5120
    v_mfma_f32_32x32x16_bf16 v[112:127], a[188:191], a[52:55], v[112:127]
    buffer_load_dwordx4 v4, s[4:7], s53 offen offset:3072 lds
    v_fma_f32 v197, v197, v14, v14
    v_fma_f32 v198, v198, v14, v14
    ds_read_b128 a[176:179], v6 offset:2048
    s_waitcnt lgkmcnt(7)
    v_mfma_f32_32x32x16_bf16 v[96:111], a[192:195], a[56:59], v[96:111]
    v_fma_f32 v199, v199, v14, v14
    v_rcp_f32 v192, v192
    v_rcp_f32 v193, v193
    v_rcp_f32 v194, v194
    ds_read_b128 a[180:183], v6 offset:6144
    v_mfma_f32_32x32x16_bf16 v[112:127], a[196:199], a[56:59], v[112:127]
    v_rcp_f32 v195, v195
    v_rcp_f32 v196, v196
    v_rcp_f32 v197, v197
    v_rcp_f32 v198, v198
    ds_read_b128 a[184:187], v6 offset:3072
    s_waitcnt lgkmcnt(7)
    v_mfma_f32_32x32x16_bf16 v[96:111], a[200:203], a[60:63], v[96:111]
    v_rcp_f32 v199, v199
    v_mul_f32 v48, v48, v192
    v_mul_f32 v49, v49, v193
    v_mul_f32_e64 v50, v50, v194
    ds_read_b128 a[188:191], v6 offset:7168
    v_mfma_f32_32x32x16_bf16 v[112:127], a[204:207], a[60:63], v[112:127]
    v_mul_f32 v51, v51, v195
    v_mul_f32 v52, v52, v196
    v_mul_f32 v53, v53, v197
    v_mul_f32 v54, v54, v198
    ds_read_b128 a[192:195], v6 offset:8192
    s_waitcnt lgkmcnt(7)
    v_mfma_f32_32x32x16_bf16 v[96:111], a[160:163], a[64:67], v[96:111]
    v_mul_f32 v55, v55, v199
    v_cvt_pk_bf16_f32 v200, v48, v49
    v_cvt_pk_bf16_f32 v201, v50, v51
    v_cvt_pk_bf16_f32 v202, v52, v53
    ds_read_b128 a[196:199], v6 offset:12288
    v_mfma_f32_32x32x16_bf16 v[112:127], a[164:167], a[64:67], v[112:127]
    v_cvt_pk_bf16_f32 v203, v54, v55
    buffer_store_dwordx4 v[200:203], v9, s[4:7], s65 offen sc1
    v_mul_f32_e64 v176, v12, v64
    ds_read_b128 a[200:203], v6 offset:9216
    s_waitcnt lgkmcnt(7)
    v_mfma_f32_32x32x16_bf16 v[96:111], a[168:171], a[68:71], v[96:111]
    v_mul_f32 v177, v12, v65
    v_mul_f32 v178, v12, v66
    v_mul_f32 v179, v12, v67
    v_mul_f32_e64 v180, v12, v68
    ds_read_b128 a[204:207], v6 offset:13312
    v_mfma_f32_32x32x16_bf16 v[112:127], a[172:175], a[68:71], v[112:127]
    v_mul_f32 v181, v12, v69
    v_mul_f32 v182, v12, v70
    v_mul_f32 v183, v12, v71
    v_exp_f32 v176, v176
    ds_read_b128 a[160:163], v6 offset:10240
    s_waitcnt lgkmcnt(7)
    v_mfma_f32_32x32x16_bf16 v[96:111], a[176:179], a[72:75], v[96:111]
    v_mul_f32 v64, v64, v72
    v_exp_f32 v177, v177
    v_mul_f32 v65, v65, v73
    v_exp_f32_e64 v178, v178
    ds_read_b128 a[164:167], v6 offset:14336
    v_mfma_f32_32x32x16_bf16 v[112:127], a[180:183], a[72:75], v[112:127]
    v_mul_f32 v66, v66, v74
    v_exp_f32 v179, v179
    v_mul_f32 v67, v67, v75
    v_exp_f32 v180, v180
    ds_read_b128 a[168:171], v6 offset:11264
    s_waitcnt lgkmcnt(7)
    v_mfma_f32_32x32x16_bf16 v[96:111], a[184:187], a[76:79], v[96:111]
    v_mul_f32 v68, v68, v76
    v_exp_f32 v181, v181
    v_mul_f32 v69, v69, v77
    v_exp_f32_e64 v182, v182
    ds_read_b128 a[172:175], v6 offset:15360
    v_mfma_f32_32x32x16_bf16 v[112:127], a[188:191], a[76:79], v[112:127]
    v_mul_f32 v70, v70, v78
    v_exp_f32 v183, v183
    v_mul_f32_e64 v71, v71, v79
    v_fma_f32 v176, v176, v14, v14
    s_waitcnt vmcnt(18)
    s_barrier
    ds_read_b128 a[176:179], v6 offset:16384
    s_waitcnt lgkmcnt(7)
    s_nop 0
    v_mfma_f32_32x32x16_bf16 v[96:111], a[192:195], a[80:83], v[96:111]
    s_add_u32 m0, s75, 0x22000
    s_add_u32 s76, s74, 0x118000
    buffer_load_dwordx4 v4, s[4:7], s76 offen lds
    v_fma_f32 v177, v177, v14, v14
    v_fma_f32 v178, v178, v14, v14
    ds_read_b128 a[180:183], v6 offset:20480
    v_mfma_f32_32x32x16_bf16 v[112:127], a[196:199], a[80:83], v[112:127]
    buffer_load_dwordx4 v4, s[4:7], s76 offen offset:1024 lds
    v_fma_f32 v179, v179, v14, v14
    v_fma_f32 v180, v180, v14, v14
    ds_read_b128 a[184:187], v6 offset:17408
    s_waitcnt lgkmcnt(7)
    s_nop 0
    v_mfma_f32_32x32x16_bf16 v[96:111], a[200:203], a[84:87], v[96:111]
    buffer_load_dwordx4 v4, s[4:7], s76 offen offset:2048 lds
    v_fma_f32 v181, v181, v14, v14
    v_fma_f32 v182, v182, v14, v14
    ds_read_b128 a[188:191], v6 offset:21504
    v_mfma_f32_32x32x16_bf16 v[112:127], a[204:207], a[84:87], v[112:127]
    buffer_load_dwordx4 v4, s[4:7], s76 offen offset:3072 lds
    v_fma_f32 v183, v183, v14, v14
    v_rcp_f32_e64 v176, v176
    ds_read_b128 a[192:195], v6 offset:18432
    s_waitcnt lgkmcnt(7)
    s_nop 0
    v_mfma_f32_32x32x16_bf16 v[96:111], a[160:163], a[88:91], v[96:111]
    s_add_u32 m0, s75, 0x23000
    s_add_u32 s76, s74, 0x119000
    buffer_load_dwordx4 v4, s[4:7], s76 offen lds
    v_rcp_f32 v177, v177
    v_rcp_f32 v178, v178
    ds_read_b128 a[196:199], v6 offset:22528
    v_mfma_f32_32x32x16_bf16 v[112:127], a[164:167], a[88:91], v[112:127]
    s_add_u32 m0, s75, 0x8000
    s_add_u32 s76, s74, 0x140000
    buffer_load_dwordx4 v4, s[4:7], s76 offen lds
    v_rcp_f32 v179, v179
    v_rcp_f32 v180, v180
    ds_read_b128 a[200:203], v6 offset:19456
    s_waitcnt lgkmcnt(7)
    v_mfma_f32_32x32x16_bf16 v[96:111], a[168:171], a[92:95], v[96:111]
    buffer_load_dwordx4 v4, s[4:7], s76 offen offset:1024 lds
    v_rcp_f32 v181, v181
    v_rcp_f32_e64 v182, v182
    ds_read_b128 a[204:207], v6 offset:23552
    v_mfma_f32_32x32x16_bf16 v[112:127], a[172:175], a[92:95], v[112:127]
    buffer_load_dwordx4 v4, s[4:7], s76 offen offset:2048 lds
    v_rcp_f32 v183, v183
    v_mul_f32 v64, v64, v176
    ds_read_b128 a[160:163], v6 offset:24576
    s_waitcnt lgkmcnt(7)
    v_mfma_f32_32x32x16_bf16 v[96:111], a[176:179], a[96:99], v[96:111]
    buffer_load_dwordx4 v4, s[4:7], s76 offen offset:3072 lds
    v_mul_f32 v65, v65, v177
    v_mul_f32_e64 v66, v66, v178
    ds_read_b128 a[164:167], v6 offset:28672
    v_mfma_f32_32x32x16_bf16 v[112:127], a[180:183], a[96:99], v[112:127]
    s_add_u32 m0, s75, 0x9000
    s_add_u32 s76, s74, 0x141000
    buffer_load_dwordx4 v4, s[4:7], s76 offen lds
    v_mul_f32 v67, v67, v179
    v_mul_f32 v68, v68, v180
    ds_read_b128 a[168:171], v6 offset:25600
    s_waitcnt lgkmcnt(7)
    v_mfma_f32_32x32x16_bf16 v[96:111], a[184:187], a[100:103], v[96:111]
    v_mul_f32 v69, v69, v181
    v_mul_f32 v70, v70, v182
    v_mul_f32 v71, v71, v183
    v_cvt_pk_bf16_f32 v184, v64, v65
    ds_read_b128 a[172:175], v6 offset:29696
    v_mfma_f32_32x32x16_bf16 v[112:127], a[188:191], a[100:103], v[112:127]
    v_cvt_pk_bf16_f32 v185, v66, v67
    v_cvt_pk_bf16_f32 v186, v68, v69
    v_cvt_pk_bf16_f32 v187, v70, v71
    buffer_store_dwordx4 v[184:187], v9, s[4:7], s66 offen sc1
    ds_read_b128 a[176:179], v6 offset:26624
    s_waitcnt lgkmcnt(7)
    v_mfma_f32_32x32x16_bf16 v[96:111], a[192:195], a[104:107], v[96:111]
    v_mul_f32 v192, v12, v80
    v_mul_f32 v193, v12, v81
    v_mul_f32 v194, v12, v82
    ds_read_b128 a[180:183], v6 offset:30720
    v_mfma_f32_32x32x16_bf16 v[112:127], a[196:199], a[104:107], v[112:127]
    v_mul_f32 v195, v12, v83
    v_mul_f32 v196, v12, v84
    v_mul_f32 v197, v12, v85
    v_mul_f32 v198, v12, v86
    ds_read_b128 a[184:187], v6 offset:27648
    s_waitcnt lgkmcnt(7)
    v_mfma_f32_32x32x16_bf16 v[96:111], a[200:203], a[108:111], v[96:111]
    v_mul_f32 v199, v12, v87
    v_exp_f32 v192, v192
    v_mul_f32 v80, v80, v88
    v_exp_f32_e64 v193, v193
    ds_read_b128 a[188:191], v6 offset:31744
    v_mfma_f32_32x32x16_bf16 v[112:127], a[204:207], a[108:111], v[112:127]
    v_mul_f32 v81, v81, v89
    v_exp_f32 v194, v194
    v_mul_f32 v82, v82, v90
    v_exp_f32 v195, v195
    s_waitcnt vmcnt(25)
    s_barrier
    ds_read_b128 a[192:195], v6 offset:32768
    s_waitcnt lgkmcnt(7)
    s_nop 0
    v_mfma_f32_32x32x16_bf16 v[96:111], a[160:163], a[112:115], v[96:111]
    s_add_u32 m0, s75, 0xd000
    s_add_u32 s76, s74, 0x168000
    buffer_load_dwordx4 v4, s[4:7], s76 offen lds
    v_mul_f32 v83, v83, v91
    v_exp_f32 v196, v196
    ds_read_b128 a[196:199], v6 offset:36864
    v_mfma_f32_32x32x16_bf16 v[112:127], a[164:167], a[112:115], v[112:127]
    buffer_load_dwordx4 v4, s[4:7], s76 offen offset:1024 lds
    v_mul_f32 v84, v84, v92
    v_exp_f32 v197, v197
    ds_read_b128 a[200:203], v6 offset:33792
    s_waitcnt lgkmcnt(7)
    v_mfma_f32_32x32x16_bf16 v[96:111], a[168:171], a[116:119], v[96:111]
    buffer_load_dwordx4 v4, s[4:7], s76 offen offset:2048 lds
    v_mul_f32 v85, v85, v93
    v_exp_f32_e64 v198, v198
    ds_read_b128 a[204:207], v6 offset:37888
    v_mfma_f32_32x32x16_bf16 v[112:127], a[172:175], a[116:119], v[112:127]
    buffer_load_dwordx4 v4, s[4:7], s76 offen offset:3072 lds
    v_mul_f32 v86, v86, v94
    v_exp_f32 v199, v199
    ds_read_b128 a[160:163], v6 offset:34816
    s_waitcnt lgkmcnt(7)
    s_nop 0
    v_mfma_f32_32x32x16_bf16 v[96:111], a[176:179], a[120:123], v[96:111]
    s_add_u32 m0, s75, 0xe000
    s_add_u32 s76, s74, 0x169000
    buffer_load_dwordx4 v4, s[4:7], s76 offen lds
    v_mul_f32_e64 v87, v87, v95
    v_fma_f32 v192, v192, v14, v14
    ds_read_b128 a[164:167], v6 offset:38912
    v_mfma_f32_32x32x16_bf16 v[112:127], a[180:183], a[120:123], v[112:127]
    v_fma_f32 v193, v193, v14, v14
    v_fma_f32 v194, v194, v14, v14
    v_fma_f32 v195, v195, v14, v14
    v_fma_f32 v196, v196, v14, v14
    ds_read_b128 a[168:171], v6 offset:35840
    s_waitcnt lgkmcnt(7)
    s_nop 0
    v_mfma_f32_32x32x16_bf16 v[96:111], a[184:187], a[124:127], v[96:111]
    v_fma_f32 v197, v197, v14, v14
    v_fma_f32 v198, v198, v14, v14
    v_fma_f32 v199, v199, v14, v14
    v_rcp_f32_e64 v192, v192
    ds_read_b128 a[172:175], v6 offset:39936
    v_mfma_f32_32x32x16_bf16 v[112:127], a[188:191], a[124:127], v[112:127]
    v_rcp_f32 v193, v193
    v_rcp_f32 v194, v194
    v_rcp_f32 v195, v195
    v_rcp_f32 v196, v196
    ds_read_b128 a[176:179], v6 offset:40960
    s_waitcnt lgkmcnt(7)
    v_mfma_f32_32x32x16_bf16 v[96:111], a[192:195], a[128:131], v[96:111]
    v_rcp_f32 v197, v197
    v_rcp_f32 v198, v198
    v_rcp_f32 v199, v199
    v_mul_f32_e64 v80, v80, v192
    ds_read_b128 a[180:183], v6 offset:45056
    v_mfma_f32_32x32x16_bf16 v[112:127], a[196:199], a[128:131], v[112:127]
    v_mul_f32 v81, v81, v193
    v_mul_f32 v82, v82, v194
    v_mul_f32 v83, v83, v195
    v_mul_f32 v84, v84, v196
    ds_read_b128 a[184:187], v6 offset:41984
    s_waitcnt lgkmcnt(7)
    v_mfma_f32_32x32x16_bf16 v[96:111], a[200:203], a[132:135], v[96:111]
    v_mul_f32 v85, v85, v197
    v_mul_f32 v86, v86, v198
    v_mul_f32 v87, v87, v199
    v_cvt_pk_bf16_f32 v200, v80, v81
    ds_read_b128 a[188:191], v6 offset:46080
    v_mfma_f32_32x32x16_bf16 v[112:127], a[204:207], a[132:135], v[112:127]
    v_cvt_pk_bf16_f32 v201, v82, v83
    v_cvt_pk_bf16_f32 v202, v84, v85
    v_cvt_pk_bf16_f32 v203, v86, v87
    buffer_store_dwordx4 v[200:203], v9, s[4:7], s67 offen sc1
    ds_read_b128 a[192:195], v6 offset:43008
    s_waitcnt lgkmcnt(7)
    s_nop 0
    v_mfma_f32_32x32x16_bf16 v[96:111], a[160:163], a[136:139], v[96:111]
    ds_read_b128 a[196:199], v6 offset:47104
    v_mfma_f32_32x32x16_bf16 v[112:127], a[164:167], a[136:139], v[112:127]
    ds_read_b128 a[200:203], v6 offset:44032
    s_waitcnt lgkmcnt(7)
    s_nop 0
    v_mfma_f32_32x32x16_bf16 v[96:111], a[168:171], a[140:143], v[96:111]
    ds_read_b128 a[204:207], v6 offset:48128
    v_mfma_f32_32x32x16_bf16 v[112:127], a[172:175], a[140:143], v[112:127]
    s_waitcnt vmcnt(27)
    s_barrier
    ds_read_b128 a[160:163], v6 offset:49152
    s_waitcnt lgkmcnt(7)
    s_nop 0
    v_mfma_f32_32x32x16_bf16 v[96:111], a[176:179], a[144:147], v[96:111]
    s_add_u32 m0, s75, 0x12000
    s_add_u32 s76, s74, 0x190000
    buffer_load_dwordx4 v4, s[4:7], s76 offen lds
    ds_read_b128 a[164:167], v6 offset:50176
    v_mfma_f32_32x32x16_bf16 v[112:127], a[180:183], a[144:147], v[112:127]
    buffer_load_dwordx4 v4, s[4:7], s76 offen offset:1024 lds
    ds_read_b128 a[168:171], v6 offset:51200
    s_waitcnt lgkmcnt(7)
    s_nop 0
    v_mfma_f32_32x32x16_bf16 v[96:111], a[184:187], a[148:151], v[96:111]
    buffer_load_dwordx4 v4, s[4:7], s76 offen offset:2048 lds
    ds_read_b128 a[172:175], v6 offset:52224
    v_mfma_f32_32x32x16_bf16 v[112:127], a[188:191], a[148:151], v[112:127]
    buffer_load_dwordx4 v4, s[4:7], s76 offen offset:3072 lds
    ds_read_b128 a[176:179], v6 offset:53248
    s_waitcnt lgkmcnt(7)
    s_nop 0
    v_mfma_f32_32x32x16_bf16 v[96:111], a[192:195], a[152:155], v[96:111]
    s_add_u32 m0, s75, 0x13000
    s_add_u32 s76, s74, 0x191000
    buffer_load_dwordx4 v4, s[4:7], s76 offen lds
    ds_read_b128 a[180:183], v6 offset:54272
    v_mfma_f32_32x32x16_bf16 v[112:127], a[196:199], a[152:155], v[112:127]
    ds_read_b128 a[184:187], v6 offset:55296
    s_waitcnt lgkmcnt(7)
    s_nop 0
    v_mfma_f32_32x32x16_bf16 v[96:111], a[200:203], a[156:159], v[96:111]
    v_mfma_f32_32x32x16_bf16 v[96:111], a[224:227], v[208:211], v[96:111]
    ds_read_b128 a[188:191], v6 offset:56320
    v_mfma_f32_32x32x16_bf16 v[112:127], a[204:207], a[156:159], v[112:127]
    v_mfma_f32_32x32x16_bf16 v[112:127], a[228:231], v[208:211], v[112:127]
    ds_read_b128 a[192:195], v6 offset:57344
    s_waitcnt lgkmcnt(7)
    s_nop 0
    v_mfma_f32_32x32x16_bf16 v[128:143], a[160:163], a[0:3], 0
    ds_read_b128 a[196:199], v6 offset:58368
    v_mfma_f32_32x32x16_bf16 v[128:143], a[164:167], a[4:7], v[128:143]
    s_nop 3
    v_mul_f32 v176, v12, v96
    v_mul_f32 v177, v12, v97
    v_mul_f32 v178, v12, v98
    ds_read_b128 a[200:203], v6 offset:59392
    s_waitcnt lgkmcnt(7)
    v_mfma_f32_32x32x16_bf16 v[128:143], a[168:171], a[8:11], v[128:143]
    v_mul_f32 v179, v12, v99
    v_mul_f32 v180, v12, v100
    v_mul_f32 v181, v12, v101
    v_mul_f32_e64 v182, v12, v102
    ds_read_b128 a[204:207], v6 offset:60416
    v_mfma_f32_32x32x16_bf16 v[128:143], a[172:175], a[12:15], v[128:143]
    v_mul_f32 v183, v12, v103
    v_exp_f32 v176, v176
    v_mul_f32 v96, v96, v104
    v_exp_f32 v177, v177
    ds_read_b128 a[160:163], v6 offset:61440
    s_waitcnt lgkmcnt(7)
    v_mfma_f32_32x32x16_bf16 v[128:143], a[176:179], a[16:19], v[128:143]
    v_mul_f32 v97, v97, v105
    v_exp_f32 v178, v178
    v_mul_f32 v98, v98, v106
    v_exp_f32_e64 v179, v179
    ds_read_b128 a[164:167], v6 offset:62464
    v_mfma_f32_32x32x16_bf16 v[128:143], a[180:183], a[20:23], v[128:143]
    v_mul_f32 v99, v99, v107
    v_exp_f32 v180, v180
    v_mul_f32 v100, v100, v108
    v_exp_f32 v181, v181
    ds_read_b128 a[168:171], v6 offset:63488
    s_waitcnt lgkmcnt(7)
    v_mfma_f32_32x32x16_bf16 v[128:143], a[184:187], a[24:27], v[128:143]
    v_mul_f32 v101, v101, v109
    v_exp_f32 v182, v182
    v_mul_f32 v102, v102, v110
    v_exp_f32_e64 v183, v183
    ds_read_b128 a[172:175], v6 offset:64512
    v_mfma_f32_32x32x16_bf16 v[128:143], a[188:191], a[28:31], v[128:143]
    v_mul_f32_e64 v103, v103, v111
    v_fma_f32 v176, v176, v14, v14
    v_fma_f32 v177, v177, v14, v14
    v_fma_f32 v178, v178, v14, v14
    s_waitcnt vmcnt(28)
    s_barrier
    ds_read_b128 a[176:179], v5
    s_waitcnt lgkmcnt(7)
    s_nop 0
    v_mfma_f32_32x32x16_bf16 v[128:143], a[192:195], a[32:35], v[128:143]
    s_add_u32 m0, s75, 0x17000
    s_add_u32 s76, s74, 0x1b8000
    buffer_load_dwordx4 v4, s[4:7], s76 offen lds
    v_fma_f32 v179, v179, v14, v14
    v_fma_f32 v180, v180, v14, v14
    ds_read_b128 a[180:183], v5 offset:1024
    v_mfma_f32_32x32x16_bf16 v[128:143], a[196:199], a[36:39], v[128:143]
    buffer_load_dwordx4 v4, s[4:7], s76 offen offset:1024 lds
    v_fma_f32 v181, v181, v14, v14
    v_fma_f32 v182, v182, v14, v14
    ds_read_b128 a[184:187], v5 offset:2048
    s_waitcnt lgkmcnt(7)
    s_nop 0
    v_mfma_f32_32x32x16_bf16 v[128:143], a[200:203], a[40:43], v[128:143]
    buffer_load_dwordx4 v4, s[4:7], s76 offen offset:2048 lds
    v_fma_f32 v183, v183, v14, v14
    v_rcp_f32_e64 v176, v176
    ds_read_b128 a[188:191], v5 offset:3072
    v_mfma_f32_32x32x16_bf16 v[128:143], a[204:207], a[44:47], v[128:143]
    buffer_load_dwordx4 v4, s[4:7], s76 offen offset:3072 lds
    v_rcp_f32 v177, v177
    v_rcp_f32 v178, v178
    ds_read_b128 a[192:195], v5 offset:4096
    s_waitcnt lgkmcnt(7)
    s_nop 0
    v_mfma_f32_32x32x16_bf16 v[128:143], a[160:163], a[48:51], v[128:143]
    s_add_u32 m0, s75, 0x18000
    s_add_u32 s76, s74, 0x1b9000
    buffer_load_dwordx4 v4, s[4:7], s76 offen lds
    v_rcp_f32 v179, v179
    v_rcp_f32 v180, v180
    ds_read_b128 a[196:199], v5 offset:5120
    v_mfma_f32_32x32x16_bf16 v[128:143], a[164:167], a[52:55], v[128:143]
    v_rcp_f32 v181, v181
    v_rcp_f32 v182, v182
    v_rcp_f32 v183, v183
    v_mul_f32 v96, v96, v176
    ds_read_b128 a[200:203], v5 offset:6144
    s_waitcnt lgkmcnt(7)
    v_mfma_f32_32x32x16_bf16 v[128:143], a[168:171], a[56:59], v[128:143]
    v_mul_f32 v97, v97, v177
    v_mul_f32 v98, v98, v178
    v_mul_f32 v99, v99, v179
    v_mul_f32_e64 v100, v100, v180
    ds_read_b128 a[204:207], v5 offset:7168
    v_mfma_f32_32x32x16_bf16 v[128:143], a[172:175], a[60:63], v[128:143]
    v_mul_f32 v101, v101, v181
    v_mul_f32 v102, v102, v182
    v_mul_f32_e64 v103, v103, v183
    v_cvt_pk_bf16_f32 v184, v96, v97
    ds_read_b128 a[160:163], v5 offset:8192
    s_waitcnt lgkmcnt(7)
    s_nop 0
    v_mfma_f32_32x32x16_bf16 v[128:143], a[176:179], a[64:67], v[128:143]
    v_cvt_pk_bf16_f32 v185, v98, v99
    v_cvt_pk_bf16_f32 v186, v100, v101
    v_cvt_pk_bf16_f32 v187, v102, v103
    buffer_store_dwordx4 v[184:187], v9, s[4:7], s68 offen sc1
    ds_read_b128 a[164:167], v5 offset:9216
    v_mfma_f32_32x32x16_bf16 v[128:143], a[180:183], a[68:71], v[128:143]
    v_mul_f32 v192, v12, v112
    v_mul_f32 v193, v12, v113
    v_mul_f32_e64 v194, v12, v114
    ds_read_b128 a[168:171], v5 offset:10240
    s_waitcnt lgkmcnt(7)
    v_mfma_f32_32x32x16_bf16 v[128:143], a[184:187], a[72:75], v[128:143]
    v_mul_f32 v195, v12, v115
    v_mul_f32 v196, v12, v116
    v_mul_f32 v197, v12, v117
    v_mul_f32_e64 v198, v12, v118
    ds_read_b128 a[172:175], v5 offset:11264
    v_mfma_f32_32x32x16_bf16 v[128:143], a[188:191], a[76:79], v[128:143]
    v_mul_f32 v199, v12, v119
    v_exp_f32 v192, v192
    v_mul_f32 v112, v112, v120
    v_exp_f32 v193, v193
    ds_read_b128 a[176:179], v5 offset:12288
    s_waitcnt lgkmcnt(7)
    v_mfma_f32_32x32x16_bf16 v[128:143], a[192:195], a[80:83], v[128:143]
    v_mul_f32 v113, v113, v121
    v_exp_f32 v194, v194
    v_mul_f32 v114, v114, v122
    v_exp_f32_e64 v195, v195
    ds_read_b128 a[180:183], v5 offset:13312
    v_mfma_f32_32x32x16_bf16 v[128:143], a[196:199], a[84:87], v[128:143]
    v_mul_f32 v115, v115, v123
    v_exp_f32 v196, v196
    v_mul_f32 v116, v116, v124
    v_exp_f32 v197, v197
    ds_read_b128 a[184:187], v5 offset:14336
    s_waitcnt lgkmcnt(7)
    v_mfma_f32_32x32x16_bf16 v[128:143], a[200:203], a[88:91], v[128:143]
    v_mul_f32 v117, v117, v125
    v_exp_f32 v198, v198
    v_mul_f32 v118, v118, v126
    v_exp_f32_e64 v199, v199
    ds_read_b128 a[188:191], v5 offset:15360
    v_mfma_f32_32x32x16_bf16 v[128:143], a[204:207], a[92:95], v[128:143]
    v_mul_f32_e64 v119, v119, v127
    v_fma_f32 v192, v192, v14, v14
    v_fma_f32 v193, v193, v14, v14
    v_fma_f32 v194, v194, v14, v14
    s_waitcnt vmcnt(29)
    s_barrier
    ds_read_b128 a[192:195], v5 offset:16384
    s_waitcnt lgkmcnt(7)
    s_nop 0
    v_mfma_f32_32x32x16_bf16 v[128:143], a[160:163], a[96:99], v[128:143]
    v_fma_f32 v195, v195, v14, v14
    v_fma_f32 v196, v196, v14, v14
    v_fma_f32 v197, v197, v14, v14
    v_fma_f32 v198, v198, v14, v14
    ds_read_b128 a[196:199], v5 offset:17408
    v_mfma_f32_32x32x16_bf16 v[128:143], a[164:167], a[100:103], v[128:143]
    v_fma_f32 v199, v199, v14, v14
    v_rcp_f32 v192, v192
    v_rcp_f32 v193, v193
    v_rcp_f32_e64 v194, v194
    ds_read_b128 a[200:203], v5 offset:18432
    s_waitcnt lgkmcnt(7)
    v_mfma_f32_32x32x16_bf16 v[128:143], a[168:171], a[104:107], v[128:143]
    v_rcp_f32 v195, v195
    v_rcp_f32 v196, v196
    v_rcp_f32 v197, v197
    v_rcp_f32_e64 v198, v198
    ds_read_b128 a[204:207], v5 offset:19456
    v_mfma_f32_32x32x16_bf16 v[128:143], a[172:175], a[108:111], v[128:143]
    v_rcp_f32 v199, v199
    v_mul_f32 v112, v112, v192
    v_mul_f32 v113, v113, v193
    v_mul_f32 v114, v114, v194
    ds_read_b128 a[160:163], v5 offset:20480
    s_waitcnt lgkmcnt(7)
    v_mfma_f32_32x32x16_bf16 v[128:143], a[176:179], a[112:115], v[128:143]
    v_mul_f32 v115, v115, v195
    v_mul_f32 v116, v116, v196
    v_mul_f32 v117, v117, v197
    v_mul_f32_e64 v118, v118, v198
    ds_read_b128 a[164:167], v5 offset:21504
    v_mfma_f32_32x32x16_bf16 v[128:143], a[180:183], a[116:119], v[128:143]
    v_mul_f32_e64 v119, v119, v199
    v_cvt_pk_bf16_f32 v200, v112, v113
    v_cvt_pk_bf16_f32 v201, v114, v115
    v_cvt_pk_bf16_f32 v202, v116, v117
    ds_read_b128 a[168:171], v5 offset:22528
    s_waitcnt lgkmcnt(7)
    s_nop 0
    v_mfma_f32_32x32x16_bf16 v[128:143], a[184:187], a[120:123], v[128:143]
    v_cvt_pk_bf16_f32 v203, v118, v119
    buffer_store_dwordx4 v[200:203], v9, s[4:7], s69 offen sc1
    ds_read_b128 a[172:175], v5 offset:23552
    v_mfma_f32_32x32x16_bf16 v[128:143], a[188:191], a[124:127], v[128:143]
    s_waitcnt lgkmcnt(6)
    v_mfma_f32_32x32x16_bf16 v[128:143], a[192:195], a[128:131], v[128:143]
    v_mfma_f32_32x32x16_bf16 v[128:143], a[196:199], a[132:135], v[128:143]
    s_waitcnt lgkmcnt(4)
    v_mfma_f32_32x32x16_bf16 v[128:143], a[200:203], a[136:139], v[128:143]
    v_mfma_f32_32x32x16_bf16 v[128:143], a[204:207], a[140:143], v[128:143]
    s_waitcnt lgkmcnt(2)
    v_mfma_f32_32x32x16_bf16 v[128:143], a[160:163], a[144:147], v[128:143]
    v_mfma_f32_32x32x16_bf16 v[128:143], a[164:167], a[148:151], v[128:143]
    s_waitcnt lgkmcnt(0)
    v_mfma_f32_32x32x16_bf16 v[128:143], a[168:171], a[152:155], v[128:143]
    v_mfma_f32_32x32x16_bf16 v[128:143], a[172:175], a[156:159], v[128:143]
    v_mfma_f32_32x32x16_bf16 v[128:143], a[232:235], v[208:211], v[128:143]
    s_nop 11
    s_nop 0
    v_pk_mul_f32 v[176:177], v[12:13], v[128:129] op_sel_hi:[0,1]
    v_pk_mul_f32 v[178:179], v[12:13], v[130:131] op_sel_hi:[0,1]
    v_pk_mul_f32 v[180:181], v[12:13], v[132:133] op_sel_hi:[0,1]
    v_pk_mul_f32 v[182:183], v[12:13], v[134:135] op_sel_hi:[0,1]
    v_exp_f32 v176, v176
    v_exp_f32 v177, v177
    v_pk_mul_f32 v[128:129], v[128:129], v[136:137]
    v_exp_f32 v178, v178
    v_exp_f32 v179, v179
    v_pk_mul_f32 v[130:131], v[130:131], v[138:139]
    v_exp_f32 v180, v180
    v_exp_f32 v181, v181
    v_pk_mul_f32 v[132:133], v[132:133], v[140:141]
    v_exp_f32 v182, v182
    v_exp_f32 v183, v183
    v_pk_mul_f32 v[134:135], v[134:135], v[142:143]
    v_pk_fma_f32 v[176:177], v[176:177], v[14:15], v[14:15] op_sel_hi:[1,0,0]
    v_pk_fma_f32 v[178:179], v[178:179], v[14:15], v[14:15] op_sel_hi:[1,0,0]
    v_pk_fma_f32 v[180:181], v[180:181], v[14:15], v[14:15] op_sel_hi:[1,0,0]
    v_pk_fma_f32 v[182:183], v[182:183], v[14:15], v[14:15] op_sel_hi:[1,0,0]
    v_rcp_f32 v176, v176
    v_rcp_f32 v177, v177
    v_rcp_f32 v178, v178
    v_rcp_f32 v179, v179
    v_rcp_f32 v180, v180
    v_rcp_f32 v181, v181
    v_rcp_f32 v182, v182
    v_rcp_f32 v183, v183
    v_pk_mul_f32 v[128:129], v[128:129], v[176:177]
    v_pk_mul_f32 v[130:131], v[130:131], v[178:179]
    v_pk_mul_f32 v[132:133], v[132:133], v[180:181]
    v_pk_mul_f32 v[134:135], v[134:135], v[182:183]
    v_cvt_pk_bf16_f32 v184, v128, v129
    v_cvt_pk_bf16_f32 v185, v130, v131
    v_cvt_pk_bf16_f32 v186, v132, v133
    v_cvt_pk_bf16_f32 v187, v134, v135
    buffer_store_dwordx4 v[184:187], v9, s[4:7], s70 offen sc1
    s_lshl_b32 s51, s49, 7
    s_lshl_b32 s52, s50, 2
    s_add_u32 s51, s51, s52
    s_add_u32 s51, s51, 0x1518800
    s_waitcnt vmcnt(0) lgkmcnt(0)
    s_barrier
    s_cmp_lg_u32 s48, 0
    s_cbranch_scc1 L_pub_a
    v_mov_b32 v16, 0x7f000000
    v_cmp_eq_u32 vcc, 0, v1
    s_nop 1
    v_cndmask_b32 v16, v16, 0, vcc
    v_mov_b32 v17, 1
    buffer_store_dword v17, v16, s[4:7], s51 offen sc1
L_pub_a:
    s_load_dwordx2 s[40:41], s[0:1], 0x38
    s_load_dwordx2 s[46:47], s[0:1], 0x48
    v_and_b32 v1, 63, v0
    v_lshrrev_b32 v10, 6, v0
    s_nop 0
    v_readfirstlane_b32 s48, v10
    v_lshrrev_b32 v2, 4, v1
    v_and_b32 v3, 15, v1
    v_lshlrev_b32 v4, 4, v1
    s_and_b32 s51, s2, 7
    s_lshr_b32 s52, s2, 3
    s_lshr_b32 s49, s51, 1
    s_lshl_b32 s49, s49, 3
    s_and_b32 s50, s51, 1
    s_lshl_b32 s50, s50, 2
    s_lshr_b32 s51, s52, 2
    s_add_u32 s49, s49, s51
    s_and_b32 s51, s52, 3
    s_add_u32 s50, s50, s51
    s_add_u32 s51, s48, 0
    s_and_b32 s51, s51, 3
    s_lshl_b32 s51, s51, 10
    v_add_u32 v5, s51, v4
    s_add_u32 s51, s48, 1
    s_and_b32 s51, s51, 3
    s_lshl_b32 s51, s51, 10
    v_add_u32 v6, s51, v4
    s_add_u32 s51, s48, 2
    s_and_b32 s51, s51, 3
    s_lshl_b32 s51, s51, 10
    v_add_u32 v7, s51, v4
    s_add_u32 s51, s48, 3
    s_and_b32 s51, s51, 3
    s_lshl_b32 s51, s51, 10
    v_add_u32_e64 v8, s51, v4
    v_add_u32 v9, 0x1000, v4
    s_add_u32 s51, s48, 1
    s_and_b32 s51, s51, 3
    s_mul_i32 s51, s51, 0x3c00
    s_add_u32 s51, s51, 0x10000
    v_add_u32 v101, s51, v4
    s_add_u32 s51, s48, 2
    s_and_b32 s51, s51, 3
    s_mul_i32 s51, s51, 0x3c00
    s_add_u32 s51, s51, 0x11400
    v_add_u32 v102, s51, v4
    s_add_u32 s51, s48, 3
    s_and_b32 s51, s51, 3
    s_mul_i32 s51, s51, 0x3c00
    s_add_u32 s51, s51, 0x12800
    v_add_u32_e64 v103, s51, v4
    s_mul_i32 s51, s48, 0x3c00
    s_add_u32 s51, s51, 0x10000
    v_add_u32_e64 v100, s51, v4
    s_mul_i32 s51, s48, 0x1400
    v_add_u32_e64 v136, s51, v4
    s_add_u32 s51, s51, 0x10000
    v_add_u32_e64 v137, s51, v4
    s_add_u32 s51, s51, 0x10000
    v_add_u32_e64 v138, s51, v4
    s_add_u32 s51, s51, 0x10000
    s_lshl_b32 s53, s48, 17
    s_lshl_b32 s51, s49, 12
    s_add_u32 s53, s53, s51
    s_mul_i32 s54, s48, 0xa000
    s_mul_i32 s51, s50, 0x1400
    s_add_u32 s54, s54, s51
    s_waitcnt lgkmcnt(0)
    s_mov_b32 s4, s46
    s_mov_b32 s5, s47
    s_nop 0
    s_mov_b32 s6, 0x1800000
    s_mov_b32 s7, 0x20000
    s_add_u32 s8, s46, 0x500000
    s_addc_u32 s9, s47, 0
    s_nop 0
    s_mov_b32 s10, 0x6c0000
    s_mov_b32 s11, 0x20000
    s_add_u32 s12, s46, 0x1200000
    s_addc_u32 s13, s47, 0
    s_mov_b32 s14, 0x21c000
    s_mov_b32 s15, 0x20000
    s_mov_b32 s16, s40
    s_mov_b32 s17, s41
    s_mov_b32 s18, 0x280000
    s_mov_b32 s19, 0x20000
    s_xor_b32 s55, s48, 3
    s_cmp_eq_u32 s55, 0
    s_cbranch_scc1 L_k4_skipw
    buffer_load_dwordx4 a[16:19], v4, s[12:15], s54 offen
    buffer_load_dwordx4 a[20:23], v4, s[12:15], s54 offen offset:1024
    buffer_load_dwordx4 a[24:27], v4, s[12:15], s54 offen offset:2048
    buffer_load_dwordx4 a[28:31], v4, s[12:15], s54 offen offset:3072
    buffer_load_dwordx4 a[32:35], v9, s[12:15], s54 offen
    s_add_u32 s54, s54, 0x28000
    buffer_load_dwordx4 a[52:55], v4, s[12:15], s54 offen
    buffer_load_dwordx4 a[56:59], v4, s[12:15], s54 offen offset:1024
    buffer_load_dwordx4 a[60:63], v4, s[12:15], s54 offen offset:2048
    buffer_load_dwordx4 a[64:67], v4, s[12:15], s54 offen offset:3072
    buffer_load_dwordx4 a[68:71], v9, s[12:15], s54 offen
    s_add_u32 s54, s54, 0x28000
    buffer_load_dwordx4 a[88:91], v4, s[12:15], s54 offen
    buffer_load_dwordx4 a[92:95], v4, s[12:15], s54 offen offset:1024
    buffer_load_dwordx4 a[96:99], v4, s[12:15], s54 offen offset:2048
    buffer_load_dwordx4 a[100:103], v4, s[12:15], s54 offen offset:3072
    buffer_load_dwordx4 a[104:107], v9, s[12:15], s54 offen
    s_add_u32 s54, s54, 0x28000
    buffer_load_dwordx4 a[124:127], v4, s[12:15], s54 offen
    buffer_load_dwordx4 a[128:131], v4, s[12:15], s54 offen offset:1024
    buffer_load_dwordx4 a[132:135], v4, s[12:15], s54 offen offset:2048
    buffer_load_dwordx4 a[136:139], v4, s[12:15], s54 offen offset:3072
    buffer_load_dwordx4 a[140:143], v9, s[12:15], s54 offen
    s_add_u32 s54, s54, 0x28000
    buffer_load_dwordx4 a[160:163], v4, s[12:15], s54 offen
    buffer_load_dwordx4 a[164:167], v4, s[12:15], s54 offen offset:1024
    buffer_load_dwordx4 a[168:171], v4, s[12:15], s54 offen offset:2048
    buffer_load_dwordx4 a[172:175], v4, s[12:15], s54 offen offset:3072
    buffer_load_dwordx4 a[176:179], v9, s[12:15], s54 offen
    s_add_u32 s54, s54, 0x28000
    buffer_load_dwordx4 a[196:199], v4, s[12:15], s54 offen
    buffer_load_dwordx4 a[200:203], v4, s[12:15], s54 offen offset:1024
    buffer_load_dwordx4 a[204:207], v4, s[12:15], s54 offen offset:2048
    buffer_load_dwordx4 a[208:211], v4, s[12:15], s54 offen offset:3072
    buffer_load_dwordx4 a[212:215], v9, s[12:15], s54 offen
    s_add_u32 s54, s54, 0x28000
    buffer_load_dwordx4 a[232:235], v4, s[12:15], s54 offen
    buffer_load_dwordx4 a[236:239], v4, s[12:15], s54 offen offset:1024
    buffer_load_dwordx4 a[240:243], v4, s[12:15], s54 offen offset:2048
    buffer_load_dwordx4 a[244:247], v4, s[12:15], s54 offen offset:3072
    buffer_load_dwordx4 a[248:251], v9, s[12:15], s54 offen
    s_add_u32 s54, s54, 0x28000
L_k4_skipw:
    s_lshr_b32 s51, s49, 1
    s_lshl_b32 s51, s51, 7
    s_add_u32 s51, s51, 0x1518800
    s_cmp_lg_u32 s55, 0
    s_cbranch_scc1 L_aw_done_a
    v_and_b32 v10, 15, v1
    v_lshlrev_b32 v10, 2, v10
    s_mov_b32 s52, 0
L_aw_a:
    buffer_load_dword v11, v10, s[4:7], s51 offen sc1
    s_waitcnt vmcnt(0)
    v_cmp_ne_u32 vcc, 1, v11
    s_add_u32 s52, s52, 1
    s_nop 0
    s_cmp_eq_u64 vcc, 0
    s_cbranch_scc1 L_aw_done_a
    s_sleep 1
    s_cmp_lt_u32 s52, 0x61a80
    s_cbranch_scc1 L_aw_a
L_aw_done_a:
    s_barrier
    s_cmp_lg_u32 s55, 0
    s_cbranch_scc1 L_k4_gotw
    buffer_load_dwordx4 a[16:19], v4, s[12:15], s54 offen
    buffer_load_dwordx4 a[20:23], v4, s[12:15], s54 offen offset:1024
    buffer_load_dwordx4 a[24:27], v4, s[12:15], s54 offen offset:2048
    buffer_load_dwordx4 a[28:31], v4, s[12:15], s54 offen offset:3072
    buffer_load_dwordx4 a[32:35], v9, s[12:15], s54 offen
    s_add_u32 s54, s54, 0x28000
    buffer_load_dwordx4 a[52:55], v4, s[12:15], s54 offen
    buffer_load_dwordx4 a[56:59], v4, s[12:15], s54 offen offset:1024
    buffer_load_dwordx4 a[60:63], v4, s[12:15], s54 offen offset:2048
    buffer_load_dwordx4 a[64:67], v4, s[12:15], s54 offen offset:3072
    buffer_load_dwordx4 a[68:71], v9, s[12:15], s54 offen
    s_add_u32 s54, s54, 0x28000
    buffer_load_dwordx4 a[88:91], v4, s[12:15], s54 offen
    buffer_load_dwordx4 a[92:95], v4, s[12:15], s54 offen offset:1024
    buffer_load_dwordx4 a[96:99], v4, s[12:15], s54 offen offset:2048
    buffer_load_dwordx4 a[100:103], v4, s[12:15], s54 offen offset:3072
    buffer_load_dwordx4 a[104:107], v9, s[12:15], s54 offen
    s_add_u32 s54, s54, 0x28000
    buffer_load_dwordx4 a[124:127], v4, s[12:15], s54 offen
    buffer_load_dwordx4 a[128:131], v4, s[12:15], s54 offen offset:1024
    buffer_load_dwordx4 a[132:135], v4, s[12:15], s54 offen offset:2048
    buffer_load_dwordx4 a[136:139], v4, s[12:15], s54 offen offset:3072
    buffer_load_dwordx4 a[140:143], v9, s[12:15], s54 offen
    s_add_u32 s54, s54, 0x28000
    buffer_load_dwordx4 a[160:163], v4, s[12:15], s54 offen
    buffer_load_dwordx4 a[164:167], v4, s[12:15], s54 offen offset:1024
    buffer_load_dwordx4 a[168:171], v4, s[12:15], s54 offen offset:2048
    buffer_load_dwordx4 a[172:175], v4, s[12:15], s54 offen offset:3072
    buffer_load_dwordx4 a[176:179], v9, s[12:15], s54 offen
    s_add_u32 s54, s54, 0x28000
    buffer_load_dwordx4 a[196:199], v4, s[12:15], s54 offen
    buffer_load_dwordx4 a[200:203], v4, s[12:15], s54 offen offset:1024
    buffer_load_dwordx4 a[204:207], v4, s[12:15], s54 offen offset:2048
    buffer_load_dwordx4 a[208:211], v4, s[12:15], s54 offen offset:3072
    buffer_load_dwordx4 a[212:215], v9, s[12:15], s54 offen
    s_add_u32 s54, s54, 0x28000
    buffer_load_dwordx4 a[232:235], v4, s[12:15], s54 offen
    buffer_load_dwordx4 a[236:239], v4, s[12:15], s54 offen offset:1024
    buffer_load_dwordx4 a[240:243], v4, s[12:15], s54 offen offset:2048
    buffer_load_dwordx4 a[244:247], v4, s[12:15], s54 offen offset:3072
    buffer_load_dwordx4 a[248:251], v9, s[12:15], s54 offen
    s_add_u32 s54, s54, 0x28000
L_k4_gotw:
    buffer_load_dwordx4 a[0:3], v5, s[8:11], s53 offen sc1
    buffer_load_dwordx4 a[4:7], v6, s[8:11], s53 offen sc1
    buffer_load_dwordx4 a[8:11], v7, s[8:11], s53 offen sc1
    buffer_load_dwordx4 a[12:15], v8, s[8:11], s53 offen sc1
    s_add_u32 s53, s53, 0x80000
    buffer_load_dwordx4 a[36:39], v5, s[8:11], s53 offen sc1
    buffer_load_dwordx4 a[40:43], v6, s[8:11], s53 offen sc1
    buffer_load_dwordx4 a[44:47], v7, s[8:11], s53 offen sc1
    buffer_load_dwordx4 a[48:51], v8, s[8:11], s53 offen sc1
    s_add_u32 s53, s53, 0x80000
    buffer_load_dwordx4 a[72:75], v5, s[8:11], s53 offen sc1
    buffer_load_dwordx4 a[76:79], v6, s[8:11], s53 offen sc1
    buffer_load_dwordx4 a[80:83], v7, s[8:11], s53 offen sc1
    buffer_load_dwordx4 a[84:87], v8, s[8:11], s53 offen sc1
    s_add_u32 s53, s53, 0x80000
    s_waitcnt vmcnt(8)
    s_nop 0
    v_mfma_f32_16x16x32_bf16 v[16:19], a[16:19], a[0:3], 0
    v_mfma_f32_16x16x32_bf16 v[20:23], a[20:23], a[0:3], 0
    buffer_load_dwordx4 a[108:111], v5, s[8:11], s53 offen sc1
    v_mfma_f32_16x16x32_bf16 v[24:27], a[24:27], a[0:3], 0
    v_mfma_f32_16x16x32_bf16 v[28:31], a[28:31], a[0:3], 0
    buffer_load_dwordx4 a[112:115], v6, s[8:11], s53 offen sc1
    v_mfma_f32_16x16x32_bf16 v[32:35], a[32:35], a[0:3], 0
    v_mfma_f32_16x16x32_bf16 v[36:39], a[16:19], a[4:7], 0
    buffer_load_dwordx4 a[116:119], v7, s[8:11], s53 offen sc1
    v_mfma_f32_16x16x32_bf16 v[40:43], a[20:23], a[4:7], 0
    v_mfma_f32_16x16x32_bf16 v[44:47], a[24:27], a[4:7], 0
    buffer_load_dwordx4 a[120:123], v8, s[8:11], s53 offen sc1
    s_add_u32 s53, s53, 0x80000
    v_mfma_f32_16x16x32_bf16 v[48:51], a[28:31], a[4:7], 0
    v_mfma_f32_16x16x32_bf16 v[52:55], a[32:35], a[4:7], 0
    buffer_load_dwordx4 a[144:147], v5, s[8:11], s53 offen sc1
    v_mfma_f32_16x16x32_bf16 v[56:59], a[16:19], a[8:11], 0
    v_mfma_f32_16x16x32_bf16 v[60:63], a[20:23], a[8:11], 0
    buffer_load_dwordx4 a[148:151], v6, s[8:11], s53 offen sc1
    v_mfma_f32_16x16x32_bf16 v[64:67], a[24:27], a[8:11], 0
    v_mfma_f32_16x16x32_bf16 v[68:71], a[28:31], a[8:11], 0
    buffer_load_dwordx4 a[152:155], v7, s[8:11], s53 offen sc1
    v_mfma_f32_16x16x32_bf16 v[72:75], a[32:35], a[8:11], 0
    v_mfma_f32_16x16x32_bf16 v[76:79], a[16:19], a[12:15], 0
    buffer_load_dwordx4 a[156:159], v8, s[8:11], s53 offen sc1
    s_add_u32 s53, s53, 0x80000
    v_mfma_f32_16x16x32_bf16 v[80:83], a[20:23], a[12:15], 0
    v_mfma_f32_16x16x32_bf16 v[84:87], a[24:27], a[12:15], 0
    buffer_load_dwordx4 a[180:183], v5, s[8:11], s53 offen sc1
    v_mfma_f32_16x16x32_bf16 v[88:91], a[28:31], a[12:15], 0
    v_mfma_f32_16x16x32_bf16 v[92:95], a[32:35], a[12:15], 0
    buffer_load_dwordx4 a[184:187], v6, s[8:11], s53 offen sc1
    s_waitcnt vmcnt(14)
    s_nop 0
    v_mfma_f32_16x16x32_bf16 v[16:19], a[52:55], a[36:39], v[16:19]
    v_mfma_f32_16x16x32_bf16 v[20:23], a[56:59], a[36:39], v[20:23]
    buffer_load_dwordx4 a[188:191], v7, s[8:11], s53 offen sc1
    v_mfma_f32_16x16x32_bf16 v[24:27], a[60:63], a[36:39], v[24:27]
    v_mfma_f32_16x16x32_bf16 v[28:31], a[64:67], a[36:39], v[28:31]
    buffer_load_dwordx4 a[192:195], v8, s[8:11], s53 offen sc1
    s_add_u32 s53, s53, 0x80000
    v_mfma_f32_16x16x32_bf16 v[32:35], a[68:71], a[36:39], v[32:35]
    v_mfma_f32_16x16x32_bf16 v[36:39], a[52:55], a[40:43], v[36:39]
    buffer_load_dwordx4 a[216:219], v5, s[8:11], s53 offen sc1
    v_mfma_f32_16x16x32_bf16 v[40:43], a[56:59], a[40:43], v[40:43]
    v_mfma_f32_16x16x32_bf16 v[44:47], a[60:63], a[40:43], v[44:47]
    buffer_load_dwordx4 a[220:223], v6, s[8:11], s53 offen sc1
    v_mfma_f32_16x16x32_bf16 v[48:51], a[64:67], a[40:43], v[48:51]
    v_mfma_f32_16x16x32_bf16 v[52:55], a[68:71], a[40:43], v[52:55]
    buffer_load_dwordx4 a[224:227], v7, s[8:11], s53 offen sc1
    v_mfma_f32_16x16x32_bf16 v[56:59], a[52:55], a[44:47], v[56:59]
    v_mfma_f32_16x16x32_bf16 v[60:63], a[56:59], a[44:47], v[60:63]
    buffer_load_dwordx4 a[228:231], v8, s[8:11], s53 offen sc1
    s_add_u32 s53, s53, 0x80000
    v_mfma_f32_16x16x32_bf16 v[64:67], a[60:63], a[44:47], v[64:67]
    v_mfma_f32_16x16x32_bf16 v[68:71], a[64:67], a[44:47], v[68:71]
    ds_read_b128 a[16:19], v138 offset:8192
    v_mfma_f32_16x16x32_bf16 v[72:75], a[68:71], a[44:47], v[72:75]
    v_mfma_f32_16x16x32_bf16 v[76:79], a[52:55], a[48:51], v[76:79]
    ds_read_b128 a[20:23], v138 offset:9216
    v_mfma_f32_16x16x32_bf16 v[80:83], a[56:59], a[48:51], v[80:83]
    v_mfma_f32_16x16x32_bf16 v[84:87], a[60:63], a[48:51], v[84:87]
    ds_read_b128 a[24:27], v138 offset:10240
    v_mfma_f32_16x16x32_bf16 v[88:91], a[64:67], a[48:51], v[88:91]
    v_mfma_f32_16x16x32_bf16 v[92:95], a[68:71], a[48:51], v[92:95]
    ds_read_b128 a[28:31], v138 offset:11264
    s_waitcnt vmcnt(16)
    s_nop 0
    v_mfma_f32_16x16x32_bf16 v[16:19], a[88:91], a[72:75], v[16:19]
    v_mfma_f32_16x16x32_bf16 v[20:23], a[92:95], a[72:75], v[20:23]
    ds_read_b128 a[32:35], v138 offset:12288
    s_add_u32 s54, s54, 0x28000
    v_mfma_f32_16x16x32_bf16 v[24:27], a[96:99], a[72:75], v[24:27]
    v_mfma_f32_16x16x32_bf16 v[28:31], a[100:103], a[72:75], v[28:31]
    buffer_load_dwordx4 a[0:3], v5, s[8:11], s53 offen sc1
    v_mfma_f32_16x16x32_bf16 v[32:35], a[104:107], a[72:75], v[32:35]
    v_mfma_f32_16x16x32_bf16 v[36:39], a[88:91], a[76:79], v[36:39]
    buffer_load_dwordx4 a[4:7], v6, s[8:11], s53 offen sc1
    v_mfma_f32_16x16x32_bf16 v[40:43], a[92:95], a[76:79], v[40:43]
    v_mfma_f32_16x16x32_bf16 v[44:47], a[96:99], a[76:79], v[44:47]
    buffer_load_dwordx4 a[8:11], v7, s[8:11], s53 offen sc1
    v_mfma_f32_16x16x32_bf16 v[48:51], a[100:103], a[76:79], v[48:51]
    v_mfma_f32_16x16x32_bf16 v[52:55], a[104:107], a[76:79], v[52:55]
    buffer_load_dwordx4 a[12:15], v8, s[8:11], s53 offen sc1
    s_add_u32 s53, s53, 0x80000
    v_mfma_f32_16x16x32_bf16 v[56:59], a[88:91], a[80:83], v[56:59]
    v_mfma_f32_16x16x32_bf16 v[60:63], a[92:95], a[80:83], v[60:63]
    ds_read_b128 a[52:55], v136 offset:32768
    v_mfma_f32_16x16x32_bf16 v[64:67], a[96:99], a[80:83], v[64:67]
    v_mfma_f32_16x16x32_bf16 v[68:71], a[100:103], a[80:83], v[68:71]
    ds_read_b128 a[56:59], v136 offset:33792
    v_mfma_f32_16x16x32_bf16 v[72:75], a[104:107], a[80:83], v[72:75]
    v_mfma_f32_16x16x32_bf16 v[76:79], a[88:91], a[84:87], v[76:79]
    ds_read_b128 a[60:63], v136 offset:34816
    v_mfma_f32_16x16x32_bf16 v[80:83], a[92:95], a[84:87], v[80:83]
    v_mfma_f32_16x16x32_bf16 v[84:87], a[96:99], a[84:87], v[84:87]
    ds_read_b128 a[64:67], v136 offset:35840
    v_mfma_f32_16x16x32_bf16 v[88:91], a[100:103], a[84:87], v[88:91]
    v_mfma_f32_16x16x32_bf16 v[92:95], a[104:107], a[84:87], v[92:95]
    ds_read_b128 a[68:71], v136 offset:36864
    s_add_u32 s54, s54, 0x28000
    s_waitcnt vmcnt(16)
    s_nop 0
    v_mfma_f32_16x16x32_bf16 v[16:19], a[124:127], a[108:111], v[16:19]
    v_mfma_f32_16x16x32_bf16 v[20:23], a[128:131], a[108:111], v[20:23]
    buffer_load_dwordx4 a[36:39], v5, s[8:11], s53 offen sc1
    v_mfma_f32_16x16x32_bf16 v[24:27], a[132:135], a[108:111], v[24:27]
    v_mfma_f32_16x16x32_bf16 v[28:31], a[136:139], a[108:111], v[28:31]
    buffer_load_dwordx4 a[40:43], v6, s[8:11], s53 offen sc1
    v_mfma_f32_16x16x32_bf16 v[32:35], a[140:143], a[108:111], v[32:35]
    v_mfma_f32_16x16x32_bf16 v[36:39], a[124:127], a[112:115], v[36:39]
    buffer_load_dwordx4 a[44:47], v7, s[8:11], s53 offen sc1
    v_mfma_f32_16x16x32_bf16 v[40:43], a[128:131], a[112:115], v[40:43]
    v_mfma_f32_16x16x32_bf16 v[44:47], a[132:135], a[112:115], v[44:47]
    buffer_load_dwordx4 a[48:51], v8, s[8:11], s53 offen sc1
    s_add_u32 s53, s53, 0x80000
    v_mfma_f32_16x16x32_bf16 v[48:51], a[136:139], a[112:115], v[48:51]
    v_mfma_f32_16x16x32_bf16 v[52:55], a[140:143], a[112:115], v[52:55]
    ds_read_b128 a[88:91], v136 offset:53248
    v_mfma_f32_16x16x32_bf16 v[56:59], a[124:127], a[116:119], v[56:59]
    v_mfma_f32_16x16x32_bf16 v[60:63], a[128:131], a[116:119], v[60:63]
    ds_read_b128 a[92:95], v136 offset:54272
    v_mfma_f32_16x16x32_bf16 v[64:67], a[132:135], a[116:119], v[64:67]
    v_mfma_f32_16x16x32_bf16 v[68:71], a[136:139], a[116:119], v[68:71]
    ds_read_b128 a[96:99], v136 offset:55296
    v_mfma_f32_16x16x32_bf16 v[72:75], a[140:143], a[116:119], v[72:75]
    v_mfma_f32_16x16x32_bf16 v[76:79], a[124:127], a[120:123], v[76:79]
    ds_read_b128 a[100:103], v136 offset:56320
    v_mfma_f32_16x16x32_bf16 v[80:83], a[128:131], a[120:123], v[80:83]
    v_mfma_f32_16x16x32_bf16 v[84:87], a[132:135], a[120:123], v[84:87]
    ds_read_b128 a[104:107], v136 offset:57344
    s_add_u32 s54, s54, 0x28000
    v_mfma_f32_16x16x32_bf16 v[88:91], a[136:139], a[120:123], v[88:91]
    v_mfma_f32_16x16x32_bf16 v[92:95], a[140:143], a[120:123], v[92:95]
    buffer_load_dwordx4 a[72:75], v5, s[8:11], s53 offen sc1
    s_waitcnt vmcnt(17)
    s_nop 0
    v_mfma_f32_16x16x32_bf16 v[16:19], a[160:163], a[144:147], v[16:19]
    v_mfma_f32_16x16x32_bf16 v[20:23], a[164:167], a[144:147], v[20:23]
    buffer_load_dwordx4 a[76:79], v6, s[8:11], s53 offen sc1
    v_mfma_f32_16x16x32_bf16 v[24:27], a[168:171], a[144:147], v[24:27]
    v_mfma_f32_16x16x32_bf16 v[28:31], a[172:175], a[144:147], v[28:31]
    buffer_load_dwordx4 a[80:83], v7, s[8:11], s53 offen sc1
    v_mfma_f32_16x16x32_bf16 v[32:35], a[176:179], a[144:147], v[32:35]
    v_mfma_f32_16x16x32_bf16 v[36:39], a[160:163], a[148:151], v[36:39]
    buffer_load_dwordx4 a[84:87], v8, s[8:11], s53 offen sc1
    s_add_u32 s53, s53, 0x80000
    v_mfma_f32_16x16x32_bf16 v[40:43], a[164:167], a[148:151], v[40:43]
    v_mfma_f32_16x16x32_bf16 v[44:47], a[168:171], a[148:151], v[44:47]
    ds_read_b128 a[124:127], v137 offset:8192
    v_mfma_f32_16x16x32_bf16 v[48:51], a[172:175], a[148:151], v[48:51]
    v_mfma_f32_16x16x32_bf16 v[52:55], a[176:179], a[148:151], v[52:55]
    ds_read_b128 a[128:131], v137 offset:9216
    v_mfma_f32_16x16x32_bf16 v[56:59], a[160:163], a[152:155], v[56:59]
    v_mfma_f32_16x16x32_bf16 v[60:63], a[164:167], a[152:155], v[60:63]
    ds_read_b128 a[132:135], v137 offset:10240
    v_mfma_f32_16x16x32_bf16 v[64:67], a[168:171], a[152:155], v[64:67]
    v_mfma_f32_16x16x32_bf16 v[68:71], a[172:175], a[152:155], v[68:71]
    ds_read_b128 a[136:139], v137 offset:11264
    v_mfma_f32_16x16x32_bf16 v[72:75], a[176:179], a[152:155], v[72:75]
    v_mfma_f32_16x16x32_bf16 v[76:79], a[160:163], a[156:159], v[76:79]
    ds_read_b128 a[140:143], v137 offset:12288
    s_add_u32 s54, s54, 0x28000
    v_mfma_f32_16x16x32_bf16 v[80:83], a[164:167], a[156:159], v[80:83]
    v_mfma_f32_16x16x32_bf16 v[84:87], a[168:171], a[156:159], v[84:87]
    buffer_load_dwordx4 a[108:111], v5, s[8:11], s53 offen sc1
    v_mfma_f32_16x16x32_bf16 v[88:91], a[172:175], a[156:159], v[88:91]
    v_mfma_f32_16x16x32_bf16 v[92:95], a[176:179], a[156:159], v[92:95]
    buffer_load_dwordx4 a[112:115], v6, s[8:11], s53 offen sc1
    s_waitcnt vmcnt(18)
    s_nop 0
    v_mfma_f32_16x16x32_bf16 v[16:19], a[196:199], a[180:183], v[16:19]
    v_mfma_f32_16x16x32_bf16 v[20:23], a[200:203], a[180:183], v[20:23]
    buffer_load_dwordx4 a[116:119], v7, s[8:11], s53 offen sc1
    v_mfma_f32_16x16x32_bf16 v[24:27], a[204:207], a[180:183], v[24:27]
    v_mfma_f32_16x16x32_bf16 v[28:31], a[208:211], a[180:183], v[28:31]
    buffer_load_dwordx4 a[120:123], v8, s[8:11], s53 offen sc1
    s_add_u32 s53, s53, 0x80000
    v_mfma_f32_16x16x32_bf16 v[32:35], a[212:215], a[180:183], v[32:35]
    v_mfma_f32_16x16x32_bf16 v[36:39], a[196:199], a[184:187], v[36:39]
    ds_read_b128 a[160:163], v137 offset:28672
    v_mfma_f32_16x16x32_bf16 v[40:43], a[200:203], a[184:187], v[40:43]
    v_mfma_f32_16x16x32_bf16 v[44:47], a[204:207], a[184:187], v[44:47]
    ds_read_b128 a[164:167], v137 offset:29696
    v_mfma_f32_16x16x32_bf16 v[48:51], a[208:211], a[184:187], v[48:51]
    v_mfma_f32_16x16x32_bf16 v[52:55], a[212:215], a[184:187], v[52:55]
    ds_read_b128 a[168:171], v137 offset:30720
    v_mfma_f32_16x16x32_bf16 v[56:59], a[196:199], a[188:191], v[56:59]
    v_mfma_f32_16x16x32_bf16 v[60:63], a[200:203], a[188:191], v[60:63]
    ds_read_b128 a[172:175], v137 offset:31744
    v_mfma_f32_16x16x32_bf16 v[64:67], a[204:207], a[188:191], v[64:67]
    v_mfma_f32_16x16x32_bf16 v[68:71], a[208:211], a[188:191], v[68:71]
    ds_read_b128 a[176:179], v137 offset:32768
    s_add_u32 s54, s54, 0x28000
    v_mfma_f32_16x16x32_bf16 v[72:75], a[212:215], a[188:191], v[72:75]
    v_mfma_f32_16x16x32_bf16 v[76:79], a[196:199], a[192:195], v[76:79]
    buffer_load_dwordx4 a[144:147], v5, s[8:11], s53 offen sc1
    v_mfma_f32_16x16x32_bf16 v[80:83], a[200:203], a[192:195], v[80:83]
    v_mfma_f32_16x16x32_bf16 v[84:87], a[204:207], a[192:195], v[84:87]
    buffer_load_dwordx4 a[148:151], v6, s[8:11], s53 offen sc1
    v_mfma_f32_16x16x32_bf16 v[88:91], a[208:211], a[192:195], v[88:91]
    v_mfma_f32_16x16x32_bf16 v[92:95], a[212:215], a[192:195], v[92:95]
    buffer_load_dwordx4 a[152:155], v7, s[8:11], s53 offen sc1
    s_waitcnt vmcnt(19)
    s_nop 0
    v_mfma_f32_16x16x32_bf16 v[16:19], a[232:235], a[216:219], v[16:19]
    v_mfma_f32_16x16x32_bf16 v[20:23], a[236:239], a[216:219], v[20:23]
    buffer_load_dwordx4 a[156:159], v8, s[8:11], s53 offen sc1
    s_add_u32 s53, s53, 0x80000
    v_mfma_f32_16x16x32_bf16 v[24:27], a[240:243], a[216:219], v[24:27]
    v_mfma_f32_16x16x32_bf16 v[28:31], a[244:247], a[216:219], v[28:31]
    buffer_load_dwordx4 a[196:199], v4, s[12:15], s54 offen
    v_mfma_f32_16x16x32_bf16 v[32:35], a[248:251], a[216:219], v[32:35]
    v_mfma_f32_16x16x32_bf16 v[36:39], a[232:235], a[220:223], v[36:39]
    buffer_load_dwordx4 a[200:203], v4, s[12:15], s54 offen offset:1024
    v_mfma_f32_16x16x32_bf16 v[40:43], a[236:239], a[220:223], v[40:43]
    v_mfma_f32_16x16x32_bf16 v[44:47], a[240:243], a[220:223], v[44:47]
    buffer_load_dwordx4 a[204:207], v4, s[12:15], s54 offen offset:2048
    v_mfma_f32_16x16x32_bf16 v[48:51], a[244:247], a[220:223], v[48:51]
    v_mfma_f32_16x16x32_bf16 v[52:55], a[248:251], a[220:223], v[52:55]
    buffer_load_dwordx4 a[208:211], v4, s[12:15], s54 offen offset:3072
    v_mfma_f32_16x16x32_bf16 v[56:59], a[232:235], a[224:227], v[56:59]
    v_mfma_f32_16x16x32_bf16 v[60:63], a[236:239], a[224:227], v[60:63]
    buffer_load_dwordx4 a[212:215], v9, s[12:15], s54 offen
    s_add_u32 s54, s54, 0x28000
    v_mfma_f32_16x16x32_bf16 v[64:67], a[240:243], a[224:227], v[64:67]
    v_mfma_f32_16x16x32_bf16 v[68:71], a[244:247], a[224:227], v[68:71]
    buffer_load_dwordx4 a[180:183], v5, s[8:11], s53 offen sc1
    v_mfma_f32_16x16x32_bf16 v[72:75], a[248:251], a[224:227], v[72:75]
    v_mfma_f32_16x16x32_bf16 v[76:79], a[232:235], a[228:231], v[76:79]
    buffer_load_dwordx4 a[184:187], v6, s[8:11], s53 offen sc1
    v_mfma_f32_16x16x32_bf16 v[80:83], a[236:239], a[228:231], v[80:83]
    v_mfma_f32_16x16x32_bf16 v[84:87], a[240:243], a[228:231], v[84:87]
    buffer_load_dwordx4 a[188:191], v7, s[8:11], s53 offen sc1
    v_mfma_f32_16x16x32_bf16 v[88:91], a[244:247], a[228:231], v[88:91]
    v_mfma_f32_16x16x32_bf16 v[92:95], a[248:251], a[228:231], v[92:95]
    buffer_load_dwordx4 a[192:195], v8, s[8:11], s53 offen sc1
    s_add_u32 s53, s53, 0x80000
    s_waitcnt vmcnt(25) lgkmcnt(15)
    s_nop 0
    v_mfma_f32_16x16x32_bf16 v[16:19], a[16:19], a[0:3], v[16:19]
    v_mfma_f32_16x16x32_bf16 v[20:23], a[20:23], a[0:3], v[20:23]
    buffer_load_dwordx4 a[232:235], v4, s[12:15], s54 offen
    v_mfma_f32_16x16x32_bf16 v[24:27], a[24:27], a[0:3], v[24:27]
    v_mfma_f32_16x16x32_bf16 v[28:31], a[28:31], a[0:3], v[28:31]
    buffer_load_dwordx4 a[236:239], v4, s[12:15], s54 offen offset:1024
    v_mfma_f32_16x16x32_bf16 v[32:35], a[32:35], a[0:3], v[32:35]
    v_mfma_f32_16x16x32_bf16 v[36:39], a[16:19], a[4:7], v[36:39]
    buffer_load_dwordx4 a[240:243], v4, s[12:15], s54 offen offset:2048
    v_mfma_f32_16x16x32_bf16 v[40:43], a[20:23], a[4:7], v[40:43]
    v_mfma_f32_16x16x32_bf16 v[44:47], a[24:27], a[4:7], v[44:47]
    buffer_load_dwordx4 a[244:247], v4, s[12:15], s54 offen offset:3072
    v_mfma_f32_16x16x32_bf16 v[48:51], a[28:31], a[4:7], v[48:51]
    v_mfma_f32_16x16x32_bf16 v[52:55], a[32:35], a[4:7], v[52:55]
    buffer_load_dwordx4 a[248:251], v9, s[12:15], s54 offen
    s_add_u32 s54, s54, 0x28000
    v_mfma_f32_16x16x32_bf16 v[56:59], a[16:19], a[8:11], v[56:59]
    v_mfma_f32_16x16x32_bf16 v[60:63], a[20:23], a[8:11], v[60:63]
    buffer_load_dwordx4 a[216:219], v5, s[8:11], s53 offen sc1
    v_mfma_f32_16x16x32_bf16 v[64:67], a[24:27], a[8:11], v[64:67]
    v_mfma_f32_16x16x32_bf16 v[68:71], a[28:31], a[8:11], v[68:71]
    buffer_load_dwordx4 a[220:223], v6, s[8:11], s53 offen sc1
    v_mfma_f32_16x16x32_bf16 v[72:75], a[32:35], a[8:11], v[72:75]
    v_mfma_f32_16x16x32_bf16 v[76:79], a[16:19], a[12:15], v[76:79]
    buffer_load_dwordx4 a[224:227], v7, s[8:11], s53 offen sc1
    v_mfma_f32_16x16x32_bf16 v[80:83], a[20:23], a[12:15], v[80:83]
    v_mfma_f32_16x16x32_bf16 v[84:87], a[24:27], a[12:15], v[84:87]
    buffer_load_dwordx4 a[228:231], v8, s[8:11], s53 offen sc1
    s_add_u32 s53, s53, 0x80000
    v_mfma_f32_16x16x32_bf16 v[88:91], a[28:31], a[12:15], v[88:91]
    v_mfma_f32_16x16x32_bf16 v[92:95], a[32:35], a[12:15], v[92:95]
    s_waitcnt vmcnt(30)
    s_nop 0
    v_mfma_f32_16x16x32_bf16 v[16:19], a[52:55], a[36:39], v[16:19]
    v_mfma_f32_16x16x32_bf16 v[20:23], a[56:59], a[36:39], v[20:23]
    v_mfma_f32_16x16x32_bf16 v[24:27], a[60:63], a[36:39], v[24:27]
    v_mfma_f32_16x16x32_bf16 v[28:31], a[64:67], a[36:39], v[28:31]
    v_mfma_f32_16x16x32_bf16 v[32:35], a[68:71], a[36:39], v[32:35]
    v_mfma_f32_16x16x32_bf16 v[36:39], a[52:55], a[40:43], v[36:39]
    v_mfma_f32_16x16x32_bf16 v[40:43], a[56:59], a[40:43], v[40:43]
    v_mfma_f32_16x16x32_bf16 v[44:47], a[60:63], a[40:43], v[44:47]
    v_mfma_f32_16x16x32_bf16 v[48:51], a[64:67], a[40:43], v[48:51]
    v_mfma_f32_16x16x32_bf16 v[52:55], a[68:71], a[40:43], v[52:55]
    v_mfma_f32_16x16x32_bf16 v[56:59], a[52:55], a[44:47], v[56:59]
    v_mfma_f32_16x16x32_bf16 v[60:63], a[56:59], a[44:47], v[60:63]
    v_mfma_f32_16x16x32_bf16 v[64:67], a[60:63], a[44:47], v[64:67]
    v_mfma_f32_16x16x32_bf16 v[68:71], a[64:67], a[44:47], v[68:71]
    v_mfma_f32_16x16x32_bf16 v[72:75], a[68:71], a[44:47], v[72:75]
    v_mfma_f32_16x16x32_bf16 v[76:79], a[52:55], a[48:51], v[76:79]
    v_mfma_f32_16x16x32_bf16 v[80:83], a[56:59], a[48:51], v[80:83]
    v_mfma_f32_16x16x32_bf16 v[84:87], a[60:63], a[48:51], v[84:87]
    v_mfma_f32_16x16x32_bf16 v[88:91], a[64:67], a[48:51], v[88:91]
    v_mfma_f32_16x16x32_bf16 v[92:95], a[68:71], a[48:51], v[92:95]
    s_waitcnt vmcnt(26) lgkmcnt(10)
    s_waitcnt lgkmcnt(0)
    s_barrier
    s_nop 0
    v_mfma_f32_16x16x32_bf16 v[16:19], a[88:91], a[72:75], v[16:19]
    v_mfma_f32_16x16x32_bf16 v[20:23], a[92:95], a[72:75], v[20:23]
    v_mfma_f32_16x16x32_bf16 v[24:27], a[96:99], a[72:75], v[24:27]
    v_mfma_f32_16x16x32_bf16 v[28:31], a[100:103], a[72:75], v[28:31]
    v_mfma_f32_16x16x32_bf16 v[32:35], a[104:107], a[72:75], v[32:35]
    v_mfma_f32_16x16x32_bf16 v[36:39], a[88:91], a[76:79], v[36:39]
    v_mfma_f32_16x16x32_bf16 v[40:43], a[92:95], a[76:79], v[40:43]
    v_mfma_f32_16x16x32_bf16 v[44:47], a[96:99], a[76:79], v[44:47]
    v_mfma_f32_16x16x32_bf16 v[48:51], a[100:103], a[76:79], v[48:51]
    v_mfma_f32_16x16x32_bf16 v[52:55], a[104:107], a[76:79], v[52:55]
    v_mfma_f32_16x16x32_bf16 v[56:59], a[88:91], a[80:83], v[56:59]
    v_mfma_f32_16x16x32_bf16 v[60:63], a[92:95], a[80:83], v[60:63]
    v_mfma_f32_16x16x32_bf16 v[64:67], a[96:99], a[80:83], v[64:67]
    v_mfma_f32_16x16x32_bf16 v[68:71], a[100:103], a[80:83], v[68:71]
    v_mfma_f32_16x16x32_bf16 v[72:75], a[104:107], a[80:83], v[72:75]
    v_mfma_f32_16x16x32_bf16 v[76:79], a[88:91], a[84:87], v[76:79]
    v_mfma_f32_16x16x32_bf16 v[80:83], a[92:95], a[84:87], v[80:83]
    v_mfma_f32_16x16x32_bf16 v[84:87], a[96:99], a[84:87], v[84:87]
    v_mfma_f32_16x16x32_bf16 v[88:91], a[100:103], a[84:87], v[88:91]
    v_mfma_f32_16x16x32_bf16 v[92:95], a[104:107], a[84:87], v[92:95]
    s_waitcnt vmcnt(22)
    s_nop 0
    v_mfma_f32_16x16x32_bf16 v[16:19], a[124:127], a[108:111], v[16:19]
    v_mfma_f32_16x16x32_bf16 v[20:23], a[128:131], a[108:111], v[20:23]
    v_mfma_f32_16x16x32_bf16 v[24:27], a[132:135], a[108:111], v[24:27]
    v_mfma_f32_16x16x32_bf16 v[28:31], a[136:139], a[108:111], v[28:31]
    v_mfma_f32_16x16x32_bf16 v[32:35], a[140:143], a[108:111], v[32:35]
    v_mfma_f32_16x16x32_bf16 v[36:39], a[124:127], a[112:115], v[36:39]
    v_mfma_f32_16x16x32_bf16 v[40:43], a[128:131], a[112:115], v[40:43]
    v_mfma_f32_16x16x32_bf16 v[44:47], a[132:135], a[112:115], v[44:47]
    v_mfma_f32_16x16x32_bf16 v[48:51], a[136:139], a[112:115], v[48:51]
    v_mfma_f32_16x16x32_bf16 v[52:55], a[140:143], a[112:115], v[52:55]
    v_mfma_f32_16x16x32_bf16 v[56:59], a[124:127], a[116:119], v[56:59]
    v_mfma_f32_16x16x32_bf16 v[60:63], a[128:131], a[116:119], v[60:63]
    v_mfma_f32_16x16x32_bf16 v[64:67], a[132:135], a[116:119], v[64:67]
    v_mfma_f32_16x16x32_bf16 v[68:71], a[136:139], a[116:119], v[68:71]
    v_mfma_f32_16x16x32_bf16 v[72:75], a[140:143], a[116:119], v[72:75]
    v_mfma_f32_16x16x32_bf16 v[76:79], a[124:127], a[120:123], v[76:79]
    v_mfma_f32_16x16x32_bf16 v[80:83], a[128:131], a[120:123], v[80:83]
    v_mfma_f32_16x16x32_bf16 v[84:87], a[132:135], a[120:123], v[84:87]
    v_mfma_f32_16x16x32_bf16 v[88:91], a[136:139], a[120:123], v[88:91]
    v_mfma_f32_16x16x32_bf16 v[92:95], a[140:143], a[120:123], v[92:95]
    s_waitcnt vmcnt(18)
    s_nop 0
    v_mfma_f32_16x16x32_bf16 v[16:19], a[160:163], a[144:147], v[16:19]
    v_mfma_f32_16x16x32_bf16 v[20:23], a[164:167], a[144:147], v[20:23]
    v_mfma_f32_16x16x32_bf16 v[24:27], a[168:171], a[144:147], v[24:27]
    v_mfma_f32_16x16x32_bf16 v[28:31], a[172:175], a[144:147], v[28:31]
    v_mfma_f32_16x16x32_bf16 v[32:35], a[176:179], a[144:147], v[32:35]
    v_mfma_f32_16x16x32_bf16 v[36:39], a[160:163], a[148:151], v[36:39]
    v_mfma_f32_16x16x32_bf16 v[40:43], a[164:167], a[148:151], v[40:43]
    v_mfma_f32_16x16x32_bf16 v[44:47], a[168:171], a[148:151], v[44:47]
    v_mfma_f32_16x16x32_bf16 v[48:51], a[172:175], a[148:151], v[48:51]
    v_mfma_f32_16x16x32_bf16 v[52:55], a[176:179], a[148:151], v[52:55]
    v_mfma_f32_16x16x32_bf16 v[56:59], a[160:163], a[152:155], v[56:59]
    v_mfma_f32_16x16x32_bf16 v[60:63], a[164:167], a[152:155], v[60:63]
    v_mfma_f32_16x16x32_bf16 v[64:67], a[168:171], a[152:155], v[64:67]
    v_mfma_f32_16x16x32_bf16 v[68:71], a[172:175], a[152:155], v[68:71]
    v_mfma_f32_16x16x32_bf16 v[72:75], a[176:179], a[152:155], v[72:75]
    v_mfma_f32_16x16x32_bf16 v[76:79], a[160:163], a[156:159], v[76:79]
    v_mfma_f32_16x16x32_bf16 v[80:83], a[164:167], a[156:159], v[80:83]
    v_mfma_f32_16x16x32_bf16 v[84:87], a[168:171], a[156:159], v[84:87]
    v_mfma_f32_16x16x32_bf16 v[88:91], a[172:175], a[156:159], v[88:91]
    v_mfma_f32_16x16x32_bf16 v[92:95], a[176:179], a[156:159], v[92:95]
    s_waitcnt vmcnt(9)
    s_nop 0
    v_mfma_f32_16x16x32_bf16 v[16:19], a[196:199], a[180:183], v[16:19]
    v_mfma_f32_16x16x32_bf16 v[20:23], a[200:203], a[180:183], v[20:23]
    v_mfma_f32_16x16x32_bf16 v[24:27], a[204:207], a[180:183], v[24:27]
    v_mfma_f32_16x16x32_bf16 v[28:31], a[208:211], a[180:183], v[28:31]
    v_mfma_f32_16x16x32_bf16 v[32:35], a[212:215], a[180:183], v[32:35]
    v_mfma_f32_16x16x32_bf16 v[36:39], a[196:199], a[184:187], v[36:39]
    v_mfma_f32_16x16x32_bf16 v[40:43], a[200:203], a[184:187], v[40:43]
    v_mfma_f32_16x16x32_bf16 v[44:47], a[204:207], a[184:187], v[44:47]
    v_mfma_f32_16x16x32_bf16 v[48:51], a[208:211], a[184:187], v[48:51]
    v_mfma_f32_16x16x32_bf16 v[52:55], a[212:215], a[184:187], v[52:55]
    v_mfma_f32_16x16x32_bf16 v[56:59], a[196:199], a[188:191], v[56:59]
    v_mfma_f32_16x16x32_bf16 v[60:63], a[200:203], a[188:191], v[60:63]
    v_mfma_f32_16x16x32_bf16 v[64:67], a[204:207], a[188:191], v[64:67]
    v_mfma_f32_16x16x32_bf16 v[68:71], a[208:211], a[188:191], v[68:71]
    v_mfma_f32_16x16x32_bf16 v[72:75], a[212:215], a[188:191], v[72:75]
    v_mfma_f32_16x16x32_bf16 v[76:79], a[196:199], a[192:195], v[76:79]
    v_mfma_f32_16x16x32_bf16 v[80:83], a[200:203], a[192:195], v[80:83]
    v_mfma_f32_16x16x32_bf16 v[84:87], a[204:207], a[192:195], v[84:87]
    v_mfma_f32_16x16x32_bf16 v[88:91], a[208:211], a[192:195], v[88:91]
    v_mfma_f32_16x16x32_bf16 v[92:95], a[212:215], a[192:195], v[92:95]
    s_waitcnt vmcnt(0)
    s_nop 0
    v_mfma_f32_16x16x32_bf16 v[36:39], a[232:235], a[220:223], v[36:39]
    v_mfma_f32_16x16x32_bf16 v[40:43], a[236:239], a[220:223], v[40:43]
    v_mfma_f32_16x16x32_bf16 v[44:47], a[240:243], a[220:223], v[44:47]
    v_mfma_f32_16x16x32_bf16 v[48:51], a[244:247], a[220:223], v[48:51]
    v_mfma_f32_16x16x32_bf16 v[52:55], a[248:251], a[220:223], v[52:55]
    v_mfma_f32_16x16x32_bf16 v[56:59], a[232:235], a[224:227], v[56:59]
    v_mfma_f32_16x16x32_bf16 v[60:63], a[236:239], a[224:227], v[60:63]
    v_mfma_f32_16x16x32_bf16 v[64:67], a[240:243], a[224:227], v[64:67]
    v_mfma_f32_16x16x32_bf16 v[68:71], a[244:247], a[224:227], v[68:71]
    v_mfma_f32_16x16x32_bf16 v[72:75], a[248:251], a[224:227], v[72:75]
    ds_write_b128 v101, v[36:39]
    ds_write_b128 v101, v[40:43] offset:1024
    ds_write_b128 v101, v[44:47] offset:2048
    ds_write_b128 v101, v[48:51] offset:3072
    ds_write_b128 v101, v[52:55] offset:4096
    v_mfma_f32_16x16x32_bf16 v[76:79], a[232:235], a[228:231], v[76:79]
    v_mfma_f32_16x16x32_bf16 v[80:83], a[236:239], a[228:231], v[80:83]
    v_mfma_f32_16x16x32_bf16 v[84:87], a[240:243], a[228:231], v[84:87]
    v_mfma_f32_16x16x32_bf16 v[88:91], a[244:247], a[228:231], v[88:91]
    v_mfma_f32_16x16x32_bf16 v[92:95], a[248:251], a[228:231], v[92:95]
    ds_write_b128 v102, v[56:59]
    ds_write_b128 v102, v[60:63] offset:1024
    ds_write_b128 v102, v[64:67] offset:2048
    ds_write_b128 v102, v[68:71] offset:3072
    ds_write_b128 v102, v[72:75] offset:4096
    v_mfma_f32_16x16x32_bf16 v[16:19], a[232:235], a[216:219], v[16:19]
    v_mfma_f32_16x16x32_bf16 v[20:23], a[236:239], a[216:219], v[20:23]
    v_mfma_f32_16x16x32_bf16 v[24:27], a[240:243], a[216:219], v[24:27]
    v_mfma_f32_16x16x32_bf16 v[28:31], a[244:247], a[216:219], v[28:31]
    v_mfma_f32_16x16x32_bf16 v[32:35], a[248:251], a[216:219], v[32:35]
    ds_write_b128 v103, v[76:79]
    ds_write_b128 v103, v[80:83] offset:1024
    ds_write_b128 v103, v[84:87] offset:2048
    ds_write_b128 v103, v[88:91] offset:3072
    ds_write_b128 v103, v[92:95] offset:4096
    s_waitcnt lgkmcnt(0)
    s_barrier
    ds_read_b128 v[144:147], v100
    ds_read_b128 v[164:167], v100 offset:5120
    ds_read_b128 v[184:187], v100 offset:10240
    ds_read_b128 v[148:151], v100 offset:1024
    ds_read_b128 v[168:171], v100 offset:6144
    ds_read_b128 v[188:191], v100 offset:11264
    ds_read_b128 v[152:155], v100 offset:2048
    ds_read_b128 v[172:175], v100 offset:7168
    ds_read_b128 v[192:195], v100 offset:12288
    ds_read_b128 v[156:159], v100 offset:3072
    ds_read_b128 v[176:179], v100 offset:8192
    ds_read_b128 v[196:199], v100 offset:13312
    ds_read_b128 v[160:163], v100 offset:4096
    ds_read_b128 v[180:183], v100 offset:9216
    ds_read_b128 v[200:203], v100 offset:14336
    s_waitcnt lgkmcnt(13)
    v_pk_add_f32 v[144:145], v[144:145], v[164:165]
    v_pk_add_f32 v[146:147], v[146:147], v[166:167]
    s_waitcnt lgkmcnt(12)
    v_pk_add_f32 v[16:17], v[16:17], v[184:185]
    v_pk_add_f32 v[18:19], v[18:19], v[186:187]
    s_waitcnt lgkmcnt(10)
    v_pk_add_f32 v[148:149], v[148:149], v[168:169]
    v_pk_add_f32 v[150:151], v[150:151], v[170:171]
    s_waitcnt lgkmcnt(9)
    v_pk_add_f32 v[20:21], v[20:21], v[188:189]
    v_pk_add_f32 v[22:23], v[22:23], v[190:191]
    s_waitcnt lgkmcnt(7)
    v_pk_add_f32 v[152:153], v[152:153], v[172:173]
    v_pk_add_f32 v[154:155], v[154:155], v[174:175]
    s_waitcnt lgkmcnt(6)
    v_pk_add_f32 v[24:25], v[24:25], v[192:193]
    v_pk_add_f32 v[26:27], v[26:27], v[194:195]
    s_waitcnt lgkmcnt(4)
    v_pk_add_f32 v[156:157], v[156:157], v[176:177]
    v_pk_add_f32 v[158:159], v[158:159], v[178:179]
    s_waitcnt lgkmcnt(3)
    v_pk_add_f32 v[28:29], v[28:29], v[196:197]
    v_pk_add_f32 v[30:31], v[30:31], v[198:199]
    s_waitcnt lgkmcnt(1)
    v_pk_add_f32 v[160:161], v[160:161], v[180:181]
    v_pk_add_f32 v[162:163], v[162:163], v[182:183]
    s_waitcnt lgkmcnt(0)
    v_pk_add_f32 v[32:33], v[32:33], v[200:201]
    v_pk_add_f32 v[34:35], v[34:35], v[202:203]
    v_pk_add_f32 v[16:17], v[16:17], v[144:145]
    v_pk_add_f32 v[18:19], v[18:19], v[146:147]
    v_pk_add_f32 v[20:21], v[20:21], v[148:149]
    v_pk_add_f32 v[22:23], v[22:23], v[150:151]
    v_pk_add_f32 v[24:25], v[24:25], v[152:153]
    v_pk_add_f32 v[26:27], v[26:27], v[154:155]
    v_pk_add_f32 v[28:29], v[28:29], v[156:157]
    v_pk_add_f32 v[30:31], v[30:31], v[158:159]
    v_pk_add_f32 v[32:33], v[32:33], v[160:161]
    v_pk_add_f32 v[34:35], v[34:35], v[162:163]
    s_lshl_b32 s51, s49, 6
    s_lshl_b32 s52, s48, 4
    s_add_u32 s51, s51, s52
    s_mul_i32 s51, s51, 0x500
    s_mul_i32 s52, s50, 0xa0
    s_add_u32 s51, s51, s52
    v_mul_u32_u24 v10, 0x500, v3
    v_lshl_add_u32 v11, v2, 3, v10
    v_lshl_add_u32 v10, v2, 4, v10
    v_cvt_pk_bf16_f32 v124, v16, v17
    v_lshlrev_b32_e64 v16, 16, v124
    v_and_b32 v17, 0xffff0000, v124
    v_lshlrev_b32_e64 v126, 16, v240
    v_and_b32 v127, 0xffff0000, v240
    v_pk_add_f32 v[16:17], v[16:17], v[126:127]
    v_cvt_pk_bf16_f32 v112, v16, v17
    v_cvt_pk_bf16_f32 v128, v18, v19
    v_lshlrev_b32_e64 v18, 16, v128
    v_and_b32 v19, 0xffff0000, v128
    v_lshlrev_b32_e64 v130, 16, v241
    v_and_b32 v131, 0xffff0000, v241
    v_pk_add_f32 v[18:19], v[18:19], v[130:131]
    v_cvt_pk_bf16_f32 v113, v18, v19
    v_cvt_pk_bf16_f32 v124, v20, v21
    v_lshlrev_b32_e64 v20, 16, v124
    v_and_b32 v21, 0xffff0000, v124
    v_lshlrev_b32_e64 v126, 16, v242
    v_and_b32 v127, 0xffff0000, v242
    v_pk_add_f32 v[20:21], v[20:21], v[126:127]
    v_cvt_pk_bf16_f32 v114, v20, v21
    v_cvt_pk_bf16_f32 v128, v22, v23
    v_lshlrev_b32_e64 v22, 16, v128
    v_and_b32 v23, 0xffff0000, v128
    v_lshlrev_b32_e64 v130, 16, v243
    v_and_b32 v131, 0xffff0000, v243
    v_pk_add_f32 v[22:23], v[22:23], v[130:131]
    v_cvt_pk_bf16_f32 v115, v22, v23
    v_cvt_pk_bf16_f32 v124, v24, v25
    v_lshlrev_b32_e64 v24, 16, v124
    v_and_b32 v25, 0xffff0000, v124
    v_lshlrev_b32_e64 v126, 16, v244
    v_and_b32 v127, 0xffff0000, v244
    v_pk_add_f32 v[24:25], v[24:25], v[126:127]
    v_cvt_pk_bf16_f32 v116, v24, v25
    v_cvt_pk_bf16_f32 v128, v26, v27
    v_lshlrev_b32_e64 v26, 16, v128
    v_and_b32 v27, 0xffff0000, v128
    v_lshlrev_b32_e64 v130, 16, v245
    v_and_b32 v131, 0xffff0000, v245
    v_pk_add_f32 v[26:27], v[26:27], v[130:131]
    v_cvt_pk_bf16_f32 v117, v26, v27
    v_cvt_pk_bf16_f32 v124, v28, v29
    v_lshlrev_b32_e64 v28, 16, v124
    v_and_b32 v29, 0xffff0000, v124
    v_lshlrev_b32_e64 v126, 16, v246
    v_and_b32 v127, 0xffff0000, v246
    v_pk_add_f32 v[28:29], v[28:29], v[126:127]
    v_cvt_pk_bf16_f32 v118, v28, v29
    v_cvt_pk_bf16_f32 v128, v30, v31
    v_lshlrev_b32_e64 v30, 16, v128
    v_and_b32 v31, 0xffff0000, v128
    v_lshlrev_b32_e64 v130, 16, v247
    v_and_b32 v131, 0xffff0000, v247
    v_pk_add_f32 v[30:31], v[30:31], v[130:131]
    v_cvt_pk_bf16_f32 v119, v30, v31
    v_cvt_pk_bf16_f32 v124, v32, v33
    v_lshlrev_b32_e64 v32, 16, v124
    v_and_b32 v33, 0xffff0000, v124
    v_lshlrev_b32_e64 v126, 16, v248
    v_and_b32 v127, 0xffff0000, v248
    v_pk_add_f32 v[32:33], v[32:33], v[126:127]
    v_cvt_pk_bf16_f32 v120, v32, v33
    v_cvt_pk_bf16_f32 v128, v34, v35
    v_lshlrev_b32_e64 v34, 16, v128
    v_and_b32 v35, 0xffff0000, v128
    v_lshlrev_b32_e64 v130, 16, v249
    v_and_b32 v131, 0xffff0000, v249
    v_pk_add_f32 v[34:35], v[34:35], v[130:131]
    v_cvt_pk_bf16_f32 v121, v34, v35
    buffer_store_dwordx4 v[112:115], v10, s[16:19], s51 offen
    buffer_store_dwordx4 v[116:119], v10, s[16:19], s51 offen offset:64
    buffer_store_dwordx2 v[120:121], v11, s[16:19], s51 offen offset:128
L_end_k234_kernel:
    s_endpgm
.p2align 8
L_code_end:
    s_endpgm
.section .rodata,"a"
.p2align 6
.amdhsa_kernel k1_kernel
  .amdhsa_next_free_vgpr 252
  .amdhsa_next_free_sgpr 102
  .amdhsa_accum_offset 252
  .amdhsa_group_segment_fixed_size 0
  .amdhsa_kernarg_size 80
  .amdhsa_user_sgpr_count 2
  .amdhsa_user_sgpr_kernarg_segment_ptr 1
  .amdhsa_system_sgpr_workgroup_id_x 1
.end_amdhsa_kernel
.p2align 6
.amdhsa_kernel k234_kernel
  .amdhsa_next_free_vgpr 508
  .amdhsa_next_free_sgpr 102
  .amdhsa_accum_offset 256
  .amdhsa_group_segment_fixed_size 0
  .amdhsa_kernarg_size 80
  .amdhsa_user_sgpr_count 2
  .amdhsa_user_sgpr_kernarg_segment_ptr 1
  .amdhsa_system_sgpr_workgroup_id_x 1
.end_amdhsa_kernel
```
